```python
import torch

def _softmax(x, axis=-1):
    return torch.softmax(x, dim=axis)
def _gelu(x):
    return torch.nn.functional.gelu(x, approximate="tanh")
def _silu(x):
    return torch.nn.functional.silu(x)
def _sigmoid(x):
    return torch.sigmoid(x)
def _layernorm(x, axis=-1, eps=1e-5):
    m = x.mean(dim=axis, keepdim=True)
    v = x.var(dim=axis, keepdim=True, unbiased=False)
    return (x - m) / torch.sqrt(v + eps)
def _scatter_add(tgt, idx, src, axis=0):
    return tgt.clone().index_add_(axis, idx, src)
def _segment_sum(src, seg, n):
    out = torch.zeros((n,) + src.shape[1:], dtype=src.dtype)
    return out.index_add_(0, seg, src)
def _pad(x, pw):
    flat = tuple(v for pair in reversed(pw) for v in pair)
    return torch.nn.functional.pad(x, flat)

kernel_name = 'standalone__gqa_block_cached__near_ridge'

def setup_inputs():

    _w = (lambda a: (lambda t: t.to(torch.bfloat16) if t.is_floating_point() else t)(torch.as_tensor(a)))
    B, Sq, D = 8, 224, 512
    Hq, Hkv, Sk, Dh = 32, 32, 1024, 128
    assert Hq % Hkv == 0, (Hq, Hkv)
    return {
        "x": _w((lambda *s: torch.randn(*s, dtype=torch.bfloat16) * 0.8)(B, Sq, D)),
        "k_cache": _w((lambda *s: torch.randn(*s, dtype=torch.bfloat16) * 0.8)(B, Hkv, Sk, Dh)),
        "v_cache": _w((lambda *s: torch.randn(*s, dtype=torch.bfloat16) * 0.05)(B, Hkv, Sk, Dh)),
        "wq": _w((lambda *s: torch.randn(*s, dtype=torch.bfloat16) * 0.8)(D, Hq * Dh) * (D ** -0.5)),
        "wo": _w((lambda *s: torch.randn(*s, dtype=torch.bfloat16) * 0.05)(Hq * Dh, D) * ((Hq * Dh) ** -0.5)),
    }

def reference(x, k_cache, v_cache, wq, wo):
    B, Sq, D = x.shape
    Hq, Dh = 32, 128
    Hkv = k_cache.shape[1]
    rep = Hq // Hkv
    q = (lambda x, *d: x.permute(*d))((x @ wq).reshape(B, Sq, Hq, Dh), 0, 2, 1, 3)
    k = (lambda x, n, axis: torch.repeat_interleave(x, n, dim=axis))(k_cache, rep, axis=1)
    v = (lambda x, n, axis: torch.repeat_interleave(x, n, dim=axis))(v_cache, rep, axis=1)
    scores = torch.einsum("bhqd,bhkd->bhqk", q, k) * (Dh ** -0.5)
    p = _softmax(scores, axis=-1)
    o = torch.einsum("bhqk,bhkd->bhqd", p, v)
    return (lambda x, *d: x.permute(*d))(o, 0, 2, 1, 3).reshape(B, Sq, Hq * Dh) @ wo
```

```asm
; @launch grid=(256,1,1) block=(256,1,1) lds=163840
.amdgcn_target "amdgcn-amd-amdhsa--gfx950"
.text
.globl standalone__gqa_block_cached__near_ridge_kernel
.p2align 8
.type standalone__gqa_block_cached__near_ridge_kernel,@function
standalone__gqa_block_cached__near_ridge_kernel:
  s_cmp_ge_u32 s2, 256
  s_cbranch_scc1 L_k1_end
  s_load_dwordx4 s[4:7], s[0:1], 8
  s_load_dwordx2 s[40:41], s[0:1], 0
  s_load_dwordx2 s[42:43], s[0:1], 24
  s_load_dwordx2 s[8:9], s[0:1], 56
  s_load_dwordx2 s[86:87], s[0:1], 48
  s_load_dwordx4 s[88:91], s[0:1], 32
  v_lshrrev_b32 v1, 6, v0
  v_and_b32 v2, 63, v0
  v_readfirstlane_b32 s3, v1
  s_and_b32 s20, s2, 7
  s_lshr_b32 s21, s2, 3
  s_lshr_b32 s44, s20, 2
  s_lshl_b32 s44, s44, 2
  s_lshr_b32 s22, s21, 3
  s_add_u32 s44, s44, s22
  s_and_b32 s45, s20, 3
  s_lshl_b32 s45, s45, 3
  s_and_b32 s23, s21, 7
  s_add_u32 s45, s45, s23
  s_lshl_b32 s22, s22, 1
  s_add_u32 s46, s23, s22
  s_and_b32 s46, s46, 7
  s_lshr_b32 s33, s3, 1
  s_and_b32 s34, s3, 1
  s_lshl_b32 s35, s34, 13
  s_and_b32 s24, s2, 15
  s_lshl_b32 s24, s24, 14
  s_getpc_b64 s[20:21]
L_pc_here:
  s_sub_u32 s20, s20, L_pc_here-standalone__gqa_block_cached__near_ridge_kernel
  s_subb_u32 s21, s21, 0
  v_cmp_gt_u32 vcc, 16, v0
  s_and_saveexec_b64 s[22:23], vcc
  s_cbranch_execz L_cpf_done
  s_lshr_b32 s25, s2, 3
  s_lshl_b32 s25, s25, 11
  v_lshlrev_b32 v3, 7, v0
  v_add_u32 v3, s25, v3
  v_min_u32 v3, L_k1_end-standalone__gqa_block_cached__near_ridge_kernel, v3
  global_load_dword v38, v3, s[20:21]
L_cpf_done:
  s_mov_b64 exec, s[22:23]
  v_lshrrev_b32 v3, 3, v2
  v_lshrrev_b32 v4, 4, v2
  v_and_b32 v5, 7, v2
  v_xor_b32 v5, v5, v4
  s_mul_i32 s20, s3, 57344
  v_lshlrev_b32 v6, 10, v3
  v_add_u32 v6, s20, v6
  s_and_b32 s21, s3, 1
  s_lshl_b32 s21, s21, 2
  v_xor_b32 v5, s21, v5
  v_xor_b32 v7, 0, v5
  v_lshl_add_u32 v7, v7, 4, v6
  v_add_u32 v240, 0, v7
  v_xor_b32 v7, 4, v5
  v_lshl_add_u32 v7, v7, 4, v6
  v_add_u32 v241, 7168, v7
  v_xor_b32 v7, 0, v5
  v_lshl_add_u32 v7, v7, 4, v6
  v_add_u32 v242, 14336, v7
  v_xor_b32 v7, 4, v5
  v_lshl_add_u32 v7, v7, 4, v6
  v_add_u32 v243, 21504, v7
  v_xor_b32 v7, 0, v5
  v_lshl_add_u32 v7, v7, 4, v6
  v_add_u32 v244, 32768, v7
  v_xor_b32 v7, 4, v5
  v_lshl_add_u32 v7, v7, 4, v6
  v_add_u32 v245, 39936, v7
  v_xor_b32 v7, 0, v5
  v_lshl_add_u32 v7, v7, 4, v6
  v_add_u32 v246, 47104, v7
  v_and_b32 v5, 15, v2
  v_lshlrev_b32 v6, 2, v4
  v_xor_b32 v5, v5, v6
  v_lshlrev_b32 v5, 4, v5
  v_lshl_add_u32 v5, v4, 13, v5
  s_lshl_b32 s20, s3, 17
  v_add_u32 v5, s20, v5
  v_add_u32 v247, 0, v5
  v_add_u32 v248, 31744, v5
  v_add_u32 v249, 63488, v5
  v_add_u32 v250, 95232, v5
  s_mul_i32 s59, s3, 7168
  s_lshl_b32 s60, s3, 12
  s_add_u32 s60, s60, 28672
  s_mov_b32 s58, 73728
  s_sub_u32 s46, s46, 1
  s_waitcnt lgkmcnt(0)
  s_lshl_b32 s10, s44, 5
  s_add_u32 s10, s10, s45
  s_lshl_b32 s10, s10, 18
  s_add_u32 s50, s4, s10
  s_addc_u32 s51, s5, 0
  s_add_u32 s52, s6, s10
  s_addc_u32 s53, s7, 0
  s_add_u32 s12, s50, s24
  s_addc_u32 s13, s51, 0
  s_add_u32 s16, s52, s24
  s_addc_u32 s17, s53, 0
  s_mul_i32 s20, s44, 229376
  s_add_u32 s40, s40, s20
  s_addc_u32 s41, s41, 0
  s_lshl_b32 s20, s45, 8
  s_add_u32 s42, s42, s20
  s_addc_u32 s43, s43, 0
  s_add_u32 s46, s46, 1
  s_and_b32 s46, s46, 7
  s_lshl_b32 s20, s46, 7
  s_add_u32 s54, s40, s20
  s_addc_u32 s55, s41, 0
  s_lshl_b32 s20, s46, 19
  s_add_u32 s56, s42, s20
  s_addc_u32 s57, s43, 0
  s_add_u32 m0, s58, s59
  s_nop 0
  global_load_lds_dwordx4 v240, s[54:55] offset:0
  global_load_lds_dwordx4 v241, s[54:55] offset:1024
  global_load_lds_dwordx4 v242, s[54:55] offset:2048
  global_load_lds_dwordx4 v243, s[54:55] offset:3072
  s_add_u32 m0, m0, 4096
  s_nop 0
  global_load_lds_dwordx4 v244, s[54:55] offset:0
  global_load_lds_dwordx4 v245, s[54:55] offset:1024
  global_load_lds_dwordx4 v246, s[54:55] offset:2048
  s_add_u32 m0, s58, s60
  s_nop 0
  global_load_lds_dwordx4 v247, s[56:57] offset:0
  global_load_lds_dwordx4 v248, s[56:57] offset:1024
  global_load_lds_dwordx4 v249, s[56:57] offset:2048
  global_load_lds_dwordx4 v250, s[56:57] offset:3072
  s_add_u32 s58, s58, 45056
  s_cmp_ge_u32 s58, 163840
  s_cselect_b32 s20, 135168, 0
  s_sub_u32 s58, s58, s20
  s_add_u32 s46, s46, 1
  s_and_b32 s46, s46, 7
  s_lshl_b32 s20, s46, 7
  s_add_u32 s54, s40, s20
  s_addc_u32 s55, s41, 0
  s_lshl_b32 s20, s46, 19
  s_add_u32 s56, s42, s20
  s_addc_u32 s57, s43, 0
  s_add_u32 m0, s58, s59
  s_nop 0
  global_load_lds_dwordx4 v240, s[54:55] offset:0
  global_load_lds_dwordx4 v241, s[54:55] offset:1024
  global_load_lds_dwordx4 v242, s[54:55] offset:2048
  global_load_lds_dwordx4 v243, s[54:55] offset:3072
  s_add_u32 m0, m0, 4096
  s_nop 0
  global_load_lds_dwordx4 v244, s[54:55] offset:0
  global_load_lds_dwordx4 v245, s[54:55] offset:1024
  global_load_lds_dwordx4 v246, s[54:55] offset:2048
  s_add_u32 m0, s58, s60
  s_nop 0
  global_load_lds_dwordx4 v247, s[56:57] offset:0
  global_load_lds_dwordx4 v248, s[56:57] offset:1024
  global_load_lds_dwordx4 v249, s[56:57] offset:2048
  global_load_lds_dwordx4 v250, s[56:57] offset:3072
  s_add_u32 s58, s58, 45056
  s_cmp_ge_u32 s58, 163840
  s_cselect_b32 s20, 135168, 0
  s_sub_u32 s58, s58, s20
  s_getreg_b32 s62, hwreg(HW_REG_XCC_ID)
  s_and_b32 s62, s62, 7
  v_cmp_eq_u32 vcc, 0, v0
  s_and_saveexec_b64 s[20:21], vcc
  s_cbranch_execz L_sig_done
  s_cmp_lg_u32 s2, 0
  s_cbranch_scc1 L_sig_done
  s_memrealtime s[64:65]
  s_waitcnt lgkmcnt(0)
  s_or_b32 s64, s64, 1
  v_mov_b32 v4, s64
  v_mov_b32 v5, s65
  v_mov_b32 v3, 0
  global_store_dwordx2 v3, v[4:5], s[86:87] sc1
L_sig_done:
  s_mov_b64 exec, s[20:21]
  v_lshrrev_b32 v3, 4, v2
  v_and_b32 v4, 15, v2
  v_xor_b32 v5, v4, v3
  v_lshlrev_b32 v6, 1, v3
  v_xor_b32 v6, v4, v6
  s_lshl_b32 s29, s3, 12
  v_xor_b32 v7, 0, v5
  v_lshlrev_b32 v7, 4, v7
  v_lshl_add_u32 v7, v3, 8, v7
  v_add_u32 v20, s29, v7
  v_xor_b32 v7, 4, v5
  v_lshlrev_b32 v7, 4, v7
  v_lshl_add_u32 v7, v3, 8, v7
  v_add_u32 v21, s29, v7
  v_xor_b32 v7, 8, v5
  v_lshlrev_b32 v7, 4, v7
  v_lshl_add_u32 v7, v3, 8, v7
  v_add_u32 v22, s29, v7
  v_xor_b32 v7, 12, v5
  v_lshlrev_b32 v7, 4, v7
  v_lshl_add_u32 v7, v3, 8, v7
  v_add_u32 v23, s29, v7
  v_xor_b32 v7, 0, v6
  v_lshlrev_b32 v7, 4, v7
  v_lshl_add_u32 v7, v3, 8, v7
  v_add_u32 v24, s29, v7
  v_xor_b32 v7, 8, v6
  v_lshlrev_b32 v7, 4, v7
  v_lshl_add_u32 v7, v3, 8, v7
  v_add_u32 v25, s29, v7
  s_mov_b32 s28, 0
  s_mov_b32 s30, s29
  s_mov_b32 m0, s30
  s_nop 0
  s_mov_b32 s94, 0
  s_mov_b32 m0, s30
  s_nop 0
  global_load_lds_dwordx4 v20, s[12:13] offset:0 nt
  global_load_lds_dwordx4 v21, s[12:13] offset:1024 nt
  global_load_lds_dwordx4 v22, s[12:13] offset:2048 nt
  global_load_lds_dwordx4 v23, s[12:13] offset:3072 nt
  v_and_b32 v3, 15, v2
  v_lshrrev_b32 v4, 4, v2
  v_lshrrev_b32 v5, 1, v3
  v_xor_b32 v5, v5, v4
  v_lshlrev_b32 v5, 4, v5
  v_lshl_add_u32 v5, v3, 7, v5
  s_mul_i32 s20, s33, 14336
  s_add_u32 s20, s20, 73728
  v_add_u32 v253, s20, v5
  v_xor_b32 v5, 64, v5
  v_add_u32 v254, s20, v5
  v_bfe_u32 v5, v2, 2, 2
  v_and_b32 v6, 3, v2
  v_lshlrev_b32 v7, 2, v5
  v_xor_b32 v6, v6, v7
  s_lshl_b32 s21, s34, 3
  v_xor_b32 v6, s21, v6
  v_lshlrev_b32 v6, 4, v6
  v_lshl_add_u32 v7, v4, 3, v5
  v_lshl_add_u32 v6, v7, 8, v6
  v_add_u32 v251, 102400, v6
  v_xor_b32 v6, 64, v6
  v_add_u32 v252, 102400, v6
  s_mov_b32 s61, 73728
  v_and_b32 v3, 15, v2
  v_lshrrev_b32 v4, 4, v2
  v_xor_b32 v5, v3, v4
  v_lshlrev_b32 v5, 4, v5
  v_lshl_add_u32 v5, v3, 8, v5
  s_lshl_b32 s36, s34, 7
  v_xor_b32 v5, s36, v5
  v_mov_b32 v33, v5
  v_add_u32 v5, s35, v5
  v_xor_b32 v8, 0, v5
  v_xor_b32 v9, 64, v5
  v_xor_b32 v10, 128, v5
  v_xor_b32 v11, 192, v5
  v_bfe_u32 v5, v2, 2, 2
  v_lshl_add_u32 v6, v4, 2, v5
  v_and_b32 v7, 7, v6
  v_lshlrev_b32 v6, 8, v6
  v_and_b32 v34, 3, v2
  v_lshl_add_u32 v6, v34, 3, v6
  v_add_u32 v6, 0x4000, v6
  v_add_u32 v6, s35, v6
  v_lshlrev_b32 v7, 5, v7
  s_lshl_b32 s36, s34, 7
  v_xor_b32 v7, s36, v7
  v_xor_b32 v34, 0, v7
  v_add_u32 v12, v6, v34
  v_xor_b32 v34, 32, v7
  v_add_u32 v13, v6, v34
  v_xor_b32 v34, 64, v7
  v_add_u32 v14, v6, v34
  v_xor_b32 v34, 96, v7
  v_add_u32 v15, v6, v34
  v_xor_b32 v34, 128, v7
  v_add_u32 v16, v6, v34
  v_xor_b32 v34, 160, v7
  v_add_u32 v17, v6, v34
  v_xor_b32 v34, 192, v7
  v_add_u32 v18, v6, v34
  v_xor_b32 v34, 224, v7
  v_add_u32 v19, v6, v34
  v_mov_b32 v26, 0
  v_mov_b32 v27, 0
  v_mov_b32 v28, 0
  v_mov_b32 v29, 0
  v_mov_b32 v30, 0
  v_mov_b32 v31, 0
  v_mov_b32 v32, 0
  s_waitcnt vmcnt(15)
  s_barrier
  ds_read_b64_tr_b16 v[152:153], v251 offset:0
  ds_read_b64_tr_b16 v[154:155], v251 offset:1024
  ds_read_b128 v[184:187], v253 offset:0
  ds_read_b128 v[188:191], v253 offset:2048
  ds_read_b128 v[192:195], v253 offset:4096
  ds_read_b128 v[196:199], v253 offset:6144
  ds_read_b128 v[200:203], v253 offset:8192
  ds_read_b128 v[204:207], v253 offset:10240
  ds_read_b128 v[208:211], v253 offset:12288
  ds_read_b64_tr_b16 v[156:157], v251 offset:8
  ds_read_b64_tr_b16 v[158:159], v251 offset:1032
  ds_read_b64_tr_b16 v[160:161], v252 offset:0
  ds_read_b64_tr_b16 v[162:163], v252 offset:1024
  ds_read_b64_tr_b16 v[164:165], v252 offset:8
  ds_read_b64_tr_b16 v[166:167], v252 offset:1032
  s_add_u32 s46, s46, 1
  s_and_b32 s46, s46, 7
  s_lshl_b32 s20, s46, 7
  s_add_u32 s54, s40, s20
  s_addc_u32 s55, s41, 0
  s_lshl_b32 s20, s46, 19
  s_add_u32 s56, s42, s20
  s_addc_u32 s57, s43, 0
  s_waitcnt lgkmcnt(12)
  v_mfma_f32_16x16x32_bf16 v[40:43], v[152:155], v[184:187], 0
  s_waitcnt lgkmcnt(11)
  ds_read_b64_tr_b16 v[168:169], v251 offset:8192
  v_accvgpr_write_b32 a0, 0
  v_mfma_f32_16x16x32_bf16 v[56:59], v[152:155], v[188:191], 0
  s_waitcnt lgkmcnt(11)
  ds_read_b64_tr_b16 v[170:171], v251 offset:9216
  v_accvgpr_write_b32 a1, 0
  v_mfma_f32_16x16x32_bf16 v[72:75], v[152:155], v[192:195], 0
  s_waitcnt lgkmcnt(11)
  ds_read_b128 v[212:215], v254 offset:0
  v_accvgpr_write_b32 a2, 0
  v_mfma_f32_16x16x32_bf16 v[88:91], v[152:155], v[196:199], 0
  s_waitcnt lgkmcnt(11)
  ds_read_b128 v[216:219], v254 offset:2048
  v_accvgpr_write_b32 a3, 0
  v_mfma_f32_16x16x32_bf16 v[104:107], v[152:155], v[200:203], 0
  s_waitcnt lgkmcnt(11)
  ds_read_b128 v[220:223], v254 offset:4096
  v_accvgpr_write_b32 a4, 0
  v_mfma_f32_16x16x32_bf16 v[120:123], v[152:155], v[204:207], 0
  s_waitcnt lgkmcnt(11)
  ds_read_b128 v[224:227], v254 offset:6144
  v_accvgpr_write_b32 a5, 0
  s_add_u32 m0, s58, s59
  v_mfma_f32_16x16x32_bf16 v[136:139], v[152:155], v[208:211], 0
  s_waitcnt lgkmcnt(10)
  ds_read_b128 v[228:231], v254 offset:8192
  global_load_lds_dwordx4 v240, s[54:55] offset:0
  v_mfma_f32_16x16x32_bf16 v[44:47], v[156:159], v[184:187], 0
  ds_read_b128 v[232:235], v254 offset:10240
  v_accvgpr_write_b32 a6, 0
  v_mfma_f32_16x16x32_bf16 v[60:63], v[156:159], v[188:191], 0
  ds_read_b128 v[236:239], v254 offset:12288
  global_load_lds_dwordx4 v241, s[54:55] offset:1024
  v_mfma_f32_16x16x32_bf16 v[76:79], v[156:159], v[192:195], 0
  ds_read_b64_tr_b16 v[172:173], v251 offset:8200
  v_accvgpr_write_b32 a7, 0
  v_mfma_f32_16x16x32_bf16 v[92:95], v[156:159], v[196:199], 0
  ds_read_b64_tr_b16 v[174:175], v251 offset:9224
  global_load_lds_dwordx4 v242, s[54:55] offset:2048
  v_mfma_f32_16x16x32_bf16 v[108:111], v[156:159], v[200:203], 0
  ds_read_b64_tr_b16 v[176:177], v252 offset:8192
  v_accvgpr_write_b32 a8, 0
  v_mfma_f32_16x16x32_bf16 v[124:127], v[156:159], v[204:207], 0
  ds_read_b64_tr_b16 v[178:179], v252 offset:9216
  global_load_lds_dwordx4 v243, s[54:55] offset:3072
  v_mfma_f32_16x16x32_bf16 v[140:143], v[156:159], v[208:211], 0
  s_waitcnt lgkmcnt(15)
  ds_read_b64_tr_b16 v[180:181], v252 offset:8200
  v_accvgpr_write_b32 a9, 0
  s_add_u32 m0, m0, 4096
  v_mfma_f32_16x16x32_bf16 v[48:51], v[160:163], v[184:187], 0
  ds_read_b64_tr_b16 v[182:183], v252 offset:9224
  global_load_lds_dwordx4 v244, s[54:55] offset:0
  v_mfma_f32_16x16x32_bf16 v[64:67], v[160:163], v[188:191], 0
  v_accvgpr_write_b32 a10, 0
  v_accvgpr_write_b32 a11, 0
  v_mfma_f32_16x16x32_bf16 v[80:83], v[160:163], v[192:195], 0
  global_load_lds_dwordx4 v245, s[54:55] offset:1024
  v_accvgpr_write_b32 a12, 0
  v_mfma_f32_16x16x32_bf16 v[96:99], v[160:163], v[196:199], 0
  v_accvgpr_write_b32 a13, 0
  v_accvgpr_write_b32 a14, 0
  v_mfma_f32_16x16x32_bf16 v[112:115], v[160:163], v[200:203], 0
  global_load_lds_dwordx4 v246, s[54:55] offset:2048
  v_accvgpr_write_b32 a15, 0
  v_mfma_f32_16x16x32_bf16 v[128:131], v[160:163], v[204:207], 0
  v_accvgpr_write_b32 a16, 0
  v_accvgpr_write_b32 a17, 0
  s_add_u32 m0, s58, s60
  v_mfma_f32_16x16x32_bf16 v[144:147], v[160:163], v[208:211], 0
  s_waitcnt lgkmcnt(15)
  global_load_lds_dwordx4 v247, s[56:57] offset:0
  v_accvgpr_write_b32 a18, 0
  v_mfma_f32_16x16x32_bf16 v[52:55], v[164:167], v[184:187], 0
  v_accvgpr_write_b32 a19, 0
  v_accvgpr_write_b32 a20, 0
  v_mfma_f32_16x16x32_bf16 v[68:71], v[164:167], v[188:191], 0
  global_load_lds_dwordx4 v248, s[56:57] offset:1024
  v_accvgpr_write_b32 a21, 0
  v_mfma_f32_16x16x32_bf16 v[84:87], v[164:167], v[192:195], 0
  v_accvgpr_write_b32 a22, 0
  v_accvgpr_write_b32 a23, 0
  v_mfma_f32_16x16x32_bf16 v[100:103], v[164:167], v[196:199], 0
  global_load_lds_dwordx4 v249, s[56:57] offset:2048
  v_accvgpr_write_b32 a24, 0
  v_mfma_f32_16x16x32_bf16 v[116:119], v[164:167], v[200:203], 0
  v_accvgpr_write_b32 a25, 0
  v_accvgpr_write_b32 a26, 0
  v_mfma_f32_16x16x32_bf16 v[132:135], v[164:167], v[204:207], 0
  global_load_lds_dwordx4 v250, s[56:57] offset:3072
  v_accvgpr_write_b32 a27, 0
  v_mfma_f32_16x16x32_bf16 v[148:151], v[164:167], v[208:211], 0
  v_accvgpr_write_b32 a28, 0
  v_accvgpr_write_b32 a29, 0
  s_add_u32 s58, s58, 45056
  s_cmp_ge_u32 s58, 163840
  s_cselect_b32 s20, 135168, 0
  s_sub_u32 s58, s58, s20
  s_mov_b32 s21, s61
  s_add_u32 s61, s61, 45056
  s_cmp_ge_u32 s61, 163840
  s_cselect_b32 s20, 135168, 0
  s_sub_u32 s61, s61, s20
  s_sub_u32 s21, s61, s21
  v_add_u32 v251, s21, v251
  v_add_u32 v252, s21, v252
  v_add_u32 v253, s21, v253
  v_add_u32 v254, s21, v254
  s_add_u32 s46, s46, 1
  s_and_b32 s46, s46, 7
  s_lshl_b32 s20, s46, 7
  s_add_u32 s54, s40, s20
  s_addc_u32 s55, s41, 0
  s_lshl_b32 s20, s46, 19
  s_add_u32 s56, s42, s20
  s_addc_u32 s57, s43, 0
  s_mov_b32 s47, 0
.p2align 3
L_p1loop:
  s_waitcnt lgkmcnt(0) vmcnt(11)
  s_barrier
  v_mfma_f32_16x16x32_bf16 v[40:43], v[168:171], v[212:215], v[40:43]
  ds_read_b64_tr_b16 v[152:153], v251 offset:0
  s_add_u32 m0, s58, s59
  v_mfma_f32_16x16x32_bf16 v[56:59], v[168:171], v[216:219], v[56:59]
  ds_read_b64_tr_b16 v[154:155], v251 offset:1024
  global_load_lds_dwordx4 v240, s[54:55] offset:0
  v_mfma_f32_16x16x32_bf16 v[72:75], v[168:171], v[220:223], v[72:75]
  ds_read_b128 v[184:187], v253 offset:0
  v_mfma_f32_16x16x32_bf16 v[88:91], v[168:171], v[224:227], v[88:91]
  ds_read_b128 v[188:191], v253 offset:2048
  v_mfma_f32_16x16x32_bf16 v[104:107], v[168:171], v[228:231], v[104:107]
  ds_read_b128 v[192:195], v253 offset:4096
  v_mfma_f32_16x16x32_bf16 v[120:123], v[168:171], v[232:235], v[120:123]
  ds_read_b128 v[196:199], v253 offset:6144
  global_load_lds_dwordx4 v241, s[54:55] offset:1024
  v_mfma_f32_16x16x32_bf16 v[136:139], v[168:171], v[236:239], v[136:139]
  ds_read_b128 v[200:203], v253 offset:8192
  v_mfma_f32_16x16x32_bf16 v[44:47], v[172:175], v[212:215], v[44:47]
  ds_read_b128 v[204:207], v253 offset:10240
  v_mfma_f32_16x16x32_bf16 v[60:63], v[172:175], v[216:219], v[60:63]
  ds_read_b128 v[208:211], v253 offset:12288
  v_mfma_f32_16x16x32_bf16 v[76:79], v[172:175], v[220:223], v[76:79]
  ds_read_b64_tr_b16 v[156:157], v251 offset:8
  global_load_lds_dwordx4 v242, s[54:55] offset:2048
  v_mfma_f32_16x16x32_bf16 v[92:95], v[172:175], v[224:227], v[92:95]
  ds_read_b64_tr_b16 v[158:159], v251 offset:1032
  v_mfma_f32_16x16x32_bf16 v[108:111], v[172:175], v[228:231], v[108:111]
  ds_read_b64_tr_b16 v[160:161], v252 offset:0
  v_mfma_f32_16x16x32_bf16 v[124:127], v[172:175], v[232:235], v[124:127]
  ds_read_b64_tr_b16 v[162:163], v252 offset:1024
  v_mfma_f32_16x16x32_bf16 v[140:143], v[172:175], v[236:239], v[140:143]
  ds_read_b64_tr_b16 v[164:165], v252 offset:8
  global_load_lds_dwordx4 v243, s[54:55] offset:3072
  v_mfma_f32_16x16x32_bf16 v[48:51], v[176:179], v[212:215], v[48:51]
  ds_read_b64_tr_b16 v[166:167], v252 offset:1032
  s_add_u32 m0, m0, 4096
  v_mfma_f32_16x16x32_bf16 v[64:67], v[176:179], v[216:219], v[64:67]
  v_mfma_f32_16x16x32_bf16 v[80:83], v[176:179], v[220:223], v[80:83]
  v_mfma_f32_16x16x32_bf16 v[96:99], v[176:179], v[224:227], v[96:99]
  global_load_lds_dwordx4 v244, s[54:55] offset:0
  v_mfma_f32_16x16x32_bf16 v[112:115], v[176:179], v[228:231], v[112:115]
  v_mfma_f32_16x16x32_bf16 v[128:131], v[176:179], v[232:235], v[128:131]
  v_mfma_f32_16x16x32_bf16 v[144:147], v[176:179], v[236:239], v[144:147]
  v_mfma_f32_16x16x32_bf16 v[52:55], v[180:183], v[212:215], v[52:55]
  global_load_lds_dwordx4 v245, s[54:55] offset:1024
  v_mfma_f32_16x16x32_bf16 v[68:71], v[180:183], v[216:219], v[68:71]
  v_mfma_f32_16x16x32_bf16 v[84:87], v[180:183], v[220:223], v[84:87]
  v_mfma_f32_16x16x32_bf16 v[100:103], v[180:183], v[224:227], v[100:103]
  v_mfma_f32_16x16x32_bf16 v[116:119], v[180:183], v[228:231], v[116:119]
  global_load_lds_dwordx4 v246, s[54:55] offset:2048
  v_mfma_f32_16x16x32_bf16 v[132:135], v[180:183], v[232:235], v[132:135]
  s_add_u32 m0, s58, s60
  v_mfma_f32_16x16x32_bf16 v[148:151], v[180:183], v[236:239], v[148:151]
  s_waitcnt lgkmcnt(12)
  v_mfma_f32_16x16x32_bf16 v[40:43], v[152:155], v[184:187], v[40:43]
  s_waitcnt lgkmcnt(11)
  ds_read_b64_tr_b16 v[168:169], v251 offset:8192
  v_mfma_f32_16x16x32_bf16 v[56:59], v[152:155], v[188:191], v[56:59]
  s_waitcnt lgkmcnt(11)
  ds_read_b64_tr_b16 v[170:171], v251 offset:9216
  global_load_lds_dwordx4 v247, s[56:57] offset:0
  v_mfma_f32_16x16x32_bf16 v[72:75], v[152:155], v[192:195], v[72:75]
  s_waitcnt lgkmcnt(11)
  ds_read_b128 v[212:215], v254 offset:0
  v_mfma_f32_16x16x32_bf16 v[88:91], v[152:155], v[196:199], v[88:91]
  s_waitcnt lgkmcnt(11)
  ds_read_b128 v[216:219], v254 offset:2048
  v_mfma_f32_16x16x32_bf16 v[104:107], v[152:155], v[200:203], v[104:107]
  s_waitcnt lgkmcnt(11)
  ds_read_b128 v[220:223], v254 offset:4096
  v_mfma_f32_16x16x32_bf16 v[120:123], v[152:155], v[204:207], v[120:123]
  s_waitcnt lgkmcnt(11)
  ds_read_b128 v[224:227], v254 offset:6144
  global_load_lds_dwordx4 v248, s[56:57] offset:1024
  v_mfma_f32_16x16x32_bf16 v[136:139], v[152:155], v[208:211], v[136:139]
  s_waitcnt lgkmcnt(10)
  ds_read_b128 v[228:231], v254 offset:8192
  v_mfma_f32_16x16x32_bf16 v[44:47], v[156:159], v[184:187], v[44:47]
  ds_read_b128 v[232:235], v254 offset:10240
  v_mfma_f32_16x16x32_bf16 v[60:63], v[156:159], v[188:191], v[60:63]
  ds_read_b128 v[236:239], v254 offset:12288
  v_mfma_f32_16x16x32_bf16 v[76:79], v[156:159], v[192:195], v[76:79]
  ds_read_b64_tr_b16 v[172:173], v251 offset:8200
  global_load_lds_dwordx4 v249, s[56:57] offset:2048
  v_mfma_f32_16x16x32_bf16 v[92:95], v[156:159], v[196:199], v[92:95]
  ds_read_b64_tr_b16 v[174:175], v251 offset:9224
  v_mfma_f32_16x16x32_bf16 v[108:111], v[156:159], v[200:203], v[108:111]
  ds_read_b64_tr_b16 v[176:177], v252 offset:8192
  v_mfma_f32_16x16x32_bf16 v[124:127], v[156:159], v[204:207], v[124:127]
  ds_read_b64_tr_b16 v[178:179], v252 offset:9216
  v_mfma_f32_16x16x32_bf16 v[140:143], v[156:159], v[208:211], v[140:143]
  s_waitcnt lgkmcnt(15)
  ds_read_b64_tr_b16 v[180:181], v252 offset:8200
  global_load_lds_dwordx4 v250, s[56:57] offset:3072
  v_mfma_f32_16x16x32_bf16 v[48:51], v[160:163], v[184:187], v[48:51]
  ds_read_b64_tr_b16 v[182:183], v252 offset:9224
  v_mfma_f32_16x16x32_bf16 v[64:67], v[160:163], v[188:191], v[64:67]
  v_mfma_f32_16x16x32_bf16 v[80:83], v[160:163], v[192:195], v[80:83]
  s_add_u32 s58, s58, 45056
  s_cmp_ge_u32 s58, 163840
  s_cselect_b32 s20, 135168, 0
  v_mfma_f32_16x16x32_bf16 v[96:99], v[160:163], v[196:199], v[96:99]
  s_sub_u32 s58, s58, s20
  s_mov_b32 s21, s61
  v_mfma_f32_16x16x32_bf16 v[112:115], v[160:163], v[200:203], v[112:115]
  s_add_u32 s61, s61, 45056
  s_cmp_ge_u32 s61, 163840
  s_cselect_b32 s20, 135168, 0
  v_mfma_f32_16x16x32_bf16 v[128:131], v[160:163], v[204:207], v[128:131]
  s_sub_u32 s61, s61, s20
  s_sub_u32 s21, s61, s21
  v_mfma_f32_16x16x32_bf16 v[144:147], v[160:163], v[208:211], v[144:147]
  s_waitcnt lgkmcnt(15)
  v_add_u32 v251, s21, v251
  v_mfma_f32_16x16x32_bf16 v[52:55], v[164:167], v[184:187], v[52:55]
  v_add_u32 v252, s21, v252
  v_mfma_f32_16x16x32_bf16 v[68:71], v[164:167], v[188:191], v[68:71]
  v_add_u32 v253, s21, v253
  v_mfma_f32_16x16x32_bf16 v[84:87], v[164:167], v[192:195], v[84:87]
  v_add_u32 v254, s21, v254
  v_mfma_f32_16x16x32_bf16 v[100:103], v[164:167], v[196:199], v[100:103]
  v_mfma_f32_16x16x32_bf16 v[116:119], v[164:167], v[200:203], v[116:119]
  v_mfma_f32_16x16x32_bf16 v[132:135], v[164:167], v[204:207], v[132:135]
  v_mfma_f32_16x16x32_bf16 v[148:151], v[164:167], v[208:211], v[148:151]
  s_add_u32 s46, s46, 1
  s_and_b32 s46, s46, 7
  s_lshl_b32 s20, s46, 7
  s_add_u32 s54, s40, s20
  s_addc_u32 s55, s41, 0
  s_lshl_b32 s20, s46, 19
  s_add_u32 s56, s42, s20
  s_addc_u32 s57, s43, 0
  s_add_u32 s47, s47, 1
  s_cmp_lt_u32 s47, 5
  s_cbranch_scc1 L_p1loop
  s_waitcnt lgkmcnt(0) vmcnt(11)
  s_barrier
  s_add_u32 m0, s30, 0x4000
  v_mfma_f32_16x16x32_bf16 v[40:43], v[168:171], v[212:215], v[40:43]
  ds_read_b64_tr_b16 v[152:153], v251 offset:0
  v_accvgpr_write_b32 a30, 0
  v_mfma_f32_16x16x32_bf16 v[56:59], v[168:171], v[216:219], v[56:59]
  ds_read_b64_tr_b16 v[154:155], v251 offset:1024
  v_accvgpr_write_b32 a31, 0
  v_mfma_f32_16x16x32_bf16 v[72:75], v[168:171], v[220:223], v[72:75]
  ds_read_b128 v[184:187], v253 offset:0
  v_accvgpr_write_b32 a32, 0
  v_mfma_f32_16x16x32_bf16 v[88:91], v[168:171], v[224:227], v[88:91]
  ds_read_b128 v[188:191], v253 offset:2048
  v_accvgpr_write_b32 a33, 0
  v_mfma_f32_16x16x32_bf16 v[104:107], v[168:171], v[228:231], v[104:107]
  ds_read_b128 v[192:195], v253 offset:4096
  v_accvgpr_write_b32 a34, 0
  v_mfma_f32_16x16x32_bf16 v[120:123], v[168:171], v[232:235], v[120:123]
  ds_read_b128 v[196:199], v253 offset:6144
  v_accvgpr_write_b32 a35, 0
  v_mfma_f32_16x16x32_bf16 v[136:139], v[168:171], v[236:239], v[136:139]
  ds_read_b128 v[200:203], v253 offset:8192
  global_load_lds_dwordx4 v24, s[16:17] offset:0 nt
  v_mfma_f32_16x16x32_bf16 v[44:47], v[172:175], v[212:215], v[44:47]
  ds_read_b128 v[204:207], v253 offset:10240
  v_accvgpr_write_b32 a36, 0
  v_mfma_f32_16x16x32_bf16 v[60:63], v[172:175], v[216:219], v[60:63]
  ds_read_b128 v[208:211], v253 offset:12288
  v_accvgpr_write_b32 a37, 0
  v_mfma_f32_16x16x32_bf16 v[76:79], v[172:175], v[220:223], v[76:79]
  ds_read_b64_tr_b16 v[156:157], v251 offset:8
  v_accvgpr_write_b32 a38, 0
  v_mfma_f32_16x16x32_bf16 v[92:95], v[172:175], v[224:227], v[92:95]
  ds_read_b64_tr_b16 v[158:159], v251 offset:1032
  v_accvgpr_write_b32 a39, 0
  v_mfma_f32_16x16x32_bf16 v[108:111], v[172:175], v[228:231], v[108:111]
  ds_read_b64_tr_b16 v[160:161], v252 offset:0
  v_accvgpr_write_b32 a40, 0
  v_mfma_f32_16x16x32_bf16 v[124:127], v[172:175], v[232:235], v[124:127]
  ds_read_b64_tr_b16 v[162:163], v252 offset:1024
  global_load_lds_dwordx4 v25, s[16:17] offset:1024 nt
  v_mfma_f32_16x16x32_bf16 v[140:143], v[172:175], v[236:239], v[140:143]
  ds_read_b64_tr_b16 v[164:165], v252 offset:8
  v_accvgpr_write_b32 a41, 0
  v_mfma_f32_16x16x32_bf16 v[48:51], v[176:179], v[212:215], v[48:51]
  ds_read_b64_tr_b16 v[166:167], v252 offset:1032
  v_accvgpr_write_b32 a42, 0
  v_mfma_f32_16x16x32_bf16 v[64:67], v[176:179], v[216:219], v[64:67]
  v_accvgpr_write_b32 a43, 0
  v_accvgpr_write_b32 a44, 0
  v_mfma_f32_16x16x32_bf16 v[80:83], v[176:179], v[220:223], v[80:83]
  v_accvgpr_write_b32 a45, 0
  v_accvgpr_write_b32 a46, 0
  v_mfma_f32_16x16x32_bf16 v[96:99], v[176:179], v[224:227], v[96:99]
  v_accvgpr_write_b32 a47, 0
  v_accvgpr_write_b32 a48, 0
  v_mfma_f32_16x16x32_bf16 v[112:115], v[176:179], v[228:231], v[112:115]
  global_load_lds_dwordx4 v24, s[16:17] offset:2048 nt
  v_accvgpr_write_b32 a49, 0
  v_mfma_f32_16x16x32_bf16 v[128:131], v[176:179], v[232:235], v[128:131]
  v_accvgpr_write_b32 a50, 0
  v_accvgpr_write_b32 a51, 0
  v_mfma_f32_16x16x32_bf16 v[144:147], v[176:179], v[236:239], v[144:147]
  v_accvgpr_write_b32 a52, 0
  v_accvgpr_write_b32 a53, 0
  v_mfma_f32_16x16x32_bf16 v[52:55], v[180:183], v[212:215], v[52:55]
  v_accvgpr_write_b32 a54, 0
  v_accvgpr_write_b32 a55, 0
  v_mfma_f32_16x16x32_bf16 v[68:71], v[180:183], v[216:219], v[68:71]
  v_accvgpr_write_b32 a56, 0
  v_accvgpr_write_b32 a57, 0
  v_mfma_f32_16x16x32_bf16 v[84:87], v[180:183], v[220:223], v[84:87]
  v_accvgpr_write_b32 a58, 0
  v_accvgpr_write_b32 a59, 0
  v_mfma_f32_16x16x32_bf16 v[100:103], v[180:183], v[224:227], v[100:103]
  global_load_lds_dwordx4 v25, s[16:17] offset:3072 nt
  v_accvgpr_write_b32 a60, 0
  v_mfma_f32_16x16x32_bf16 v[116:119], v[180:183], v[228:231], v[116:119]
  v_accvgpr_write_b32 a61, 0
  v_accvgpr_write_b32 a62, 0
  s_add_u32 s28, s28, 0x8000
  s_and_b32 s28, s28, 0x1ffff
  v_mfma_f32_16x16x32_bf16 v[132:135], v[180:183], v[232:235], v[132:135]
  v_accvgpr_write_b32 a63, 0
  v_accvgpr_write_b32 a64, 0
  s_add_u32 s30, s28, s29
  s_mov_b32 m0, s30
  v_mfma_f32_16x16x32_bf16 v[148:151], v[180:183], v[236:239], v[148:151]
  s_waitcnt lgkmcnt(12)
  v_accvgpr_write_b32 a65, 0
  v_accvgpr_write_b32 a66, 0
  s_add_u32 s24, s24, 0x4000
  s_and_b32 s24, s24, 0x3ffff
  v_mfma_f32_16x16x32_bf16 v[40:43], v[152:155], v[184:187], v[40:43]
  s_waitcnt lgkmcnt(11)
  ds_read_b64_tr_b16 v[168:169], v251 offset:8192
  v_accvgpr_write_b32 a67, 0
  s_add_u32 s12, s50, s24
  s_addc_u32 s13, s51, 0
  v_mfma_f32_16x16x32_bf16 v[56:59], v[152:155], v[188:191], v[56:59]
  s_waitcnt lgkmcnt(11)
  ds_read_b64_tr_b16 v[170:171], v251 offset:9216
  v_accvgpr_write_b32 a68, 0
  s_add_u32 s16, s52, s24
  s_addc_u32 s17, s53, 0
  v_mfma_f32_16x16x32_bf16 v[72:75], v[152:155], v[192:195], v[72:75]
  s_waitcnt lgkmcnt(11)
  ds_read_b128 v[212:215], v254 offset:0
  v_accvgpr_write_b32 a69, 0
  v_mfma_f32_16x16x32_bf16 v[88:91], v[152:155], v[196:199], v[88:91]
  s_waitcnt lgkmcnt(11)
  ds_read_b128 v[216:219], v254 offset:2048
  v_accvgpr_write_b32 a70, 0
  v_mfma_f32_16x16x32_bf16 v[104:107], v[152:155], v[200:203], v[104:107]
  s_waitcnt lgkmcnt(11)
  ds_read_b128 v[220:223], v254 offset:4096
  v_accvgpr_write_b32 a71, 0
  v_mfma_f32_16x16x32_bf16 v[120:123], v[152:155], v[204:207], v[120:123]
  s_waitcnt lgkmcnt(11)
  ds_read_b128 v[224:227], v254 offset:6144
  v_accvgpr_write_b32 a72, 0
  v_mfma_f32_16x16x32_bf16 v[136:139], v[152:155], v[208:211], v[136:139]
  s_waitcnt lgkmcnt(10)
  ds_read_b128 v[228:231], v254 offset:8192
  v_accvgpr_write_b32 a73, 0
  v_mfma_f32_16x16x32_bf16 v[44:47], v[156:159], v[184:187], v[44:47]
  ds_read_b128 v[232:235], v254 offset:10240
  v_accvgpr_write_b32 a74, 0
  v_mfma_f32_16x16x32_bf16 v[60:63], v[156:159], v[188:191], v[60:63]
  ds_read_b128 v[236:239], v254 offset:12288
  v_accvgpr_write_b32 a75, 0
  v_mfma_f32_16x16x32_bf16 v[76:79], v[156:159], v[192:195], v[76:79]
  ds_read_b64_tr_b16 v[172:173], v251 offset:8200
  v_accvgpr_write_b32 a76, 0
  v_mfma_f32_16x16x32_bf16 v[92:95], v[156:159], v[196:199], v[92:95]
  ds_read_b64_tr_b16 v[174:175], v251 offset:9224
  v_accvgpr_write_b32 a77, 0
  v_mfma_f32_16x16x32_bf16 v[108:111], v[156:159], v[200:203], v[108:111]
  ds_read_b64_tr_b16 v[176:177], v252 offset:8192
  v_accvgpr_write_b32 a78, 0
  v_mfma_f32_16x16x32_bf16 v[124:127], v[156:159], v[204:207], v[124:127]
  ds_read_b64_tr_b16 v[178:179], v252 offset:9216
  v_accvgpr_write_b32 a79, 0
  v_mfma_f32_16x16x32_bf16 v[140:143], v[156:159], v[208:211], v[140:143]
  s_waitcnt lgkmcnt(15)
  ds_read_b64_tr_b16 v[180:181], v252 offset:8200
  v_accvgpr_write_b32 a80, 0
  v_mfma_f32_16x16x32_bf16 v[48:51], v[160:163], v[184:187], v[48:51]
  ds_read_b64_tr_b16 v[182:183], v252 offset:9224
  v_accvgpr_write_b32 a81, 0
  v_mfma_f32_16x16x32_bf16 v[64:67], v[160:163], v[188:191], v[64:67]
  v_accvgpr_write_b32 a82, 0
  v_accvgpr_write_b32 a83, 0
  v_mfma_f32_16x16x32_bf16 v[80:83], v[160:163], v[192:195], v[80:83]
  v_accvgpr_write_b32 a84, 0
  v_accvgpr_write_b32 a85, 0
  v_mfma_f32_16x16x32_bf16 v[96:99], v[160:163], v[196:199], v[96:99]
  v_accvgpr_write_b32 a86, 0
  v_accvgpr_write_b32 a87, 0
  v_mfma_f32_16x16x32_bf16 v[112:115], v[160:163], v[200:203], v[112:115]
  v_accvgpr_write_b32 a88, 0
  v_accvgpr_write_b32 a89, 0
  s_mov_b32 s21, s61
  s_add_u32 s61, s61, 45056
  v_mfma_f32_16x16x32_bf16 v[128:131], v[160:163], v[204:207], v[128:131]
  v_accvgpr_write_b32 a90, 0
  v_accvgpr_write_b32 a91, 0
  s_cmp_ge_u32 s61, 163840
  s_cselect_b32 s20, 135168, 0
  v_mfma_f32_16x16x32_bf16 v[144:147], v[160:163], v[208:211], v[144:147]
  s_waitcnt lgkmcnt(15)
  v_accvgpr_write_b32 a92, 0
  v_accvgpr_write_b32 a93, 0
  s_sub_u32 s61, s61, s20
  s_sub_u32 s21, s61, s21
  v_mfma_f32_16x16x32_bf16 v[52:55], v[164:167], v[184:187], v[52:55]
  v_add_u32 v251, s21, v251
  v_accvgpr_write_b32 a94, 0
  v_accvgpr_write_b32 a95, 0
  v_mfma_f32_16x16x32_bf16 v[68:71], v[164:167], v[188:191], v[68:71]
  v_add_u32 v252, s21, v252
  v_accvgpr_write_b32 a96, 0
  v_accvgpr_write_b32 a97, 0
  v_mfma_f32_16x16x32_bf16 v[84:87], v[164:167], v[192:195], v[84:87]
  v_add_u32 v253, s21, v253
  v_accvgpr_write_b32 a98, 0
  v_accvgpr_write_b32 a99, 0
  v_mfma_f32_16x16x32_bf16 v[100:103], v[164:167], v[196:199], v[100:103]
  v_add_u32 v254, s21, v254
  v_accvgpr_write_b32 a100, 0
  v_accvgpr_write_b32 a101, 0
  v_mfma_f32_16x16x32_bf16 v[116:119], v[164:167], v[200:203], v[116:119]
  v_accvgpr_write_b32 a102, 0
  v_accvgpr_write_b32 a103, 0
  v_mfma_f32_16x16x32_bf16 v[132:135], v[164:167], v[204:207], v[132:135]
  v_accvgpr_write_b32 a104, 0
  v_accvgpr_write_b32 a105, 0
  v_mfma_f32_16x16x32_bf16 v[148:151], v[164:167], v[208:211], v[148:151]
  v_accvgpr_write_b32 a106, 0
  v_accvgpr_write_b32 a107, 0
  s_waitcnt lgkmcnt(0) vmcnt(4)
  s_barrier
  v_mfma_f32_16x16x32_bf16 v[40:43], v[168:171], v[212:215], v[40:43]
  ds_read_b64_tr_b16 v[152:153], v251 offset:0
  v_accvgpr_write_b32 a108, 0
  v_mfma_f32_16x16x32_bf16 v[56:59], v[168:171], v[216:219], v[56:59]
  ds_read_b64_tr_b16 v[154:155], v251 offset:1024
  v_accvgpr_write_b32 a109, 0
  v_mfma_f32_16x16x32_bf16 v[72:75], v[168:171], v[220:223], v[72:75]
  ds_read_b128 v[184:187], v253 offset:0
  v_accvgpr_write_b32 a110, 0
  v_mfma_f32_16x16x32_bf16 v[88:91], v[168:171], v[224:227], v[88:91]
  ds_read_b128 v[188:191], v253 offset:2048
  v_accvgpr_write_b32 a111, 0
  v_mfma_f32_16x16x32_bf16 v[104:107], v[168:171], v[228:231], v[104:107]
  ds_read_b128 v[192:195], v253 offset:4096
  global_load_lds_dwordx4 v20, s[12:13] offset:0 nt
  v_mfma_f32_16x16x32_bf16 v[120:123], v[168:171], v[232:235], v[120:123]
  ds_read_b128 v[196:199], v253 offset:6144
  v_accvgpr_write_b32 a112, 0
  v_mfma_f32_16x16x32_bf16 v[136:139], v[168:171], v[236:239], v[136:139]
  ds_read_b128 v[200:203], v253 offset:8192
  v_accvgpr_write_b32 a113, 0
  v_mfma_f32_16x16x32_bf16 v[44:47], v[172:175], v[212:215], v[44:47]
  ds_read_b128 v[204:207], v253 offset:10240
  v_accvgpr_write_b32 a114, 0
  v_mfma_f32_16x16x32_bf16 v[60:63], v[172:175], v[216:219], v[60:63]
  ds_read_b128 v[208:211], v253 offset:12288
  v_accvgpr_write_b32 a115, 0
  v_mfma_f32_16x16x32_bf16 v[76:79], v[172:175], v[220:223], v[76:79]
  ds_read_b64_tr_b16 v[156:157], v251 offset:8
  v_accvgpr_write_b32 a116, 0
  v_mfma_f32_16x16x32_bf16 v[92:95], v[172:175], v[224:227], v[92:95]
  ds_read_b64_tr_b16 v[158:159], v251 offset:1032
  global_load_lds_dwordx4 v21, s[12:13] offset:1024 nt
  v_mfma_f32_16x16x32_bf16 v[108:111], v[172:175], v[228:231], v[108:111]
  ds_read_b64_tr_b16 v[160:161], v252 offset:0
  v_accvgpr_write_b32 a117, 0
  v_mfma_f32_16x16x32_bf16 v[124:127], v[172:175], v[232:235], v[124:127]
  ds_read_b64_tr_b16 v[162:163], v252 offset:1024
  v_accvgpr_write_b32 a118, 0
  v_mfma_f32_16x16x32_bf16 v[140:143], v[172:175], v[236:239], v[140:143]
  ds_read_b64_tr_b16 v[164:165], v252 offset:8
  v_accvgpr_write_b32 a119, 0
  v_mfma_f32_16x16x32_bf16 v[48:51], v[176:179], v[212:215], v[48:51]
  ds_read_b64_tr_b16 v[166:167], v252 offset:1032
  v_accvgpr_write_b32 a120, 0
  v_mfma_f32_16x16x32_bf16 v[64:67], v[176:179], v[216:219], v[64:67]
  v_accvgpr_write_b32 a121, 0
  v_accvgpr_write_b32 a122, 0
  v_mfma_f32_16x16x32_bf16 v[80:83], v[176:179], v[220:223], v[80:83]
  global_load_lds_dwordx4 v22, s[12:13] offset:2048 nt
  v_accvgpr_write_b32 a123, 0
  v_mfma_f32_16x16x32_bf16 v[96:99], v[176:179], v[224:227], v[96:99]
  v_accvgpr_write_b32 a124, 0
  v_accvgpr_write_b32 a125, 0
  v_mfma_f32_16x16x32_bf16 v[112:115], v[176:179], v[228:231], v[112:115]
  v_accvgpr_write_b32 a126, 0
  v_accvgpr_write_b32 a127, 0
  v_mfma_f32_16x16x32_bf16 v[128:131], v[176:179], v[232:235], v[128:131]
  v_accvgpr_write_b32 a128, 0
  v_accvgpr_write_b32 a129, 0
  v_mfma_f32_16x16x32_bf16 v[144:147], v[176:179], v[236:239], v[144:147]
  v_accvgpr_write_b32 a130, 0
  v_accvgpr_write_b32 a131, 0
  v_mfma_f32_16x16x32_bf16 v[52:55], v[180:183], v[212:215], v[52:55]
  v_accvgpr_write_b32 a132, 0
  v_accvgpr_write_b32 a133, 0
  v_mfma_f32_16x16x32_bf16 v[68:71], v[180:183], v[216:219], v[68:71]
  global_load_lds_dwordx4 v23, s[12:13] offset:3072 nt
  v_accvgpr_write_b32 a134, 0
  v_mfma_f32_16x16x32_bf16 v[84:87], v[180:183], v[220:223], v[84:87]
  v_accvgpr_write_b32 a135, 0
  v_accvgpr_write_b32 a136, 0
  s_add_u32 m0, s30, 0x4000
  v_mfma_f32_16x16x32_bf16 v[100:103], v[180:183], v[224:227], v[100:103]
  v_accvgpr_write_b32 a137, 0
  v_accvgpr_write_b32 a138, 0
  v_mfma_f32_16x16x32_bf16 v[116:119], v[180:183], v[228:231], v[116:119]
  v_accvgpr_write_b32 a139, 0
  v_accvgpr_write_b32 a140, 0
  v_mfma_f32_16x16x32_bf16 v[132:135], v[180:183], v[232:235], v[132:135]
  v_accvgpr_write_b32 a141, 0
  v_accvgpr_write_b32 a142, 0
  v_mfma_f32_16x16x32_bf16 v[148:151], v[180:183], v[236:239], v[148:151]
  s_waitcnt lgkmcnt(12)
  v_accvgpr_write_b32 a143, 0
  v_accvgpr_write_b32 a144, 0
  v_mfma_f32_16x16x32_bf16 v[40:43], v[152:155], v[184:187], v[40:43]
  s_waitcnt lgkmcnt(11)
  ds_read_b64_tr_b16 v[168:169], v251 offset:8192
  global_load_lds_dwordx4 v24, s[16:17] offset:0 nt
  v_mfma_f32_16x16x32_bf16 v[56:59], v[152:155], v[188:191], v[56:59]
  s_waitcnt lgkmcnt(11)
  ds_read_b64_tr_b16 v[170:171], v251 offset:9216
  v_accvgpr_write_b32 a145, 0
  v_mfma_f32_16x16x32_bf16 v[72:75], v[152:155], v[192:195], v[72:75]
  s_waitcnt lgkmcnt(11)
  ds_read_b128 v[212:215], v254 offset:0
  v_accvgpr_write_b32 a146, 0
  v_mfma_f32_16x16x32_bf16 v[88:91], v[152:155], v[196:199], v[88:91]
  s_waitcnt lgkmcnt(11)
  ds_read_b128 v[216:219], v254 offset:2048
  v_accvgpr_write_b32 a147, 0
  v_mfma_f32_16x16x32_bf16 v[104:107], v[152:155], v[200:203], v[104:107]
  s_waitcnt lgkmcnt(11)
  ds_read_b128 v[220:223], v254 offset:4096
  v_accvgpr_write_b32 a148, 0
  v_mfma_f32_16x16x32_bf16 v[120:123], v[152:155], v[204:207], v[120:123]
  s_waitcnt lgkmcnt(11)
  ds_read_b128 v[224:227], v254 offset:6144
  v_accvgpr_write_b32 a149, 0
  v_mfma_f32_16x16x32_bf16 v[136:139], v[152:155], v[208:211], v[136:139]
  s_waitcnt lgkmcnt(10)
  ds_read_b128 v[228:231], v254 offset:8192
  global_load_lds_dwordx4 v25, s[16:17] offset:1024 nt
  v_mfma_f32_16x16x32_bf16 v[44:47], v[156:159], v[184:187], v[44:47]
  ds_read_b128 v[232:235], v254 offset:10240
  v_accvgpr_write_b32 a150, 0
  v_mfma_f32_16x16x32_bf16 v[60:63], v[156:159], v[188:191], v[60:63]
  ds_read_b128 v[236:239], v254 offset:12288
  v_accvgpr_write_b32 a151, 0
  v_mfma_f32_16x16x32_bf16 v[76:79], v[156:159], v[192:195], v[76:79]
  ds_read_b64_tr_b16 v[172:173], v251 offset:8200
  v_accvgpr_write_b32 a152, 0
  v_mfma_f32_16x16x32_bf16 v[92:95], v[156:159], v[196:199], v[92:95]
  ds_read_b64_tr_b16 v[174:175], v251 offset:9224
  v_accvgpr_write_b32 a153, 0
  v_mfma_f32_16x16x32_bf16 v[108:111], v[156:159], v[200:203], v[108:111]
  ds_read_b64_tr_b16 v[176:177], v252 offset:8192
  v_accvgpr_write_b32 a154, 0
  v_mfma_f32_16x16x32_bf16 v[124:127], v[156:159], v[204:207], v[124:127]
  ds_read_b64_tr_b16 v[178:179], v252 offset:9216
  global_load_lds_dwordx4 v24, s[16:17] offset:2048 nt
  v_mfma_f32_16x16x32_bf16 v[140:143], v[156:159], v[208:211], v[140:143]
  s_waitcnt lgkmcnt(15)
  ds_read_b64_tr_b16 v[180:181], v252 offset:8200
  v_accvgpr_write_b32 a155, 0
  v_mfma_f32_16x16x32_bf16 v[48:51], v[160:163], v[184:187], v[48:51]
  ds_read_b64_tr_b16 v[182:183], v252 offset:9224
  v_accvgpr_write_b32 a156, 0
  v_mfma_f32_16x16x32_bf16 v[64:67], v[160:163], v[188:191], v[64:67]
  v_accvgpr_write_b32 a157, 0
  v_accvgpr_write_b32 a158, 0
  v_mfma_f32_16x16x32_bf16 v[80:83], v[160:163], v[192:195], v[80:83]
  v_accvgpr_write_b32 a159, 0
  v_accvgpr_write_b32 a160, 0
  v_mfma_f32_16x16x32_bf16 v[96:99], v[160:163], v[196:199], v[96:99]
  v_accvgpr_write_b32 a161, 0
  v_accvgpr_write_b32 a162, 0
  v_mfma_f32_16x16x32_bf16 v[112:115], v[160:163], v[200:203], v[112:115]
  global_load_lds_dwordx4 v25, s[16:17] offset:3072 nt
  v_accvgpr_write_b32 a163, 0
  v_mfma_f32_16x16x32_bf16 v[128:131], v[160:163], v[204:207], v[128:131]
  v_accvgpr_write_b32 a164, 0
  v_accvgpr_write_b32 a165, 0
  s_add_u32 s28, s28, 0x8000
  s_and_b32 s28, s28, 0x1ffff
  v_mfma_f32_16x16x32_bf16 v[144:147], v[160:163], v[208:211], v[144:147]
  s_waitcnt lgkmcnt(15)
  v_accvgpr_write_b32 a166, 0
  v_accvgpr_write_b32 a167, 0
  s_add_u32 s30, s28, s29
  s_mov_b32 m0, s30
  v_mfma_f32_16x16x32_bf16 v[52:55], v[164:167], v[184:187], v[52:55]
  v_accvgpr_write_b32 a168, 0
  v_accvgpr_write_b32 a169, 0
  s_add_u32 s24, s24, 0x4000
  s_and_b32 s24, s24, 0x3ffff
  v_mfma_f32_16x16x32_bf16 v[68:71], v[164:167], v[188:191], v[68:71]
  v_accvgpr_write_b32 a170, 0
  v_accvgpr_write_b32 a171, 0
  s_add_u32 s12, s50, s24
  s_addc_u32 s13, s51, 0
  v_mfma_f32_16x16x32_bf16 v[84:87], v[164:167], v[192:195], v[84:87]
  v_accvgpr_write_b32 a172, 0
  v_accvgpr_write_b32 a173, 0
  s_add_u32 s16, s52, s24
  s_addc_u32 s17, s53, 0
  v_mfma_f32_16x16x32_bf16 v[100:103], v[164:167], v[196:199], v[100:103]
  v_accvgpr_write_b32 a174, 0
  v_accvgpr_write_b32 a175, 0
  v_mfma_f32_16x16x32_bf16 v[116:119], v[164:167], v[200:203], v[116:119]
  v_accvgpr_write_b32 a176, 0
  v_accvgpr_write_b32 a177, 0
  v_mfma_f32_16x16x32_bf16 v[132:135], v[164:167], v[204:207], v[132:135]
  v_accvgpr_write_b32 a178, 0
  v_accvgpr_write_b32 a179, 0
  v_mfma_f32_16x16x32_bf16 v[148:151], v[164:167], v[208:211], v[148:151]
  v_accvgpr_write_b32 a180, 0
  v_accvgpr_write_b32 a181, 0
  s_waitcnt lgkmcnt(0)
  s_barrier
  v_mfma_f32_16x16x32_bf16 v[40:43], v[168:171], v[212:215], v[40:43]
  v_accvgpr_write_b32 a182, 0
  v_accvgpr_write_b32 a183, 0
  v_mfma_f32_16x16x32_bf16 v[56:59], v[168:171], v[216:219], v[56:59]
  v_accvgpr_write_b32 a184, 0
  v_accvgpr_write_b32 a185, 0
  v_mfma_f32_16x16x32_bf16 v[72:75], v[168:171], v[220:223], v[72:75]
  v_accvgpr_write_b32 a186, 0
  v_accvgpr_write_b32 a187, 0
  v_mfma_f32_16x16x32_bf16 v[88:91], v[168:171], v[224:227], v[88:91]
  v_accvgpr_write_b32 a188, 0
  v_accvgpr_write_b32 a189, 0
  v_mfma_f32_16x16x32_bf16 v[104:107], v[168:171], v[228:231], v[104:107]
  v_accvgpr_write_b32 a190, 0
  v_accvgpr_write_b32 a191, 0
  v_mfma_f32_16x16x32_bf16 v[120:123], v[168:171], v[232:235], v[120:123]
  v_accvgpr_write_b32 a192, 0
  v_accvgpr_write_b32 a193, 0
  v_mfma_f32_16x16x32_bf16 v[136:139], v[168:171], v[236:239], v[136:139]
  v_accvgpr_write_b32 a194, 0
  v_accvgpr_write_b32 a195, 0
  v_mfma_f32_16x16x32_bf16 v[44:47], v[172:175], v[212:215], v[44:47]
  v_accvgpr_write_b32 a196, 0
  v_accvgpr_write_b32 a197, 0
  v_mfma_f32_16x16x32_bf16 v[60:63], v[172:175], v[216:219], v[60:63]
  v_accvgpr_write_b32 a198, 0
  v_accvgpr_write_b32 a199, 0
  v_mfma_f32_16x16x32_bf16 v[76:79], v[172:175], v[220:223], v[76:79]
  v_accvgpr_write_b32 a200, 0
  v_accvgpr_write_b32 a201, 0
  v_mfma_f32_16x16x32_bf16 v[92:95], v[172:175], v[224:227], v[92:95]
  v_accvgpr_write_b32 a202, 0
  v_accvgpr_write_b32 a203, 0
  v_mfma_f32_16x16x32_bf16 v[108:111], v[172:175], v[228:231], v[108:111]
  v_accvgpr_write_b32 a204, 0
  v_accvgpr_write_b32 a205, 0
  v_mfma_f32_16x16x32_bf16 v[124:127], v[172:175], v[232:235], v[124:127]
  v_accvgpr_write_b32 a206, 0
  v_accvgpr_write_b32 a207, 0
  v_mfma_f32_16x16x32_bf16 v[140:143], v[172:175], v[236:239], v[140:143]
  v_accvgpr_write_b32 a208, 0
  v_accvgpr_write_b32 a209, 0
  v_mfma_f32_16x16x32_bf16 v[48:51], v[176:179], v[212:215], v[48:51]
  v_accvgpr_write_b32 a210, 0
  v_accvgpr_write_b32 a211, 0
  v_mfma_f32_16x16x32_bf16 v[64:67], v[176:179], v[216:219], v[64:67]
  v_accvgpr_write_b32 a212, 0
  v_accvgpr_write_b32 a213, 0
  v_mfma_f32_16x16x32_bf16 v[80:83], v[176:179], v[220:223], v[80:83]
  v_accvgpr_write_b32 a214, 0
  v_accvgpr_write_b32 a215, 0
  v_mfma_f32_16x16x32_bf16 v[96:99], v[176:179], v[224:227], v[96:99]
  v_accvgpr_write_b32 a216, 0
  v_accvgpr_write_b32 a217, 0
  v_mfma_f32_16x16x32_bf16 v[112:115], v[176:179], v[228:231], v[112:115]
  v_accvgpr_write_b32 a218, 0
  v_accvgpr_write_b32 a219, 0
  v_mfma_f32_16x16x32_bf16 v[128:131], v[176:179], v[232:235], v[128:131]
  v_accvgpr_write_b32 a220, 0
  v_accvgpr_write_b32 a221, 0
  v_mfma_f32_16x16x32_bf16 v[144:147], v[176:179], v[236:239], v[144:147]
  v_accvgpr_write_b32 a222, 0
  v_accvgpr_write_b32 a223, 0
  v_mfma_f32_16x16x32_bf16 v[52:55], v[180:183], v[212:215], v[52:55]
  v_mfma_f32_16x16x32_bf16 v[68:71], v[180:183], v[216:219], v[68:71]
  v_mfma_f32_16x16x32_bf16 v[84:87], v[180:183], v[220:223], v[84:87]
  v_mfma_f32_16x16x32_bf16 v[100:103], v[180:183], v[224:227], v[100:103]
  v_mfma_f32_16x16x32_bf16 v[116:119], v[180:183], v[228:231], v[116:119]
  v_mfma_f32_16x16x32_bf16 v[132:135], v[180:183], v[232:235], v[132:135]
  v_mfma_f32_16x16x32_bf16 v[148:151], v[180:183], v[236:239], v[148:151]
  s_mov_b32 s36, 0x3e0293ee
  s_mov_b32 s37, 0x3e0293ee
  v_lshlrev_b32 v5, 4, v2
  s_mul_i32 s20, s3, 14336
  s_add_u32 s20, s20, 98304
  v_add_u32 v6, s20, v5
  s_xor_b32 s21, s3, 1
  s_mul_i32 s21, s21, 14336
  s_add_u32 s21, s21, 98304
  v_add_u32 v7, s21, v5
  s_nop 2
  v_pk_mul_f32 v[136:137], v[136:137], s[36:37]
  v_pk_mul_f32 v[138:139], v[138:139], s[36:37]
  v_pk_mul_f32 v[140:141], v[140:141], s[36:37]
  v_pk_mul_f32 v[142:143], v[142:143], s[36:37]
  v_pk_mul_f32 v[144:145], v[144:145], s[36:37]
  v_pk_mul_f32 v[146:147], v[146:147], s[36:37]
  v_pk_mul_f32 v[148:149], v[148:149], s[36:37]
  v_pk_mul_f32 v[150:151], v[150:151], s[36:37]
  v_cvt_pk_bf16_f32 v224, v136, v137
  v_cvt_pk_bf16_f32 v225, v138, v139
  v_cvt_pk_bf16_f32 v226, v140, v141
  v_cvt_pk_bf16_f32 v227, v142, v143
  v_cvt_pk_bf16_f32 v228, v144, v145
  v_cvt_pk_bf16_f32 v229, v146, v147
  v_cvt_pk_bf16_f32 v230, v148, v149
  v_cvt_pk_bf16_f32 v231, v150, v151
  ds_write_b128 v6, v[224:227] offset:12288
  ds_write_b128 v6, v[228:231] offset:13312
  v_pk_mul_f32 v[120:121], v[120:121], s[36:37]
  v_pk_mul_f32 v[122:123], v[122:123], s[36:37]
  v_pk_mul_f32 v[124:125], v[124:125], s[36:37]
  v_pk_mul_f32 v[126:127], v[126:127], s[36:37]
  v_pk_mul_f32 v[128:129], v[128:129], s[36:37]
  v_pk_mul_f32 v[130:131], v[130:131], s[36:37]
  v_pk_mul_f32 v[132:133], v[132:133], s[36:37]
  v_pk_mul_f32 v[134:135], v[134:135], s[36:37]
  v_cvt_pk_bf16_f32 v208, v120, v121
  v_cvt_pk_bf16_f32 v209, v122, v123
  v_cvt_pk_bf16_f32 v210, v124, v125
  v_cvt_pk_bf16_f32 v211, v126, v127
  v_cvt_pk_bf16_f32 v212, v128, v129
  v_cvt_pk_bf16_f32 v213, v130, v131
  v_cvt_pk_bf16_f32 v214, v132, v133
  v_cvt_pk_bf16_f32 v215, v134, v135
  ds_write_b128 v6, v[208:211] offset:10240
  ds_write_b128 v6, v[212:215] offset:11264
  global_load_lds_dwordx4 v20, s[12:13] offset:0 nt
  global_load_lds_dwordx4 v21, s[12:13] offset:1024 nt
  global_load_lds_dwordx4 v22, s[12:13] offset:2048 nt
  global_load_lds_dwordx4 v23, s[12:13] offset:3072 nt
  s_add_u32 m0, s30, 0x4000
  s_nop 0
  v_pk_mul_f32 v[104:105], v[104:105], s[36:37]
  v_pk_mul_f32 v[106:107], v[106:107], s[36:37]
  v_pk_mul_f32 v[108:109], v[108:109], s[36:37]
  v_pk_mul_f32 v[110:111], v[110:111], s[36:37]
  v_pk_mul_f32 v[112:113], v[112:113], s[36:37]
  v_pk_mul_f32 v[114:115], v[114:115], s[36:37]
  v_pk_mul_f32 v[116:117], v[116:117], s[36:37]
  v_pk_mul_f32 v[118:119], v[118:119], s[36:37]
  v_cvt_pk_bf16_f32 v192, v104, v105
  v_cvt_pk_bf16_f32 v193, v106, v107
  v_cvt_pk_bf16_f32 v194, v108, v109
  v_cvt_pk_bf16_f32 v195, v110, v111
  v_cvt_pk_bf16_f32 v196, v112, v113
  v_cvt_pk_bf16_f32 v197, v114, v115
  v_cvt_pk_bf16_f32 v198, v116, v117
  v_cvt_pk_bf16_f32 v199, v118, v119
  ds_write_b128 v6, v[192:195] offset:8192
  ds_write_b128 v6, v[196:199] offset:9216
  v_pk_mul_f32 v[88:89], v[88:89], s[36:37]
  v_pk_mul_f32 v[90:91], v[90:91], s[36:37]
  v_pk_mul_f32 v[92:93], v[92:93], s[36:37]
  v_pk_mul_f32 v[94:95], v[94:95], s[36:37]
  v_pk_mul_f32 v[96:97], v[96:97], s[36:37]
  v_pk_mul_f32 v[98:99], v[98:99], s[36:37]
  v_pk_mul_f32 v[100:101], v[100:101], s[36:37]
  v_pk_mul_f32 v[102:103], v[102:103], s[36:37]
  v_cvt_pk_bf16_f32 v176, v88, v89
  v_cvt_pk_bf16_f32 v177, v90, v91
  v_cvt_pk_bf16_f32 v178, v92, v93
  v_cvt_pk_bf16_f32 v179, v94, v95
  v_cvt_pk_bf16_f32 v180, v96, v97
  v_cvt_pk_bf16_f32 v181, v98, v99
  v_cvt_pk_bf16_f32 v182, v100, v101
  v_cvt_pk_bf16_f32 v183, v102, v103
  ds_write_b128 v6, v[176:179] offset:6144
  ds_write_b128 v6, v[180:183] offset:7168
  global_load_lds_dwordx4 v24, s[16:17] offset:0 nt
  global_load_lds_dwordx4 v25, s[16:17] offset:1024 nt
  global_load_lds_dwordx4 v24, s[16:17] offset:2048 nt
  global_load_lds_dwordx4 v25, s[16:17] offset:3072 nt
  s_add_u32 s28, s28, 0x8000
  s_and_b32 s28, s28, 0x1ffff
  s_add_u32 s30, s28, s29
  s_mov_b32 m0, s30
  s_add_u32 s24, s24, 0x4000
  s_and_b32 s24, s24, 0x3ffff
  s_add_u32 s12, s50, s24
  s_addc_u32 s13, s51, 0
  s_add_u32 s16, s52, s24
  s_addc_u32 s17, s53, 0
  v_pk_mul_f32 v[72:73], v[72:73], s[36:37]
  v_pk_mul_f32 v[74:75], v[74:75], s[36:37]
  v_pk_mul_f32 v[76:77], v[76:77], s[36:37]
  v_pk_mul_f32 v[78:79], v[78:79], s[36:37]
  v_pk_mul_f32 v[80:81], v[80:81], s[36:37]
  v_pk_mul_f32 v[82:83], v[82:83], s[36:37]
  v_pk_mul_f32 v[84:85], v[84:85], s[36:37]
  v_pk_mul_f32 v[86:87], v[86:87], s[36:37]
  v_cvt_pk_bf16_f32 v160, v72, v73
  v_cvt_pk_bf16_f32 v161, v74, v75
  v_cvt_pk_bf16_f32 v162, v76, v77
  v_cvt_pk_bf16_f32 v163, v78, v79
  v_cvt_pk_bf16_f32 v164, v80, v81
  v_cvt_pk_bf16_f32 v165, v82, v83
  v_cvt_pk_bf16_f32 v166, v84, v85
  v_cvt_pk_bf16_f32 v167, v86, v87
  ds_write_b128 v6, v[160:163] offset:4096
  ds_write_b128 v6, v[164:167] offset:5120
  v_pk_mul_f32 v[56:57], v[56:57], s[36:37]
  v_pk_mul_f32 v[58:59], v[58:59], s[36:37]
  v_pk_mul_f32 v[60:61], v[60:61], s[36:37]
  v_pk_mul_f32 v[62:63], v[62:63], s[36:37]
  v_pk_mul_f32 v[64:65], v[64:65], s[36:37]
  v_pk_mul_f32 v[66:67], v[66:67], s[36:37]
  v_pk_mul_f32 v[68:69], v[68:69], s[36:37]
  v_pk_mul_f32 v[70:71], v[70:71], s[36:37]
  v_cvt_pk_bf16_f32 v144, v56, v57
  v_cvt_pk_bf16_f32 v145, v58, v59
  v_cvt_pk_bf16_f32 v146, v60, v61
  v_cvt_pk_bf16_f32 v147, v62, v63
  v_cvt_pk_bf16_f32 v148, v64, v65
  v_cvt_pk_bf16_f32 v149, v66, v67
  v_cvt_pk_bf16_f32 v150, v68, v69
  v_cvt_pk_bf16_f32 v151, v70, v71
  ds_write_b128 v6, v[144:147] offset:2048
  ds_write_b128 v6, v[148:151] offset:3072
  v_pk_mul_f32 v[40:41], v[40:41], s[36:37]
  v_pk_mul_f32 v[42:43], v[42:43], s[36:37]
  v_pk_mul_f32 v[44:45], v[44:45], s[36:37]
  v_pk_mul_f32 v[46:47], v[46:47], s[36:37]
  v_pk_mul_f32 v[48:49], v[48:49], s[36:37]
  v_pk_mul_f32 v[50:51], v[50:51], s[36:37]
  v_pk_mul_f32 v[52:53], v[52:53], s[36:37]
  v_pk_mul_f32 v[54:55], v[54:55], s[36:37]
  v_cvt_pk_bf16_f32 v128, v40, v41
  v_cvt_pk_bf16_f32 v129, v42, v43
  v_cvt_pk_bf16_f32 v130, v44, v45
  v_cvt_pk_bf16_f32 v131, v46, v47
  v_cvt_pk_bf16_f32 v132, v48, v49
  v_cvt_pk_bf16_f32 v133, v50, v51
  v_cvt_pk_bf16_f32 v134, v52, v53
  v_cvt_pk_bf16_f32 v135, v54, v55
  ds_write_b128 v6, v[128:131] offset:0
  ds_write_b128 v6, v[132:135] offset:1024
  s_waitcnt lgkmcnt(0) vmcnt(16)
  s_barrier
  ds_read_b128 v[136:139], v7 offset:0
  ds_read_b128 v[140:143], v7 offset:1024
  ds_read_b128 v[152:155], v7 offset:2048
  ds_read_b128 v[156:159], v7 offset:3072
  ds_read_b128 v[168:171], v7 offset:4096
  ds_read_b128 v[172:175], v7 offset:5120
  ds_read_b128 v[184:187], v7 offset:6144
  ds_read_b128 v[188:191], v7 offset:7168
  ds_read_b128 v[200:203], v7 offset:8192
  ds_read_b128 v[204:207], v7 offset:9216
  ds_read_b128 v[216:219], v7 offset:10240
  ds_read_b128 v[220:223], v7 offset:11264
  ds_read_b128 v[232:235], v7 offset:12288
  ds_read_b128 v[236:239], v7 offset:13312
  s_waitcnt lgkmcnt(0)
  s_barrier
  global_load_lds_dwordx4 v20, s[12:13] offset:0 nt
  global_load_lds_dwordx4 v21, s[12:13] offset:1024 nt
  global_load_lds_dwordx4 v22, s[12:13] offset:2048 nt
  global_load_lds_dwordx4 v23, s[12:13] offset:3072 nt
  s_add_u32 m0, s30, 0x4000
  s_nop 0
  s_lshr_b32 s20, s45, 3
  s_lshl_b32 s20, s20, 10
  s_and_b32 s21, s44, 3
  s_lshl_b32 s21, s21, 1
  s_bfe_u32 s22, s45, 0x10002
  s_add_u32 s21, s21, s22
  s_lshl_b32 s21, s21, 7
  s_add_u32 s20, s20, s21
  s_lshl_b32 s21, s3, 5
  s_add_u32 s20, s20, s21
  v_lshrrev_b32 v240, 1, v2
  v_add_u32 v240, s20, v240
  v_lshlrev_b32 v240, 10, v240
  v_and_b32 v241, 1, v2
  v_lshl_add_u32 v240, v241, 7, v240
  s_and_b32 s21, s45, 3
  s_lshl_b32 s21, s21, 8
  v_add_u32 v240, s21, v240
  v_mov_b32 v241, 0
  s_lshl_b32 s26, s44, 2
  s_lshr_b32 s27, s45, 3
  s_add_u32 s26, s26, s27
  s_lshl_b32 s26, s26, 2
  s_add_u32 s26, s26, 32
  s_cmp_eq_u32 s3, 0
  s_cselect_b32 s84, s86, s8
  s_cselect_b32 s85, s87, s9
  v_lshlrev_b32 v247, 4, v2
  s_lshl_b32 s20, s3, 15
  v_add_u32 v247, s20, v247
  s_lshr_b32 s20, s45, 3
  s_lshl_b32 s20, s20, 20
  s_and_b32 s21, s45, 3
  s_lshl_b32 s21, s21, 8
  s_add_u32 s20, s20, s21
  s_add_u32 s56, s88, s20
  s_addc_u32 s57, s89, 0
  s_and_b32 s38, s45, 7
  s_lshl_b32 s38, s38, 17
  s_add_u32 s14, s56, s38
  s_addc_u32 s15, s57, 0
  s_lshl_b32 s37, s3, 11
  v_lshrrev_b32 v3, 4, v2
  v_and_b32 v4, 15, v2
  v_lshlrev_b32 v5, 1, v3
  v_xor_b32 v4, v4, v5
  v_lshlrev_b32 v5, 10, v3
  s_lshl_b32 s20, s3, 13
  v_add_u32 v5, s20, v5
  v_lshl_add_u32 v92, v4, 4, v5
  v_xor_b32 v4, 8, v4
  v_lshl_add_u32 v4, v4, 4, v5
  v_add_u32 v93, 3072, v4
  s_mov_b32 s60, 0
  s_getpc_b64 s[92:93]
L_pc2:
  s_add_u32 s92, s92, L_pen-L_pc2
  s_addc_u32 s93, s93, 0
  s_lshr_b32 s20, s2, 3
  s_lshl_b32 s20, s20, 3
  s_lshl_b32 s21, s3, 1
  s_add_u32 s20, s20, s21
  v_and_b32 v95, 1, v2
  v_add_u32 v95, s20, v95
  v_lshlrev_b32 v95, 7, v95
  v_min_u32 v95, L_k1_end-L_pen, v95
  v_xor_b32 v34, 0, v33
  ds_read_b128 v[96:99], v34
  v_xor_b32 v34, 64, v33
  ds_read_b128 v[100:103], v34
  v_xor_b32 v34, 128, v33
  ds_read_b128 v[104:107], v34
  v_xor_b32 v34, 192, v33
  ds_read_b128 v[108:111], v34
  ds_read_b128 a[224:227], v8 offset:0
  ds_read_b128 a[240:243], v8 offset:4096
  ds_read_b128 a[228:231], v9 offset:0
  ds_read_b128 a[244:247], v9 offset:4096
  ds_read_b128 a[232:235], v10 offset:0
  ds_read_b128 a[248:251], v10 offset:4096
  ds_read_b128 a[236:239], v11 offset:0
  ds_read_b128 a[252:255], v11 offset:4096
  s_waitcnt lgkmcnt(11)
  v_mfma_f32_16x16x32_bf16 v[64:67], v[96:99], v[128:131], 0
  v_mfma_f32_16x16x32_bf16 v[68:71], v[96:99], v[144:147], 0
  v_mfma_f32_16x16x32_bf16 v[72:75], v[96:99], v[160:163], 0
  v_mfma_f32_16x16x32_bf16 v[76:79], v[96:99], v[176:179], 0
  v_mfma_f32_16x16x32_bf16 v[80:83], v[96:99], v[192:195], 0
  v_mfma_f32_16x16x32_bf16 v[84:87], v[96:99], v[208:211], 0
  v_mfma_f32_16x16x32_bf16 v[88:91], v[96:99], v[224:227], 0
  s_waitcnt lgkmcnt(10)
  v_mfma_f32_16x16x32_bf16 v[64:67], v[100:103], v[132:135], v[64:67]
  v_mfma_f32_16x16x32_bf16 v[68:71], v[100:103], v[148:151], v[68:71]
  v_mfma_f32_16x16x32_bf16 v[72:75], v[100:103], v[164:167], v[72:75]
  v_mfma_f32_16x16x32_bf16 v[76:79], v[100:103], v[180:183], v[76:79]
  v_mfma_f32_16x16x32_bf16 v[80:83], v[100:103], v[196:199], v[80:83]
  v_mfma_f32_16x16x32_bf16 v[84:87], v[100:103], v[212:215], v[84:87]
  v_mfma_f32_16x16x32_bf16 v[88:91], v[100:103], v[228:231], v[88:91]
  s_waitcnt lgkmcnt(9)
  v_mfma_f32_16x16x32_bf16 v[64:67], v[104:107], v[136:139], v[64:67]
  v_mfma_f32_16x16x32_bf16 v[68:71], v[104:107], v[152:155], v[68:71]
  v_mfma_f32_16x16x32_bf16 v[72:75], v[104:107], v[168:171], v[72:75]
  v_mfma_f32_16x16x32_bf16 v[76:79], v[104:107], v[184:187], v[76:79]
  v_mfma_f32_16x16x32_bf16 v[80:83], v[104:107], v[200:203], v[80:83]
  v_mfma_f32_16x16x32_bf16 v[84:87], v[104:107], v[216:219], v[84:87]
  v_mfma_f32_16x16x32_bf16 v[88:91], v[104:107], v[232:235], v[88:91]
  s_waitcnt lgkmcnt(8)
  v_mfma_f32_16x16x32_bf16 v[64:67], v[108:111], v[140:143], v[64:67]
  v_mfma_f32_16x16x32_bf16 v[68:71], v[108:111], v[156:159], v[68:71]
  v_mfma_f32_16x16x32_bf16 v[72:75], v[108:111], v[172:175], v[72:75]
  v_mfma_f32_16x16x32_bf16 v[76:79], v[108:111], v[188:191], v[76:79]
  v_mfma_f32_16x16x32_bf16 v[80:83], v[108:111], v[204:207], v[80:83]
  v_mfma_f32_16x16x32_bf16 v[84:87], v[108:111], v[220:223], v[84:87]
  v_mfma_f32_16x16x32_bf16 v[88:91], v[108:111], v[236:239], v[88:91]
  ds_read_b64_tr_b16 v[96:97], v12 offset:0
  ds_read_b64_tr_b16 v[98:99], v12 offset:4096
  ds_read_b64_tr_b16 v[100:101], v13 offset:0
  ds_read_b64_tr_b16 v[102:103], v13 offset:4096
  ds_read_b64_tr_b16 v[104:105], v14 offset:0
  ds_read_b64_tr_b16 v[106:107], v14 offset:4096
  ds_read_b64_tr_b16 v[108:109], v15 offset:0
  ds_read_b64_tr_b16 v[110:111], v15 offset:4096
  ds_read_b64_tr_b16 v[112:113], v16 offset:0
  ds_read_b64_tr_b16 v[114:115], v16 offset:4096
  ds_read_b64_tr_b16 v[116:117], v17 offset:0
  ds_read_b64_tr_b16 v[118:119], v17 offset:4096
  ds_read_b64_tr_b16 v[120:121], v18 offset:0
  ds_read_b64_tr_b16 v[122:123], v18 offset:4096
  ds_read_b64_tr_b16 v[124:125], v19 offset:0
  ds_read_b64_tr_b16 v[126:127], v19 offset:4096
  v_max3_f32 v64, v64, v65, v66
  v_max_f32 v64, v64, v67
  v_max3_f32 v68, v68, v69, v70
  v_max_f32 v68, v68, v71
  v_max3_f32 v72, v72, v73, v74
  v_max_f32 v72, v72, v75
  v_max3_f32 v76, v76, v77, v78
  v_max_f32 v76, v76, v79
  v_max3_f32 v80, v80, v81, v82
  v_max_f32 v80, v80, v83
  v_max3_f32 v84, v84, v85, v86
  v_max_f32 v84, v84, v87
  v_max3_f32 v88, v88, v89, v90
  v_max_f32 v88, v88, v91
  v_mov_b32 v65, v64
  v_mov_b32 v69, v68
  v_mov_b32 v73, v72
  v_mov_b32 v77, v76
  v_mov_b32 v81, v80
  v_mov_b32 v85, v84
  v_mov_b32 v89, v88
  v_permlane16_swap_b32 v64, v65
  v_permlane16_swap_b32 v68, v69
  v_permlane16_swap_b32 v72, v73
  v_permlane16_swap_b32 v76, v77
  v_permlane16_swap_b32 v80, v81
  v_permlane16_swap_b32 v84, v85
  v_permlane16_swap_b32 v88, v89
  v_max_f32 v64, v64, v65
  v_max_f32 v68, v68, v69
  v_max_f32 v72, v72, v73
  v_max_f32 v76, v76, v77
  v_max_f32 v80, v80, v81
  v_max_f32 v84, v84, v85
  v_max_f32 v88, v88, v89
  v_mov_b32 v65, v64
  v_mov_b32 v69, v68
  v_mov_b32 v73, v72
  v_mov_b32 v77, v76
  v_mov_b32 v81, v80
  v_mov_b32 v85, v84
  v_mov_b32 v89, v88
  v_permlane32_swap_b32 v64, v65
  v_permlane32_swap_b32 v68, v69
  v_permlane32_swap_b32 v72, v73
  v_permlane32_swap_b32 v76, v77
  v_permlane32_swap_b32 v80, v81
  v_permlane32_swap_b32 v84, v85
  v_permlane32_swap_b32 v88, v89
  v_max_f32 v64, v64, v65
  v_max_f32 v68, v68, v69
  v_max_f32 v72, v72, v73
  v_max_f32 v76, v76, v77
  v_max_f32 v80, v80, v81
  v_max_f32 v84, v84, v85
  v_max_f32 v88, v88, v89
  v_sub_f32 v64, 0, v64
  v_sub_f32 v68, 0, v68
  v_sub_f32 v72, 0, v72
  v_sub_f32 v76, 0, v76
  v_sub_f32 v80, 0, v80
  v_sub_f32 v84, 0, v84
  v_sub_f32 v88, 0, v88
  v_mov_b32 v65, v64
  v_mov_b32 v69, v68
  v_mov_b32 v73, v72
  v_mov_b32 v77, v76
  v_mov_b32 v81, v80
  v_mov_b32 v85, v84
  v_mov_b32 v89, v88
  v_mov_b32 v66, v64
  v_mov_b32 v70, v68
  v_mov_b32 v74, v72
  v_mov_b32 v78, v76
  v_mov_b32 v82, v80
  v_mov_b32 v86, v84
  v_mov_b32 v90, v88
  v_mov_b32 v67, v64
  v_mov_b32 v71, v68
  v_mov_b32 v75, v72
  v_mov_b32 v79, v76
  v_mov_b32 v83, v80
  v_mov_b32 v87, v84
  v_mov_b32 v91, v88
  s_nop 1
  s_waitcnt lgkmcnt(15)
  v_mfma_f32_16x16x32_bf16 v[40:43], a[224:227], v[128:131], v[64:67]
  v_mfma_f32_16x16x32_bf16 v[44:47], a[240:243], v[128:131], v[64:67]
  v_mfma_f32_16x16x32_bf16 v[40:43], a[228:231], v[132:135], v[40:43]
  v_mfma_f32_16x16x32_bf16 v[44:47], a[244:247], v[132:135], v[44:47]
  v_mfma_f32_16x16x32_bf16 v[40:43], a[232:235], v[136:139], v[40:43]
  v_mfma_f32_16x16x32_bf16 v[44:47], a[248:251], v[136:139], v[44:47]
  v_mfma_f32_16x16x32_bf16 v[40:43], a[236:239], v[140:143], v[40:43]
  v_mfma_f32_16x16x32_bf16 v[44:47], a[252:255], v[140:143], v[44:47]
  v_mfma_f32_16x16x32_bf16 v[48:51], a[224:227], v[144:147], v[68:71]
  v_mfma_f32_16x16x32_bf16 v[52:55], a[240:243], v[144:147], v[68:71]
  v_mfma_f32_16x16x32_bf16 v[48:51], a[228:231], v[148:151], v[48:51]
  v_mfma_f32_16x16x32_bf16 v[52:55], a[244:247], v[148:151], v[52:55]
  v_mfma_f32_16x16x32_bf16 v[48:51], a[232:235], v[152:155], v[48:51]
  v_mfma_f32_16x16x32_bf16 v[52:55], a[248:251], v[152:155], v[52:55]
  v_mfma_f32_16x16x32_bf16 v[48:51], a[236:239], v[156:159], v[48:51]
  v_exp_f32 v40, v40
  v_exp_f32 v41, v41
  v_mfma_f32_16x16x32_bf16 v[52:55], a[252:255], v[156:159], v[52:55]
  v_exp_f32 v42, v42
  v_exp_f32 v43, v43
  v_exp_f32 v44, v44
  v_exp_f32 v45, v45
  v_exp_f32 v46, v46
  v_exp_f32 v47, v47
  v_add_f32 v26, v26, v40
  v_add_f32 v26, v26, v41
  v_cvt_pk_bf16_f32 v56, v40, v41
  v_add_f32 v26, v26, v42
  v_add_f32 v26, v26, v43
  v_cvt_pk_bf16_f32 v57, v42, v43
  v_add_f32 v26, v26, v44
  v_add_f32 v26, v26, v45
  v_cvt_pk_bf16_f32 v58, v44, v45
  v_add_f32 v26, v26, v46
  v_add_f32 v26, v26, v47
  v_cvt_pk_bf16_f32 v59, v46, v47
  v_exp_f32 v48, v48
  v_exp_f32 v49, v49
  s_nop 0
  v_add_f32 v27, v27, v48
  v_add_f32 v27, v27, v49
  v_cvt_pk_bf16_f32 v60, v48, v49
L_attn_start:
  s_waitcnt lgkmcnt(0)
  s_mov_b32 s47, 0
.p2align 3
L_loop:
  v_mfma_f32_16x16x32_bf16 v[40:43], a[224:227], v[160:163], v[72:75]
  ds_read_b64_tr_b16 v[118:119], v17 offset:4096
  v_exp_f32 v50, v50
  v_mfma_f32_16x16x32_bf16 v[44:47], a[240:243], v[160:163], v[72:75]
  ds_read_b64_tr_b16 v[120:121], v18 offset:0
  ds_read_b64_tr_b16 v[122:123], v18 offset:4096
  v_add_f32 v27, v27, v50
  v_mfma_f32_16x16x32_bf16 v[40:43], a[228:231], v[164:167], v[40:43]
  ds_read_b64_tr_b16 v[124:125], v19 offset:0
  v_exp_f32 v51, v51
  v_mfma_f32_16x16x32_bf16 v[44:47], a[244:247], v[164:167], v[44:47]
  v_add_f32 v27, v27, v51
  v_cvt_pk_bf16_f32 v61, v50, v51
  v_mfma_f32_16x16x32_bf16 v[40:43], a[232:235], v[168:171], v[40:43]
  v_exp_f32 v52, v52
  v_mfma_f32_16x16x32_bf16 v[44:47], a[248:251], v[168:171], v[44:47]
  ds_read_b64_tr_b16 v[126:127], v19 offset:4096
  global_load_lds_dwordx4 v24, s[16:17] offset:0 nt
  v_add_f32 v27, v27, v52
  v_mfma_f32_16x16x32_bf16 v[40:43], a[236:239], v[172:175], v[40:43]
  v_exp_f32 v53, v53
  v_mfma_f32_16x16x32_bf16 v[44:47], a[252:255], v[172:175], v[44:47]
  s_waitcnt lgkmcnt(14)
  v_add_f32 v27, v27, v53
  v_cvt_pk_bf16_f32 v62, v52, v53
  v_mfma_f32_16x16x32_bf16 a[0:3], v[96:99], v[56:59], a[0:3]
  s_waitcnt lgkmcnt(12)
  v_exp_f32 v54, v54
  v_mfma_f32_16x16x32_bf16 a[4:7], v[100:103], v[56:59], a[4:7]
  s_waitcnt lgkmcnt(10)
  global_load_lds_dwordx4 v25, s[16:17] offset:1024 nt
  v_add_f32 v27, v27, v54
  v_mfma_f32_16x16x32_bf16 a[8:11], v[104:107], v[56:59], a[8:11]
  s_waitcnt lgkmcnt(8)
  v_exp_f32 v55, v55
  v_mfma_f32_16x16x32_bf16 a[12:15], v[108:111], v[56:59], a[12:15]
  s_waitcnt lgkmcnt(6)
  v_add_f32 v27, v27, v55
  v_cvt_pk_bf16_f32 v63, v54, v55
  v_mfma_f32_16x16x32_bf16 a[16:19], v[112:115], v[56:59], a[16:19]
  s_waitcnt lgkmcnt(4)
  v_exp_f32 v40, v40
  v_mfma_f32_16x16x32_bf16 a[20:23], v[116:119], v[56:59], a[20:23]
  s_waitcnt lgkmcnt(2)
  v_add_f32 v28, v28, v40
  v_mfma_f32_16x16x32_bf16 a[24:27], v[120:123], v[56:59], a[24:27]
  s_waitcnt lgkmcnt(0)
  v_exp_f32 v41, v41
  v_mfma_f32_16x16x32_bf16 a[28:31], v[124:127], v[56:59], a[28:31]
  v_add_f32 v28, v28, v41
  v_cvt_pk_bf16_f32 v56, v40, v41
  v_mfma_f32_16x16x32_bf16 v[48:51], a[224:227], v[176:179], v[76:79]
  v_exp_f32 v42, v42
  v_mfma_f32_16x16x32_bf16 v[52:55], a[240:243], v[176:179], v[76:79]
  v_add_f32 v28, v28, v42
  v_mfma_f32_16x16x32_bf16 v[48:51], a[228:231], v[180:183], v[48:51]
  v_exp_f32 v43, v43
  v_mfma_f32_16x16x32_bf16 v[52:55], a[244:247], v[180:183], v[52:55]
  v_add_f32 v28, v28, v43
  v_cvt_pk_bf16_f32 v57, v42, v43
  v_mfma_f32_16x16x32_bf16 v[48:51], a[232:235], v[184:187], v[48:51]
  v_exp_f32 v44, v44
  v_mfma_f32_16x16x32_bf16 v[52:55], a[248:251], v[184:187], v[52:55]
  global_load_lds_dwordx4 v24, s[16:17] offset:2048 nt
  v_add_f32 v28, v28, v44
  v_mfma_f32_16x16x32_bf16 v[48:51], a[236:239], v[188:191], v[48:51]
  v_exp_f32 v45, v45
  v_mfma_f32_16x16x32_bf16 v[52:55], a[252:255], v[188:191], v[52:55]
  v_add_f32 v28, v28, v45
  v_cvt_pk_bf16_f32 v58, v44, v45
  v_mfma_f32_16x16x32_bf16 a[32:35], v[96:99], v[60:63], a[32:35]
  v_exp_f32 v46, v46
  v_mfma_f32_16x16x32_bf16 a[36:39], v[100:103], v[60:63], a[36:39]
  global_load_lds_dwordx4 v25, s[16:17] offset:3072 nt
  v_add_f32 v28, v28, v46
  v_mfma_f32_16x16x32_bf16 a[40:43], v[104:107], v[60:63], a[40:43]
  s_add_u32 s28, s28, 0x8000
  s_and_b32 s28, s28, 0x1ffff
  v_exp_f32 v47, v47
  v_mfma_f32_16x16x32_bf16 a[44:47], v[108:111], v[60:63], a[44:47]
  s_add_u32 s30, s28, s29
  s_mov_b32 m0, s30
  v_add_f32 v28, v28, v47
  v_cvt_pk_bf16_f32 v59, v46, v47
  v_mfma_f32_16x16x32_bf16 a[48:51], v[112:115], v[60:63], a[48:51]
  s_add_u32 s24, s24, 0x4000
  s_and_b32 s24, s24, 0x3ffff
  v_exp_f32 v48, v48
  v_mfma_f32_16x16x32_bf16 a[52:55], v[116:119], v[60:63], a[52:55]
  s_add_u32 s12, s50, s24
  s_addc_u32 s13, s51, 0
  v_add_f32 v29, v29, v48
  v_mfma_f32_16x16x32_bf16 a[56:59], v[120:123], v[60:63], a[56:59]
  s_add_u32 s16, s52, s24
  s_addc_u32 s17, s53, 0
  v_exp_f32 v49, v49
  v_mfma_f32_16x16x32_bf16 a[60:63], v[124:127], v[60:63], a[60:63]
  v_add_f32 v29, v29, v49
  v_cvt_pk_bf16_f32 v60, v48, v49
  v_mfma_f32_16x16x32_bf16 v[40:43], a[224:227], v[192:195], v[80:83]
  v_exp_f32 v50, v50
  v_mfma_f32_16x16x32_bf16 v[44:47], a[240:243], v[192:195], v[80:83]
  v_add_f32 v29, v29, v50
  v_mfma_f32_16x16x32_bf16 v[40:43], a[228:231], v[196:199], v[40:43]
  v_exp_f32 v51, v51
  v_mfma_f32_16x16x32_bf16 v[44:47], a[244:247], v[196:199], v[44:47]
  v_add_f32 v29, v29, v51
  v_cvt_pk_bf16_f32 v61, v50, v51
  v_mfma_f32_16x16x32_bf16 v[40:43], a[232:235], v[200:203], v[40:43]
  v_exp_f32 v52, v52
  v_mfma_f32_16x16x32_bf16 v[44:47], a[248:251], v[200:203], v[44:47]
  v_add_f32 v29, v29, v52
  v_mfma_f32_16x16x32_bf16 v[40:43], a[236:239], v[204:207], v[40:43]
  v_exp_f32 v53, v53
  v_mfma_f32_16x16x32_bf16 v[44:47], a[252:255], v[204:207], v[44:47]
  v_add_f32 v29, v29, v53
  v_cvt_pk_bf16_f32 v62, v52, v53
  v_mfma_f32_16x16x32_bf16 a[64:67], v[96:99], v[56:59], a[64:67]
  v_exp_f32 v54, v54
  v_mfma_f32_16x16x32_bf16 a[68:71], v[100:103], v[56:59], a[68:71]
  v_add_f32 v29, v29, v54
  v_mfma_f32_16x16x32_bf16 a[72:75], v[104:107], v[56:59], a[72:75]
  v_exp_f32 v55, v55
  v_mfma_f32_16x16x32_bf16 a[76:79], v[108:111], v[56:59], a[76:79]
  v_add_f32 v29, v29, v55
  v_cvt_pk_bf16_f32 v63, v54, v55
  v_mfma_f32_16x16x32_bf16 a[80:83], v[112:115], v[56:59], a[80:83]
  v_exp_f32 v40, v40
  v_mfma_f32_16x16x32_bf16 a[84:87], v[116:119], v[56:59], a[84:87]
  v_add_f32 v30, v30, v40
  v_mfma_f32_16x16x32_bf16 a[88:91], v[120:123], v[56:59], a[88:91]
  v_exp_f32 v41, v41
  v_mfma_f32_16x16x32_bf16 a[92:95], v[124:127], v[56:59], a[92:95]
  v_add_f32 v30, v30, v41
  v_cvt_pk_bf16_f32 v56, v40, v41
  v_mfma_f32_16x16x32_bf16 v[48:51], a[224:227], v[208:211], v[84:87]
  v_exp_f32 v42, v42
  v_mfma_f32_16x16x32_bf16 v[52:55], a[240:243], v[208:211], v[84:87]
  v_add_f32 v30, v30, v42
  v_mfma_f32_16x16x32_bf16 v[48:51], a[228:231], v[212:215], v[48:51]
  v_exp_f32 v43, v43
  v_mfma_f32_16x16x32_bf16 v[52:55], a[244:247], v[212:215], v[52:55]
  v_add_f32 v30, v30, v43
  v_cvt_pk_bf16_f32 v57, v42, v43
  v_mfma_f32_16x16x32_bf16 v[48:51], a[232:235], v[216:219], v[48:51]
  v_exp_f32 v44, v44
  v_mfma_f32_16x16x32_bf16 v[52:55], a[248:251], v[216:219], v[52:55]
  v_add_f32 v30, v30, v44
  v_mfma_f32_16x16x32_bf16 v[48:51], a[236:239], v[220:223], v[48:51]
  v_exp_f32 v45, v45
  v_mfma_f32_16x16x32_bf16 v[52:55], a[252:255], v[220:223], v[52:55]
  v_add_f32 v30, v30, v45
  v_cvt_pk_bf16_f32 v58, v44, v45
  v_mfma_f32_16x16x32_bf16 a[96:99], v[96:99], v[60:63], a[96:99]
  v_exp_f32 v46, v46
  v_mfma_f32_16x16x32_bf16 a[100:103], v[100:103], v[60:63], a[100:103]
  v_add_f32 v30, v30, v46
  v_mfma_f32_16x16x32_bf16 a[104:107], v[104:107], v[60:63], a[104:107]
  v_exp_f32 v47, v47
  v_mfma_f32_16x16x32_bf16 a[108:111], v[108:111], v[60:63], a[108:111]
  v_add_f32 v30, v30, v47
  v_cvt_pk_bf16_f32 v59, v46, v47
  v_mfma_f32_16x16x32_bf16 a[112:115], v[112:115], v[60:63], a[112:115]
  v_exp_f32 v48, v48
  v_mfma_f32_16x16x32_bf16 a[116:119], v[116:119], v[60:63], a[116:119]
  v_add_f32 v31, v31, v48
  v_mfma_f32_16x16x32_bf16 a[120:123], v[120:123], v[60:63], a[120:123]
  v_exp_f32 v49, v49
  v_mfma_f32_16x16x32_bf16 a[124:127], v[124:127], v[60:63], a[124:127]
  v_add_f32 v31, v31, v49
  v_cvt_pk_bf16_f32 v60, v48, v49
  s_waitcnt vmcnt(16)
  s_barrier
  v_mfma_f32_16x16x32_bf16 v[40:43], a[224:227], v[224:227], v[88:91]
  v_exp_f32 v50, v50
  v_mfma_f32_16x16x32_bf16 v[44:47], a[240:243], v[224:227], v[88:91]
  ds_read_b128 a[224:227], v8 offset:32768
  v_add_f32 v31, v31, v50
  v_mfma_f32_16x16x32_bf16 v[40:43], a[228:231], v[228:231], v[40:43]
  ds_read_b128 a[240:243], v8 offset:36864
  v_exp_f32 v51, v51
  v_mfma_f32_16x16x32_bf16 v[44:47], a[244:247], v[228:231], v[44:47]
  ds_read_b128 a[228:231], v9 offset:32768
  v_add_f32 v31, v31, v51
  v_cvt_pk_bf16_f32 v61, v50, v51
  v_mfma_f32_16x16x32_bf16 v[40:43], a[232:235], v[232:235], v[40:43]
  v_exp_f32 v52, v52
  v_mfma_f32_16x16x32_bf16 v[44:47], a[248:251], v[232:235], v[44:47]
  ds_read_b128 a[244:247], v9 offset:36864
  v_add_f32 v31, v31, v52
  v_mfma_f32_16x16x32_bf16 v[40:43], a[236:239], v[236:239], v[40:43]
  v_exp_f32 v53, v53
  v_mfma_f32_16x16x32_bf16 v[44:47], a[252:255], v[236:239], v[44:47]
  ds_read_b128 a[232:235], v10 offset:32768
  v_add_f32 v31, v31, v53
  v_cvt_pk_bf16_f32 v62, v52, v53
  v_mfma_f32_16x16x32_bf16 a[128:131], v[96:99], v[56:59], a[128:131]
  v_exp_f32 v54, v54
  v_mfma_f32_16x16x32_bf16 a[132:135], v[100:103], v[56:59], a[132:135]
  ds_read_b128 a[248:251], v10 offset:36864
  v_add_f32 v31, v31, v54
  v_mfma_f32_16x16x32_bf16 a[136:139], v[104:107], v[56:59], a[136:139]
  v_exp_f32 v55, v55
  v_mfma_f32_16x16x32_bf16 a[140:143], v[108:111], v[56:59], a[140:143]
  ds_read_b128 a[236:239], v11 offset:32768
  v_add_f32 v31, v31, v55
  v_cvt_pk_bf16_f32 v63, v54, v55
  v_mfma_f32_16x16x32_bf16 a[144:147], v[112:115], v[56:59], a[144:147]
  v_exp_f32 v40, v40
  v_mfma_f32_16x16x32_bf16 a[148:151], v[116:119], v[56:59], a[148:151]
  ds_read_b128 a[252:255], v11 offset:36864
  v_add_f32 v32, v32, v40
  v_mfma_f32_16x16x32_bf16 a[152:155], v[120:123], v[56:59], a[152:155]
  v_exp_f32 v41, v41
  v_mfma_f32_16x16x32_bf16 a[156:159], v[124:127], v[56:59], a[156:159]
  s_waitcnt lgkmcnt(7)
  v_add_f32 v32, v32, v41
  v_cvt_pk_bf16_f32 v56, v40, v41
  v_mfma_f32_16x16x32_bf16 v[48:51], a[224:227], v[128:131], v[64:67]
  s_waitcnt lgkmcnt(6)
  v_exp_f32 v42, v42
  v_mfma_f32_16x16x32_bf16 v[52:55], a[240:243], v[128:131], v[64:67]
  s_waitcnt lgkmcnt(5)
  v_add_f32 v32, v32, v42
  v_mfma_f32_16x16x32_bf16 v[48:51], a[228:231], v[132:135], v[48:51]
  s_waitcnt lgkmcnt(4)
  v_exp_f32 v43, v43
  v_mfma_f32_16x16x32_bf16 v[52:55], a[244:247], v[132:135], v[52:55]
  s_waitcnt lgkmcnt(3)
  v_add_f32 v32, v32, v43
  v_cvt_pk_bf16_f32 v57, v42, v43
  v_mfma_f32_16x16x32_bf16 v[48:51], a[232:235], v[136:139], v[48:51]
  s_waitcnt lgkmcnt(2)
  v_exp_f32 v44, v44
  v_mfma_f32_16x16x32_bf16 v[52:55], a[248:251], v[136:139], v[52:55]
  s_waitcnt lgkmcnt(1)
  global_load_lds_dwordx4 v20, s[12:13] offset:0 nt
  v_add_f32 v32, v32, v44
  v_mfma_f32_16x16x32_bf16 v[48:51], a[236:239], v[140:143], v[48:51]
  s_waitcnt lgkmcnt(0)
  v_exp_f32 v45, v45
  v_mfma_f32_16x16x32_bf16 v[52:55], a[252:255], v[140:143], v[52:55]
  v_add_f32 v32, v32, v45
  v_cvt_pk_bf16_f32 v58, v44, v45
  v_mfma_f32_16x16x32_bf16 a[160:163], v[96:99], v[60:63], a[160:163]
  v_exp_f32 v46, v46
  v_mfma_f32_16x16x32_bf16 a[164:167], v[100:103], v[60:63], a[164:167]
  global_load_lds_dwordx4 v21, s[12:13] offset:1024 nt
  v_add_f32 v32, v32, v46
  v_mfma_f32_16x16x32_bf16 a[168:171], v[104:107], v[60:63], a[168:171]
  v_exp_f32 v47, v47
  v_mfma_f32_16x16x32_bf16 a[172:175], v[108:111], v[60:63], a[172:175]
  v_add_f32 v32, v32, v47
  v_cvt_pk_bf16_f32 v59, v46, v47
  v_mfma_f32_16x16x32_bf16 a[176:179], v[112:115], v[60:63], a[176:179]
  v_exp_f32 v48, v48
  v_mfma_f32_16x16x32_bf16 a[180:183], v[116:119], v[60:63], a[180:183]
  v_add_f32 v26, v26, v48
  v_mfma_f32_16x16x32_bf16 a[184:187], v[120:123], v[60:63], a[184:187]
  v_exp_f32 v49, v49
  v_mfma_f32_16x16x32_bf16 a[188:191], v[124:127], v[60:63], a[188:191]
  v_add_f32 v26, v26, v49
  v_cvt_pk_bf16_f32 v60, v48, v49
  v_mfma_f32_16x16x32_bf16 v[40:43], a[224:227], v[144:147], v[68:71]
  v_exp_f32 v50, v50
  v_mfma_f32_16x16x32_bf16 v[44:47], a[240:243], v[144:147], v[68:71]
  v_add_f32 v26, v26, v50
  v_mfma_f32_16x16x32_bf16 v[40:43], a[228:231], v[148:151], v[40:43]
  v_exp_f32 v51, v51
  v_mfma_f32_16x16x32_bf16 v[44:47], a[244:247], v[148:151], v[44:47]
  v_add_f32 v26, v26, v51
  v_cvt_pk_bf16_f32 v61, v50, v51
  v_mfma_f32_16x16x32_bf16 v[40:43], a[232:235], v[152:155], v[40:43]
  v_exp_f32 v52, v52
  v_mfma_f32_16x16x32_bf16 v[44:47], a[248:251], v[152:155], v[44:47]
  global_load_lds_dwordx4 v22, s[12:13] offset:2048 nt
  v_add_f32 v26, v26, v52
  v_mfma_f32_16x16x32_bf16 v[40:43], a[236:239], v[156:159], v[40:43]
  v_exp_f32 v53, v53
  v_mfma_f32_16x16x32_bf16 v[44:47], a[252:255], v[156:159], v[44:47]
  v_add_f32 v26, v26, v53
  v_cvt_pk_bf16_f32 v62, v52, v53
  v_mfma_f32_16x16x32_bf16 a[192:195], v[96:99], v[56:59], a[192:195]
  v_exp_f32 v54, v54
  v_mfma_f32_16x16x32_bf16 a[196:199], v[100:103], v[56:59], a[196:199]
  ds_read_b64_tr_b16 v[96:97], v12 offset:32768
  ds_read_b64_tr_b16 v[98:99], v12 offset:36864
  global_load_lds_dwordx4 v23, s[12:13] offset:3072 nt
  v_add_f32 v26, v26, v54
  v_mfma_f32_16x16x32_bf16 a[200:203], v[104:107], v[56:59], a[200:203]
  ds_read_b64_tr_b16 v[100:101], v13 offset:32768
  s_add_u32 m0, s30, 0x4000
  v_exp_f32 v55, v55
  v_mfma_f32_16x16x32_bf16 a[204:207], v[108:111], v[56:59], a[204:207]
  ds_read_b64_tr_b16 v[102:103], v13 offset:36864
  ds_read_b64_tr_b16 v[104:105], v14 offset:32768
  v_add_f32 v26, v26, v55
  v_cvt_pk_bf16_f32 v63, v54, v55
  v_mfma_f32_16x16x32_bf16 a[208:211], v[112:115], v[56:59], a[208:211]
  ds_read_b64_tr_b16 v[106:107], v14 offset:36864
  v_exp_f32 v40, v40
  v_mfma_f32_16x16x32_bf16 a[212:215], v[116:119], v[56:59], a[212:215]
  ds_read_b64_tr_b16 v[108:109], v15 offset:32768
  ds_read_b64_tr_b16 v[110:111], v15 offset:36864
  v_add_f32 v27, v27, v40
  v_mfma_f32_16x16x32_bf16 a[216:219], v[120:123], v[56:59], a[216:219]
  ds_read_b64_tr_b16 v[112:113], v16 offset:32768
  v_exp_f32 v41, v41
  v_mfma_f32_16x16x32_bf16 a[220:223], v[124:127], v[56:59], a[220:223]
  ds_read_b64_tr_b16 v[114:115], v16 offset:36864
  ds_read_b64_tr_b16 v[116:117], v17 offset:32768
  v_add_f32 v27, v27, v41
  v_cvt_pk_bf16_f32 v56, v40, v41
  v_mfma_f32_16x16x32_bf16 v[48:51], a[224:227], v[160:163], v[72:75]
  ds_read_b64_tr_b16 v[118:119], v17 offset:36864
  v_exp_f32 v42, v42
  v_mfma_f32_16x16x32_bf16 v[52:55], a[240:243], v[160:163], v[72:75]
  ds_read_b64_tr_b16 v[120:121], v18 offset:32768
  ds_read_b64_tr_b16 v[122:123], v18 offset:36864
  v_add_f32 v27, v27, v42
  v_mfma_f32_16x16x32_bf16 v[48:51], a[228:231], v[164:167], v[48:51]
  ds_read_b64_tr_b16 v[124:125], v19 offset:32768
  v_exp_f32 v43, v43
  v_mfma_f32_16x16x32_bf16 v[52:55], a[244:247], v[164:167], v[52:55]
  v_add_f32 v27, v27, v43
  v_cvt_pk_bf16_f32 v57, v42, v43
  v_mfma_f32_16x16x32_bf16 v[48:51], a[232:235], v[168:171], v[48:51]
  v_exp_f32 v44, v44
  v_mfma_f32_16x16x32_bf16 v[52:55], a[248:251], v[168:171], v[52:55]
  ds_read_b64_tr_b16 v[126:127], v19 offset:36864
  global_load_lds_dwordx4 v24, s[16:17] offset:0 nt
  v_add_f32 v27, v27, v44
  v_mfma_f32_16x16x32_bf16 v[48:51], a[236:239], v[172:175], v[48:51]
  v_exp_f32 v45, v45
  v_mfma_f32_16x16x32_bf16 v[52:55], a[252:255], v[172:175], v[52:55]
  s_waitcnt lgkmcnt(14)
  v_add_f32 v27, v27, v45
  v_cvt_pk_bf16_f32 v58, v44, v45
  v_mfma_f32_16x16x32_bf16 a[0:3], v[96:99], v[60:63], a[0:3]
  s_waitcnt lgkmcnt(12)
  v_exp_f32 v46, v46
  v_mfma_f32_16x16x32_bf16 a[4:7], v[100:103], v[60:63], a[4:7]
  s_waitcnt lgkmcnt(10)
  global_load_lds_dwordx4 v25, s[16:17] offset:1024 nt
  v_add_f32 v27, v27, v46
  v_mfma_f32_16x16x32_bf16 a[8:11], v[104:107], v[60:63], a[8:11]
  s_waitcnt lgkmcnt(8)
  v_exp_f32 v47, v47
  v_mfma_f32_16x16x32_bf16 a[12:15], v[108:111], v[60:63], a[12:15]
  s_waitcnt lgkmcnt(6)
  v_add_f32 v27, v27, v47
  v_cvt_pk_bf16_f32 v59, v46, v47
  v_mfma_f32_16x16x32_bf16 a[16:19], v[112:115], v[60:63], a[16:19]
  s_waitcnt lgkmcnt(4)
  v_exp_f32 v48, v48
  v_mfma_f32_16x16x32_bf16 a[20:23], v[116:119], v[60:63], a[20:23]
  s_waitcnt lgkmcnt(2)
  v_add_f32 v28, v28, v48
  v_mfma_f32_16x16x32_bf16 a[24:27], v[120:123], v[60:63], a[24:27]
  s_waitcnt lgkmcnt(0)
  v_exp_f32 v49, v49
  v_mfma_f32_16x16x32_bf16 a[28:31], v[124:127], v[60:63], a[28:31]
  v_add_f32 v28, v28, v49
  v_cvt_pk_bf16_f32 v60, v48, v49
  v_mfma_f32_16x16x32_bf16 v[40:43], a[224:227], v[176:179], v[76:79]
  v_exp_f32 v50, v50
  v_mfma_f32_16x16x32_bf16 v[44:47], a[240:243], v[176:179], v[76:79]
  v_add_f32 v28, v28, v50
  v_xor_b32 v8, 0x10000, v8
  v_mfma_f32_16x16x32_bf16 v[40:43], a[228:231], v[180:183], v[40:43]
  v_exp_f32 v51, v51
  v_mfma_f32_16x16x32_bf16 v[44:47], a[244:247], v[180:183], v[44:47]
  v_add_f32 v28, v28, v51
  v_cvt_pk_bf16_f32 v61, v50, v51
  v_mfma_f32_16x16x32_bf16 v[40:43], a[232:235], v[184:187], v[40:43]
  v_exp_f32 v52, v52
  v_mfma_f32_16x16x32_bf16 v[44:47], a[248:251], v[184:187], v[44:47]
  global_load_lds_dwordx4 v24, s[16:17] offset:2048 nt
  v_add_f32 v28, v28, v52
  v_xor_b32 v9, 0x10000, v9
  v_mfma_f32_16x16x32_bf16 v[40:43], a[236:239], v[188:191], v[40:43]
  v_exp_f32 v53, v53
  v_mfma_f32_16x16x32_bf16 v[44:47], a[252:255], v[188:191], v[44:47]
  v_add_f32 v28, v28, v53
  v_cvt_pk_bf16_f32 v62, v52, v53
  v_mfma_f32_16x16x32_bf16 a[32:35], v[96:99], v[56:59], a[32:35]
  v_exp_f32 v54, v54
  v_mfma_f32_16x16x32_bf16 a[36:39], v[100:103], v[56:59], a[36:39]
  global_load_lds_dwordx4 v25, s[16:17] offset:3072 nt
  v_add_f32 v28, v28, v54
  v_xor_b32 v10, 0x10000, v10
  v_mfma_f32_16x16x32_bf16 a[40:43], v[104:107], v[56:59], a[40:43]
  s_add_u32 s28, s28, 0x8000
  s_and_b32 s28, s28, 0x1ffff
  v_exp_f32 v55, v55
  v_mfma_f32_16x16x32_bf16 a[44:47], v[108:111], v[56:59], a[44:47]
  s_add_u32 s30, s28, s29
  s_mov_b32 m0, s30
  v_add_f32 v28, v28, v55
  v_cvt_pk_bf16_f32 v63, v54, v55
  v_mfma_f32_16x16x32_bf16 a[48:51], v[112:115], v[56:59], a[48:51]
  s_add_u32 s24, s24, 0x4000
  s_and_b32 s24, s24, 0x3ffff
  v_exp_f32 v40, v40
  v_mfma_f32_16x16x32_bf16 a[52:55], v[116:119], v[56:59], a[52:55]
  s_add_u32 s12, s50, s24
  s_addc_u32 s13, s51, 0
  v_add_f32 v29, v29, v40
  v_xor_b32 v11, 0x10000, v11
  v_mfma_f32_16x16x32_bf16 a[56:59], v[120:123], v[56:59], a[56:59]
  s_add_u32 s16, s52, s24
  s_addc_u32 s17, s53, 0
  v_exp_f32 v41, v41
  v_mfma_f32_16x16x32_bf16 a[60:63], v[124:127], v[56:59], a[60:63]
  v_add_f32 v29, v29, v41
  v_cvt_pk_bf16_f32 v56, v40, v41
  v_mfma_f32_16x16x32_bf16 v[48:51], a[224:227], v[192:195], v[80:83]
  v_exp_f32 v42, v42
  v_mfma_f32_16x16x32_bf16 v[52:55], a[240:243], v[192:195], v[80:83]
  v_add_f32 v29, v29, v42
  v_xor_b32 v12, 0x10000, v12
  v_mfma_f32_16x16x32_bf16 v[48:51], a[228:231], v[196:199], v[48:51]
  v_exp_f32 v43, v43
  v_mfma_f32_16x16x32_bf16 v[52:55], a[244:247], v[196:199], v[52:55]
  v_add_f32 v29, v29, v43
  v_cvt_pk_bf16_f32 v57, v42, v43
  v_mfma_f32_16x16x32_bf16 v[48:51], a[232:235], v[200:203], v[48:51]
  v_exp_f32 v44, v44
  v_mfma_f32_16x16x32_bf16 v[52:55], a[248:251], v[200:203], v[52:55]
  v_add_f32 v29, v29, v44
  v_xor_b32 v13, 0x10000, v13
  v_mfma_f32_16x16x32_bf16 v[48:51], a[236:239], v[204:207], v[48:51]
  v_exp_f32 v45, v45
  v_mfma_f32_16x16x32_bf16 v[52:55], a[252:255], v[204:207], v[52:55]
  v_add_f32 v29, v29, v45
  v_cvt_pk_bf16_f32 v58, v44, v45
  v_mfma_f32_16x16x32_bf16 a[64:67], v[96:99], v[60:63], a[64:67]
  v_exp_f32 v46, v46
  v_mfma_f32_16x16x32_bf16 a[68:71], v[100:103], v[60:63], a[68:71]
  v_add_f32 v29, v29, v46
  v_xor_b32 v14, 0x10000, v14
  v_mfma_f32_16x16x32_bf16 a[72:75], v[104:107], v[60:63], a[72:75]
  v_exp_f32 v47, v47
  v_mfma_f32_16x16x32_bf16 a[76:79], v[108:111], v[60:63], a[76:79]
  v_add_f32 v29, v29, v47
  v_cvt_pk_bf16_f32 v59, v46, v47
  v_mfma_f32_16x16x32_bf16 a[80:83], v[112:115], v[60:63], a[80:83]
  v_exp_f32 v48, v48
  v_mfma_f32_16x16x32_bf16 a[84:87], v[116:119], v[60:63], a[84:87]
  v_add_f32 v30, v30, v48
  v_xor_b32 v15, 0x10000, v15
  v_mfma_f32_16x16x32_bf16 a[88:91], v[120:123], v[60:63], a[88:91]
  v_exp_f32 v49, v49
  v_mfma_f32_16x16x32_bf16 a[92:95], v[124:127], v[60:63], a[92:95]
  v_add_f32 v30, v30, v49
  v_cvt_pk_bf16_f32 v60, v48, v49
  v_mfma_f32_16x16x32_bf16 v[40:43], a[224:227], v[208:211], v[84:87]
  v_exp_f32 v50, v50
  v_mfma_f32_16x16x32_bf16 v[44:47], a[240:243], v[208:211], v[84:87]
  v_add_f32 v30, v30, v50
  v_xor_b32 v16, 0x10000, v16
  v_mfma_f32_16x16x32_bf16 v[40:43], a[228:231], v[212:215], v[40:43]
  v_exp_f32 v51, v51
  v_mfma_f32_16x16x32_bf16 v[44:47], a[244:247], v[212:215], v[44:47]
  v_add_f32 v30, v30, v51
  v_cvt_pk_bf16_f32 v61, v50, v51
  v_mfma_f32_16x16x32_bf16 v[40:43], a[232:235], v[216:219], v[40:43]
  v_exp_f32 v52, v52
  v_mfma_f32_16x16x32_bf16 v[44:47], a[248:251], v[216:219], v[44:47]
  global_load_dword v94, v95, s[92:93]
  v_add_f32 v30, v30, v52
  v_xor_b32 v17, 0x10000, v17
  v_mfma_f32_16x16x32_bf16 v[40:43], a[236:239], v[220:223], v[40:43]
  v_exp_f32 v53, v53
  v_mfma_f32_16x16x32_bf16 v[44:47], a[252:255], v[220:223], v[44:47]
  v_add_f32 v30, v30, v53
  v_cvt_pk_bf16_f32 v62, v52, v53
  v_mfma_f32_16x16x32_bf16 a[96:99], v[96:99], v[56:59], a[96:99]
  v_exp_f32 v54, v54
  v_mfma_f32_16x16x32_bf16 a[100:103], v[100:103], v[56:59], a[100:103]
  v_add_f32 v30, v30, v54
  v_xor_b32 v18, 0x10000, v18
  v_mfma_f32_16x16x32_bf16 a[104:107], v[104:107], v[56:59], a[104:107]
  v_exp_f32 v55, v55
  v_mfma_f32_16x16x32_bf16 a[108:111], v[108:111], v[56:59], a[108:111]
  v_add_f32 v30, v30, v55
  v_cvt_pk_bf16_f32 v63, v54, v55
  v_mfma_f32_16x16x32_bf16 a[112:115], v[112:115], v[56:59], a[112:115]
  v_exp_f32 v40, v40
  v_mfma_f32_16x16x32_bf16 a[116:119], v[116:119], v[56:59], a[116:119]
  v_add_f32 v31, v31, v40
  v_xor_b32 v19, 0x10000, v19
  v_mfma_f32_16x16x32_bf16 a[120:123], v[120:123], v[56:59], a[120:123]
  v_exp_f32 v41, v41
  v_mfma_f32_16x16x32_bf16 a[124:127], v[124:127], v[56:59], a[124:127]
  v_add_f32 v31, v31, v41
  v_cvt_pk_bf16_f32 v56, v40, v41
  s_waitcnt vmcnt(17)
  s_barrier
  v_mfma_f32_16x16x32_bf16 v[48:51], a[224:227], v[224:227], v[88:91]
  v_exp_f32 v42, v42
  v_mfma_f32_16x16x32_bf16 v[52:55], a[240:243], v[224:227], v[88:91]
  ds_read_b128 a[224:227], v8 offset:0
  v_add_f32 v31, v31, v42
  v_mfma_f32_16x16x32_bf16 v[48:51], a[228:231], v[228:231], v[48:51]
  ds_read_b128 a[240:243], v8 offset:4096
  v_exp_f32 v43, v43
  v_mfma_f32_16x16x32_bf16 v[52:55], a[244:247], v[228:231], v[52:55]
  ds_read_b128 a[228:231], v9 offset:0
  v_add_f32 v31, v31, v43
  v_cvt_pk_bf16_f32 v57, v42, v43
  v_mfma_f32_16x16x32_bf16 v[48:51], a[232:235], v[232:235], v[48:51]
  v_exp_f32 v44, v44
  v_mfma_f32_16x16x32_bf16 v[52:55], a[248:251], v[232:235], v[52:55]
  ds_read_b128 a[244:247], v9 offset:4096
  v_add_f32 v31, v31, v44
  v_mfma_f32_16x16x32_bf16 v[48:51], a[236:239], v[236:239], v[48:51]
  v_exp_f32 v45, v45
  v_mfma_f32_16x16x32_bf16 v[52:55], a[252:255], v[236:239], v[52:55]
  ds_read_b128 a[232:235], v10 offset:0
  v_add_f32 v31, v31, v45
  v_cvt_pk_bf16_f32 v58, v44, v45
  v_mfma_f32_16x16x32_bf16 a[128:131], v[96:99], v[60:63], a[128:131]
  v_exp_f32 v46, v46
  v_mfma_f32_16x16x32_bf16 a[132:135], v[100:103], v[60:63], a[132:135]
  ds_read_b128 a[248:251], v10 offset:4096
  v_add_f32 v31, v31, v46
  v_mfma_f32_16x16x32_bf16 a[136:139], v[104:107], v[60:63], a[136:139]
  v_exp_f32 v47, v47
  v_mfma_f32_16x16x32_bf16 a[140:143], v[108:111], v[60:63], a[140:143]
  ds_read_b128 a[236:239], v11 offset:0
  v_add_f32 v31, v31, v47
  v_cvt_pk_bf16_f32 v59, v46, v47
  v_mfma_f32_16x16x32_bf16 a[144:147], v[112:115], v[60:63], a[144:147]
  v_exp_f32 v48, v48
  v_mfma_f32_16x16x32_bf16 a[148:151], v[116:119], v[60:63], a[148:151]
  ds_read_b128 a[252:255], v11 offset:4096
  v_add_f32 v32, v32, v48
  v_mfma_f32_16x16x32_bf16 a[152:155], v[120:123], v[60:63], a[152:155]
  v_exp_f32 v49, v49
  v_mfma_f32_16x16x32_bf16 a[156:159], v[124:127], v[60:63], a[156:159]
  s_waitcnt lgkmcnt(7)
  v_add_f32 v32, v32, v49
  v_cvt_pk_bf16_f32 v60, v48, v49
  v_mfma_f32_16x16x32_bf16 v[40:43], a[224:227], v[128:131], v[64:67]
  s_waitcnt lgkmcnt(6)
  v_exp_f32 v50, v50
  v_mfma_f32_16x16x32_bf16 v[44:47], a[240:243], v[128:131], v[64:67]
  s_waitcnt lgkmcnt(5)
  v_add_f32 v32, v32, v50
  v_mfma_f32_16x16x32_bf16 v[40:43], a[228:231], v[132:135], v[40:43]
  s_waitcnt lgkmcnt(4)
  v_exp_f32 v51, v51
  v_mfma_f32_16x16x32_bf16 v[44:47], a[244:247], v[132:135], v[44:47]
  s_waitcnt lgkmcnt(3)
  v_add_f32 v32, v32, v51
  v_cvt_pk_bf16_f32 v61, v50, v51
  v_mfma_f32_16x16x32_bf16 v[40:43], a[232:235], v[136:139], v[40:43]
  s_waitcnt lgkmcnt(2)
  v_exp_f32 v52, v52
  v_mfma_f32_16x16x32_bf16 v[44:47], a[248:251], v[136:139], v[44:47]
  s_waitcnt lgkmcnt(1)
  global_load_lds_dwordx4 v20, s[12:13] offset:0 nt
  v_add_f32 v32, v32, v52
  v_mfma_f32_16x16x32_bf16 v[40:43], a[236:239], v[140:143], v[40:43]
  s_waitcnt lgkmcnt(0)
  v_exp_f32 v53, v53
  v_mfma_f32_16x16x32_bf16 v[44:47], a[252:255], v[140:143], v[44:47]
  v_add_f32 v32, v32, v53
  v_cvt_pk_bf16_f32 v62, v52, v53
  v_mfma_f32_16x16x32_bf16 a[160:163], v[96:99], v[56:59], a[160:163]
  v_exp_f32 v54, v54
  v_mfma_f32_16x16x32_bf16 a[164:167], v[100:103], v[56:59], a[164:167]
  global_load_lds_dwordx4 v21, s[12:13] offset:1024 nt
  v_add_f32 v32, v32, v54
  v_mfma_f32_16x16x32_bf16 a[168:171], v[104:107], v[56:59], a[168:171]
  v_exp_f32 v55, v55
  v_mfma_f32_16x16x32_bf16 a[172:175], v[108:111], v[56:59], a[172:175]
  v_add_f32 v32, v32, v55
  v_cvt_pk_bf16_f32 v63, v54, v55
  v_mfma_f32_16x16x32_bf16 a[176:179], v[112:115], v[56:59], a[176:179]
  v_exp_f32 v40, v40
  v_mfma_f32_16x16x32_bf16 a[180:183], v[116:119], v[56:59], a[180:183]
  v_add_f32 v26, v26, v40
  v_mfma_f32_16x16x32_bf16 a[184:187], v[120:123], v[56:59], a[184:187]
  v_exp_f32 v41, v41
  v_mfma_f32_16x16x32_bf16 a[188:191], v[124:127], v[56:59], a[188:191]
  v_add_f32 v26, v26, v41
  v_cvt_pk_bf16_f32 v56, v40, v41
  v_mfma_f32_16x16x32_bf16 v[48:51], a[224:227], v[144:147], v[68:71]
  v_exp_f32 v42, v42
  v_mfma_f32_16x16x32_bf16 v[52:55], a[240:243], v[144:147], v[68:71]
  v_add_f32 v26, v26, v42
  v_mfma_f32_16x16x32_bf16 v[48:51], a[228:231], v[148:151], v[48:51]
  v_exp_f32 v43, v43
  v_mfma_f32_16x16x32_bf16 v[52:55], a[244:247], v[148:151], v[52:55]
  v_add_f32 v26, v26, v43
  v_cvt_pk_bf16_f32 v57, v42, v43
  v_mfma_f32_16x16x32_bf16 v[48:51], a[232:235], v[152:155], v[48:51]
  v_exp_f32 v44, v44
  v_mfma_f32_16x16x32_bf16 v[52:55], a[248:251], v[152:155], v[52:55]
  global_load_lds_dwordx4 v22, s[12:13] offset:2048 nt
  v_add_f32 v26, v26, v44
  v_mfma_f32_16x16x32_bf16 v[48:51], a[236:239], v[156:159], v[48:51]
  v_exp_f32 v45, v45
  v_mfma_f32_16x16x32_bf16 v[52:55], a[252:255], v[156:159], v[52:55]
  v_add_f32 v26, v26, v45
  v_cvt_pk_bf16_f32 v58, v44, v45
  v_mfma_f32_16x16x32_bf16 a[192:195], v[96:99], v[60:63], a[192:195]
  v_exp_f32 v46, v46
  v_mfma_f32_16x16x32_bf16 a[196:199], v[100:103], v[60:63], a[196:199]
  ds_read_b64_tr_b16 v[96:97], v12 offset:0
  ds_read_b64_tr_b16 v[98:99], v12 offset:4096
  global_load_lds_dwordx4 v23, s[12:13] offset:3072 nt
  v_add_f32 v26, v26, v46
  v_mfma_f32_16x16x32_bf16 a[200:203], v[104:107], v[60:63], a[200:203]
  ds_read_b64_tr_b16 v[100:101], v13 offset:0
  s_add_u32 m0, s30, 0x4000
  v_exp_f32 v47, v47
  v_mfma_f32_16x16x32_bf16 a[204:207], v[108:111], v[60:63], a[204:207]
  ds_read_b64_tr_b16 v[102:103], v13 offset:4096
  ds_read_b64_tr_b16 v[104:105], v14 offset:0
  v_add_f32 v26, v26, v47
  v_cvt_pk_bf16_f32 v59, v46, v47
  v_mfma_f32_16x16x32_bf16 a[208:211], v[112:115], v[60:63], a[208:211]
  ds_read_b64_tr_b16 v[106:107], v14 offset:4096
  v_exp_f32 v48, v48
  v_mfma_f32_16x16x32_bf16 a[212:215], v[116:119], v[60:63], a[212:215]
  ds_read_b64_tr_b16 v[108:109], v15 offset:0
  ds_read_b64_tr_b16 v[110:111], v15 offset:4096
  v_add_f32 v27, v27, v48
  v_mfma_f32_16x16x32_bf16 a[216:219], v[120:123], v[60:63], a[216:219]
  ds_read_b64_tr_b16 v[112:113], v16 offset:0
  v_exp_f32 v49, v49
  v_mfma_f32_16x16x32_bf16 a[220:223], v[124:127], v[60:63], a[220:223]
  ds_read_b64_tr_b16 v[114:115], v16 offset:4096
  ds_read_b64_tr_b16 v[116:117], v17 offset:0
  v_add_f32 v27, v27, v49
  v_cvt_pk_bf16_f32 v60, v48, v49
  s_add_u32 s47, s47, 1
  s_cmp_lt_u32 s47, 6
  s_cbranch_scc1 L_loop
L_pen:
  v_mfma_f32_16x16x32_bf16 v[40:43], a[224:227], v[160:163], v[72:75]
  ds_read_b64_tr_b16 v[118:119], v17 offset:4096
  v_exp_f32 v50, v50
  v_mfma_f32_16x16x32_bf16 v[44:47], a[240:243], v[160:163], v[72:75]
  ds_read_b64_tr_b16 v[120:121], v18 offset:0
  ds_read_b64_tr_b16 v[122:123], v18 offset:4096
  v_add_f32 v27, v27, v50
  v_mfma_f32_16x16x32_bf16 v[40:43], a[228:231], v[164:167], v[40:43]
  ds_read_b64_tr_b16 v[124:125], v19 offset:0
  v_exp_f32 v51, v51
  v_mfma_f32_16x16x32_bf16 v[44:47], a[244:247], v[164:167], v[44:47]
  v_add_f32 v27, v27, v51
  v_cvt_pk_bf16_f32 v61, v50, v51
  v_mfma_f32_16x16x32_bf16 v[40:43], a[232:235], v[168:171], v[40:43]
  v_exp_f32 v52, v52
  v_mfma_f32_16x16x32_bf16 v[44:47], a[248:251], v[168:171], v[44:47]
  ds_read_b64_tr_b16 v[126:127], v19 offset:4096
  global_load_lds_dwordx4 v24, s[16:17] offset:0 nt
  v_add_f32 v27, v27, v52
  v_mfma_f32_16x16x32_bf16 v[40:43], a[236:239], v[172:175], v[40:43]
  v_exp_f32 v53, v53
  v_mfma_f32_16x16x32_bf16 v[44:47], a[252:255], v[172:175], v[44:47]
  s_waitcnt lgkmcnt(14)
  v_add_f32 v27, v27, v53
  v_cvt_pk_bf16_f32 v62, v52, v53
  v_mfma_f32_16x16x32_bf16 a[0:3], v[96:99], v[56:59], a[0:3]
  s_waitcnt lgkmcnt(12)
  v_exp_f32 v54, v54
  v_mfma_f32_16x16x32_bf16 a[4:7], v[100:103], v[56:59], a[4:7]
  s_waitcnt lgkmcnt(10)
  global_load_lds_dwordx4 v25, s[16:17] offset:1024 nt
  v_add_f32 v27, v27, v54
  v_mfma_f32_16x16x32_bf16 a[8:11], v[104:107], v[56:59], a[8:11]
  s_waitcnt lgkmcnt(8)
  v_exp_f32 v55, v55
  v_mfma_f32_16x16x32_bf16 a[12:15], v[108:111], v[56:59], a[12:15]
  s_waitcnt lgkmcnt(6)
  v_add_f32 v27, v27, v55
  v_cvt_pk_bf16_f32 v63, v54, v55
  v_mfma_f32_16x16x32_bf16 a[16:19], v[112:115], v[56:59], a[16:19]
  s_waitcnt lgkmcnt(4)
  v_exp_f32 v40, v40
  v_mfma_f32_16x16x32_bf16 a[20:23], v[116:119], v[56:59], a[20:23]
  s_waitcnt lgkmcnt(2)
  v_add_f32 v28, v28, v40
  v_mfma_f32_16x16x32_bf16 a[24:27], v[120:123], v[56:59], a[24:27]
  s_waitcnt lgkmcnt(0)
  v_exp_f32 v41, v41
  v_mfma_f32_16x16x32_bf16 a[28:31], v[124:127], v[56:59], a[28:31]
  v_add_f32 v28, v28, v41
  v_cvt_pk_bf16_f32 v56, v40, v41
  v_mfma_f32_16x16x32_bf16 v[48:51], a[224:227], v[176:179], v[76:79]
  v_exp_f32 v42, v42
  v_mfma_f32_16x16x32_bf16 v[52:55], a[240:243], v[176:179], v[76:79]
  v_add_f32 v28, v28, v42
  v_mfma_f32_16x16x32_bf16 v[48:51], a[228:231], v[180:183], v[48:51]
  v_exp_f32 v43, v43
  v_mfma_f32_16x16x32_bf16 v[52:55], a[244:247], v[180:183], v[52:55]
  v_add_f32 v28, v28, v43
  v_cvt_pk_bf16_f32 v57, v42, v43
  v_mfma_f32_16x16x32_bf16 v[48:51], a[232:235], v[184:187], v[48:51]
  v_exp_f32 v44, v44
  v_mfma_f32_16x16x32_bf16 v[52:55], a[248:251], v[184:187], v[52:55]
  global_load_lds_dwordx4 v24, s[16:17] offset:2048 nt
  v_add_f32 v28, v28, v44
  v_mfma_f32_16x16x32_bf16 v[48:51], a[236:239], v[188:191], v[48:51]
  v_exp_f32 v45, v45
  v_mfma_f32_16x16x32_bf16 v[52:55], a[252:255], v[188:191], v[52:55]
  v_add_f32 v28, v28, v45
  v_cvt_pk_bf16_f32 v58, v44, v45
  v_mfma_f32_16x16x32_bf16 a[32:35], v[96:99], v[60:63], a[32:35]
  v_exp_f32 v46, v46
  v_mfma_f32_16x16x32_bf16 a[36:39], v[100:103], v[60:63], a[36:39]
  global_load_lds_dwordx4 v25, s[16:17] offset:3072 nt
  v_add_f32 v28, v28, v46
  v_mfma_f32_16x16x32_bf16 a[40:43], v[104:107], v[60:63], a[40:43]
  s_add_u32 s28, s28, 0x8000
  s_and_b32 s28, s28, 0x1ffff
  v_exp_f32 v47, v47
  v_mfma_f32_16x16x32_bf16 a[44:47], v[108:111], v[60:63], a[44:47]
  s_add_u32 s30, s28, s29
  s_mov_b32 m0, s30
  v_add_f32 v28, v28, v47
  v_cvt_pk_bf16_f32 v59, v46, v47
  v_mfma_f32_16x16x32_bf16 a[48:51], v[112:115], v[60:63], a[48:51]
  s_add_u32 s24, s24, 0x4000
  s_and_b32 s24, s24, 0x3ffff
  v_exp_f32 v48, v48
  v_mfma_f32_16x16x32_bf16 a[52:55], v[116:119], v[60:63], a[52:55]
  s_add_u32 s12, s50, s24
  s_addc_u32 s13, s51, 0
  v_add_f32 v29, v29, v48
  v_mfma_f32_16x16x32_bf16 a[56:59], v[120:123], v[60:63], a[56:59]
  s_add_u32 s16, s52, s24
  s_addc_u32 s17, s53, 0
  v_exp_f32 v49, v49
  v_mfma_f32_16x16x32_bf16 a[60:63], v[124:127], v[60:63], a[60:63]
  v_add_f32 v29, v29, v49
  v_cvt_pk_bf16_f32 v60, v48, v49
  v_mfma_f32_16x16x32_bf16 v[40:43], a[224:227], v[192:195], v[80:83]
  v_exp_f32 v50, v50
  v_mfma_f32_16x16x32_bf16 v[44:47], a[240:243], v[192:195], v[80:83]
  v_add_f32 v29, v29, v50
  v_mfma_f32_16x16x32_bf16 v[40:43], a[228:231], v[196:199], v[40:43]
  v_exp_f32 v51, v51
  v_mfma_f32_16x16x32_bf16 v[44:47], a[244:247], v[196:199], v[44:47]
  v_add_f32 v29, v29, v51
  v_cvt_pk_bf16_f32 v61, v50, v51
  v_mfma_f32_16x16x32_bf16 v[40:43], a[232:235], v[200:203], v[40:43]
  v_exp_f32 v52, v52
  v_mfma_f32_16x16x32_bf16 v[44:47], a[248:251], v[200:203], v[44:47]
  v_add_f32 v29, v29, v52
  v_mfma_f32_16x16x32_bf16 v[40:43], a[236:239], v[204:207], v[40:43]
  v_exp_f32 v53, v53
  v_mfma_f32_16x16x32_bf16 v[44:47], a[252:255], v[204:207], v[44:47]
  v_add_f32 v29, v29, v53
  v_cvt_pk_bf16_f32 v62, v52, v53
  v_mfma_f32_16x16x32_bf16 a[64:67], v[96:99], v[56:59], a[64:67]
  v_exp_f32 v54, v54
  v_mfma_f32_16x16x32_bf16 a[68:71], v[100:103], v[56:59], a[68:71]
  v_add_f32 v29, v29, v54
  v_mfma_f32_16x16x32_bf16 a[72:75], v[104:107], v[56:59], a[72:75]
  v_exp_f32 v55, v55
  v_mfma_f32_16x16x32_bf16 a[76:79], v[108:111], v[56:59], a[76:79]
  v_add_f32 v29, v29, v55
  v_cvt_pk_bf16_f32 v63, v54, v55
  v_mfma_f32_16x16x32_bf16 a[80:83], v[112:115], v[56:59], a[80:83]
  v_exp_f32 v40, v40
  v_mfma_f32_16x16x32_bf16 a[84:87], v[116:119], v[56:59], a[84:87]
  v_add_f32 v30, v30, v40
  v_mfma_f32_16x16x32_bf16 a[88:91], v[120:123], v[56:59], a[88:91]
  v_exp_f32 v41, v41
  v_mfma_f32_16x16x32_bf16 a[92:95], v[124:127], v[56:59], a[92:95]
  v_add_f32 v30, v30, v41
  v_cvt_pk_bf16_f32 v56, v40, v41
  v_mfma_f32_16x16x32_bf16 v[48:51], a[224:227], v[208:211], v[84:87]
  v_exp_f32 v42, v42
  v_mfma_f32_16x16x32_bf16 v[52:55], a[240:243], v[208:211], v[84:87]
  v_add_f32 v30, v30, v42
  v_mfma_f32_16x16x32_bf16 v[48:51], a[228:231], v[212:215], v[48:51]
  v_exp_f32 v43, v43
  v_mfma_f32_16x16x32_bf16 v[52:55], a[244:247], v[212:215], v[52:55]
  v_add_f32 v30, v30, v43
  v_cvt_pk_bf16_f32 v57, v42, v43
  v_mfma_f32_16x16x32_bf16 v[48:51], a[232:235], v[216:219], v[48:51]
  v_exp_f32 v44, v44
  v_mfma_f32_16x16x32_bf16 v[52:55], a[248:251], v[216:219], v[52:55]
  v_add_f32 v30, v30, v44
  v_mfma_f32_16x16x32_bf16 v[48:51], a[236:239], v[220:223], v[48:51]
  v_exp_f32 v45, v45
  v_mfma_f32_16x16x32_bf16 v[52:55], a[252:255], v[220:223], v[52:55]
  v_add_f32 v30, v30, v45
  v_cvt_pk_bf16_f32 v58, v44, v45
  v_mfma_f32_16x16x32_bf16 a[96:99], v[96:99], v[60:63], a[96:99]
  v_exp_f32 v46, v46
  v_mfma_f32_16x16x32_bf16 a[100:103], v[100:103], v[60:63], a[100:103]
  v_add_f32 v30, v30, v46
  v_mfma_f32_16x16x32_bf16 a[104:107], v[104:107], v[60:63], a[104:107]
  v_exp_f32 v47, v47
  v_mfma_f32_16x16x32_bf16 a[108:111], v[108:111], v[60:63], a[108:111]
  v_add_f32 v30, v30, v47
  v_cvt_pk_bf16_f32 v59, v46, v47
  v_mfma_f32_16x16x32_bf16 a[112:115], v[112:115], v[60:63], a[112:115]
  v_exp_f32 v48, v48
  v_mfma_f32_16x16x32_bf16 a[116:119], v[116:119], v[60:63], a[116:119]
  v_add_f32 v31, v31, v48
  v_mfma_f32_16x16x32_bf16 a[120:123], v[120:123], v[60:63], a[120:123]
  v_exp_f32 v49, v49
  v_mfma_f32_16x16x32_bf16 a[124:127], v[124:127], v[60:63], a[124:127]
  v_add_f32 v31, v31, v49
  v_cvt_pk_bf16_f32 v60, v48, v49
  s_waitcnt vmcnt(16)
  s_barrier
  v_mfma_f32_16x16x32_bf16 v[40:43], a[224:227], v[224:227], v[88:91]
  v_exp_f32 v50, v50
  v_mfma_f32_16x16x32_bf16 v[44:47], a[240:243], v[224:227], v[88:91]
  ds_read_b128 a[224:227], v8 offset:32768
  v_add_f32 v31, v31, v50
  v_mfma_f32_16x16x32_bf16 v[40:43], a[228:231], v[228:231], v[40:43]
  ds_read_b128 a[240:243], v8 offset:36864
  v_exp_f32 v51, v51
  v_mfma_f32_16x16x32_bf16 v[44:47], a[244:247], v[228:231], v[44:47]
  ds_read_b128 a[228:231], v9 offset:32768
  v_add_f32 v31, v31, v51
  v_cvt_pk_bf16_f32 v61, v50, v51
  v_mfma_f32_16x16x32_bf16 v[40:43], a[232:235], v[232:235], v[40:43]
  v_exp_f32 v52, v52
  v_mfma_f32_16x16x32_bf16 v[44:47], a[248:251], v[232:235], v[44:47]
  ds_read_b128 a[244:247], v9 offset:36864
  v_add_f32 v31, v31, v52
  v_mfma_f32_16x16x32_bf16 v[40:43], a[236:239], v[236:239], v[40:43]
  v_exp_f32 v53, v53
  v_mfma_f32_16x16x32_bf16 v[44:47], a[252:255], v[236:239], v[44:47]
  ds_read_b128 a[232:235], v10 offset:32768
  v_add_f32 v31, v31, v53
  v_cvt_pk_bf16_f32 v62, v52, v53
  v_mfma_f32_16x16x32_bf16 a[128:131], v[96:99], v[56:59], a[128:131]
  v_exp_f32 v54, v54
  v_mfma_f32_16x16x32_bf16 a[132:135], v[100:103], v[56:59], a[132:135]
  ds_read_b128 a[248:251], v10 offset:36864
  v_add_f32 v31, v31, v54
  v_mfma_f32_16x16x32_bf16 a[136:139], v[104:107], v[56:59], a[136:139]
  v_exp_f32 v55, v55
  v_mfma_f32_16x16x32_bf16 a[140:143], v[108:111], v[56:59], a[140:143]
  ds_read_b128 a[236:239], v11 offset:32768
  v_add_f32 v31, v31, v55
  v_cvt_pk_bf16_f32 v63, v54, v55
  v_mfma_f32_16x16x32_bf16 a[144:147], v[112:115], v[56:59], a[144:147]
  v_exp_f32 v40, v40
  v_mfma_f32_16x16x32_bf16 a[148:151], v[116:119], v[56:59], a[148:151]
  ds_read_b128 a[252:255], v11 offset:36864
  v_add_f32 v32, v32, v40
  v_mfma_f32_16x16x32_bf16 a[152:155], v[120:123], v[56:59], a[152:155]
  v_exp_f32 v41, v41
  v_mfma_f32_16x16x32_bf16 a[156:159], v[124:127], v[56:59], a[156:159]
  s_waitcnt lgkmcnt(7)
  v_add_f32 v32, v32, v41
  v_cvt_pk_bf16_f32 v56, v40, v41
  v_mfma_f32_16x16x32_bf16 v[48:51], a[224:227], v[128:131], v[64:67]
  s_waitcnt lgkmcnt(6)
  v_exp_f32 v42, v42
  v_mfma_f32_16x16x32_bf16 v[52:55], a[240:243], v[128:131], v[64:67]
  s_waitcnt lgkmcnt(5)
  v_add_f32 v32, v32, v42
  v_mfma_f32_16x16x32_bf16 v[48:51], a[228:231], v[132:135], v[48:51]
  s_waitcnt lgkmcnt(4)
  v_exp_f32 v43, v43
  v_mfma_f32_16x16x32_bf16 v[52:55], a[244:247], v[132:135], v[52:55]
  s_waitcnt lgkmcnt(3)
  v_add_f32 v32, v32, v43
  v_cvt_pk_bf16_f32 v57, v42, v43
  v_mfma_f32_16x16x32_bf16 v[48:51], a[232:235], v[136:139], v[48:51]
  s_waitcnt lgkmcnt(2)
  v_exp_f32 v44, v44
  v_mfma_f32_16x16x32_bf16 v[52:55], a[248:251], v[136:139], v[52:55]
  s_waitcnt lgkmcnt(1)
  v_add_f32 v32, v32, v44
  v_mfma_f32_16x16x32_bf16 v[48:51], a[236:239], v[140:143], v[48:51]
  s_waitcnt lgkmcnt(0)
  v_exp_f32 v45, v45
  v_mfma_f32_16x16x32_bf16 v[52:55], a[252:255], v[140:143], v[52:55]
  v_add_f32 v32, v32, v45
  v_cvt_pk_bf16_f32 v58, v44, v45
  v_mfma_f32_16x16x32_bf16 a[160:163], v[96:99], v[60:63], a[160:163]
  v_exp_f32 v46, v46
  v_mfma_f32_16x16x32_bf16 a[164:167], v[100:103], v[60:63], a[164:167]
  v_add_f32 v32, v32, v46
  v_mfma_f32_16x16x32_bf16 a[168:171], v[104:107], v[60:63], a[168:171]
  v_exp_f32 v47, v47
  v_mfma_f32_16x16x32_bf16 a[172:175], v[108:111], v[60:63], a[172:175]
  v_add_f32 v32, v32, v47
  v_cvt_pk_bf16_f32 v59, v46, v47
  v_mfma_f32_16x16x32_bf16 a[176:179], v[112:115], v[60:63], a[176:179]
  v_exp_f32 v48, v48
  v_mfma_f32_16x16x32_bf16 a[180:183], v[116:119], v[60:63], a[180:183]
  v_add_f32 v26, v26, v48
  v_mfma_f32_16x16x32_bf16 a[184:187], v[120:123], v[60:63], a[184:187]
  v_exp_f32 v49, v49
  v_mfma_f32_16x16x32_bf16 a[188:191], v[124:127], v[60:63], a[188:191]
  v_add_f32 v26, v26, v49
  v_cvt_pk_bf16_f32 v60, v48, v49
  v_mfma_f32_16x16x32_bf16 v[40:43], a[224:227], v[144:147], v[68:71]
  v_exp_f32 v50, v50
  v_mfma_f32_16x16x32_bf16 v[44:47], a[240:243], v[144:147], v[68:71]
  global_load_dwordx2 v[244:245], v241, s[84:85] sc1
  v_add_f32 v26, v26, v50
  v_mfma_f32_16x16x32_bf16 v[40:43], a[228:231], v[148:151], v[40:43]
  v_exp_f32 v51, v51
  v_mfma_f32_16x16x32_bf16 v[44:47], a[244:247], v[148:151], v[44:47]
  v_add_f32 v26, v26, v51
  v_cvt_pk_bf16_f32 v61, v50, v51
  v_mfma_f32_16x16x32_bf16 v[40:43], a[232:235], v[152:155], v[40:43]
  v_exp_f32 v52, v52
  v_mfma_f32_16x16x32_bf16 v[44:47], a[248:251], v[152:155], v[44:47]
  v_add_f32 v26, v26, v52
  v_mfma_f32_16x16x32_bf16 v[40:43], a[236:239], v[156:159], v[40:43]
  v_exp_f32 v53, v53
  v_mfma_f32_16x16x32_bf16 v[44:47], a[252:255], v[156:159], v[44:47]
  v_add_f32 v26, v26, v53
  v_cvt_pk_bf16_f32 v62, v52, v53
  v_mfma_f32_16x16x32_bf16 a[192:195], v[96:99], v[56:59], a[192:195]
  v_exp_f32 v54, v54
  v_mfma_f32_16x16x32_bf16 a[196:199], v[100:103], v[56:59], a[196:199]
  ds_read_b64_tr_b16 v[96:97], v12 offset:32768
  ds_read_b64_tr_b16 v[98:99], v12 offset:36864
  v_add_f32 v26, v26, v54
  v_mfma_f32_16x16x32_bf16 a[200:203], v[104:107], v[56:59], a[200:203]
  ds_read_b64_tr_b16 v[100:101], v13 offset:32768
  v_exp_f32 v55, v55
  v_mfma_f32_16x16x32_bf16 a[204:207], v[108:111], v[56:59], a[204:207]
  ds_read_b64_tr_b16 v[102:103], v13 offset:36864
  ds_read_b64_tr_b16 v[104:105], v14 offset:32768
  v_add_f32 v26, v26, v55
  v_cvt_pk_bf16_f32 v63, v54, v55
  v_mfma_f32_16x16x32_bf16 a[208:211], v[112:115], v[56:59], a[208:211]
  ds_read_b64_tr_b16 v[106:107], v14 offset:36864
  v_exp_f32 v40, v40
  v_mfma_f32_16x16x32_bf16 a[212:215], v[116:119], v[56:59], a[212:215]
  ds_read_b64_tr_b16 v[108:109], v15 offset:32768
  ds_read_b64_tr_b16 v[110:111], v15 offset:36864
  v_add_f32 v27, v27, v40
  v_mfma_f32_16x16x32_bf16 a[216:219], v[120:123], v[56:59], a[216:219]
  ds_read_b64_tr_b16 v[112:113], v16 offset:32768
  v_exp_f32 v41, v41
  v_mfma_f32_16x16x32_bf16 a[220:223], v[124:127], v[56:59], a[220:223]
  ds_read_b64_tr_b16 v[114:115], v16 offset:36864
  ds_read_b64_tr_b16 v[116:117], v17 offset:32768
  v_add_f32 v27, v27, v41
  v_cvt_pk_bf16_f32 v56, v40, v41
  v_mfma_f32_16x16x32_bf16 v[48:51], a[224:227], v[160:163], v[72:75]
  ds_read_b64_tr_b16 v[118:119], v17 offset:36864
  v_exp_f32 v42, v42
  v_mfma_f32_16x16x32_bf16 v[52:55], a[240:243], v[160:163], v[72:75]
  ds_read_b64_tr_b16 v[120:121], v18 offset:32768
  ds_read_b64_tr_b16 v[122:123], v18 offset:36864
  v_add_f32 v27, v27, v42
  v_mfma_f32_16x16x32_bf16 v[48:51], a[228:231], v[164:167], v[48:51]
  ds_read_b64_tr_b16 v[124:125], v19 offset:32768
  v_exp_f32 v43, v43
  v_mfma_f32_16x16x32_bf16 v[52:55], a[244:247], v[164:167], v[52:55]
  v_add_f32 v27, v27, v43
  v_cvt_pk_bf16_f32 v57, v42, v43
  v_mfma_f32_16x16x32_bf16 v[48:51], a[232:235], v[168:171], v[48:51]
  v_exp_f32 v44, v44
  v_mfma_f32_16x16x32_bf16 v[52:55], a[248:251], v[168:171], v[52:55]
  ds_read_b64_tr_b16 v[126:127], v19 offset:36864
  v_add_f32 v27, v27, v44
  v_mfma_f32_16x16x32_bf16 v[48:51], a[236:239], v[172:175], v[48:51]
  v_exp_f32 v45, v45
  v_mfma_f32_16x16x32_bf16 v[52:55], a[252:255], v[172:175], v[52:55]
  s_waitcnt lgkmcnt(14)
  v_add_f32 v27, v27, v45
  v_cvt_pk_bf16_f32 v58, v44, v45
  v_mfma_f32_16x16x32_bf16 a[0:3], v[96:99], v[60:63], a[0:3]
  s_waitcnt lgkmcnt(12)
  v_exp_f32 v46, v46
  v_mfma_f32_16x16x32_bf16 a[4:7], v[100:103], v[60:63], a[4:7]
  s_waitcnt lgkmcnt(10)
  v_add_f32 v27, v27, v46
  v_mfma_f32_16x16x32_bf16 a[8:11], v[104:107], v[60:63], a[8:11]
  s_waitcnt lgkmcnt(8)
  v_exp_f32 v47, v47
  v_mfma_f32_16x16x32_bf16 a[12:15], v[108:111], v[60:63], a[12:15]
  s_waitcnt lgkmcnt(6)
  v_add_f32 v27, v27, v47
  v_cvt_pk_bf16_f32 v59, v46, v47
  v_mfma_f32_16x16x32_bf16 a[16:19], v[112:115], v[60:63], a[16:19]
  s_waitcnt lgkmcnt(4)
  v_exp_f32 v48, v48
  v_mfma_f32_16x16x32_bf16 a[20:23], v[116:119], v[60:63], a[20:23]
  s_waitcnt lgkmcnt(2)
  v_add_f32 v28, v28, v48
  v_mfma_f32_16x16x32_bf16 a[24:27], v[120:123], v[60:63], a[24:27]
  s_waitcnt lgkmcnt(0)
  v_exp_f32 v49, v49
  v_mfma_f32_16x16x32_bf16 a[28:31], v[124:127], v[60:63], a[28:31]
  v_add_f32 v28, v28, v49
  v_cvt_pk_bf16_f32 v60, v48, v49
  v_mfma_f32_16x16x32_bf16 v[40:43], a[224:227], v[176:179], v[76:79]
  v_exp_f32 v50, v50
  v_mfma_f32_16x16x32_bf16 v[44:47], a[240:243], v[176:179], v[76:79]
  v_add_f32 v28, v28, v50
  v_xor_b32 v8, 0x10000, v8
  v_mfma_f32_16x16x32_bf16 v[40:43], a[228:231], v[180:183], v[40:43]
  v_exp_f32 v51, v51
  v_mfma_f32_16x16x32_bf16 v[44:47], a[244:247], v[180:183], v[44:47]
  v_add_f32 v28, v28, v51
  v_cvt_pk_bf16_f32 v61, v50, v51
  v_mfma_f32_16x16x32_bf16 v[40:43], a[232:235], v[184:187], v[40:43]
  v_exp_f32 v52, v52
  v_mfma_f32_16x16x32_bf16 v[44:47], a[248:251], v[184:187], v[44:47]
  v_add_f32 v28, v28, v52
  v_xor_b32 v9, 0x10000, v9
  v_mfma_f32_16x16x32_bf16 v[40:43], a[236:239], v[188:191], v[40:43]
  v_exp_f32 v53, v53
  v_mfma_f32_16x16x32_bf16 v[44:47], a[252:255], v[188:191], v[44:47]
  v_add_f32 v28, v28, v53
  v_cvt_pk_bf16_f32 v62, v52, v53
  v_mfma_f32_16x16x32_bf16 a[32:35], v[96:99], v[56:59], a[32:35]
  v_exp_f32 v54, v54
  v_mfma_f32_16x16x32_bf16 a[36:39], v[100:103], v[56:59], a[36:39]
  v_add_f32 v28, v28, v54
  v_xor_b32 v10, 0x10000, v10
  v_mfma_f32_16x16x32_bf16 a[40:43], v[104:107], v[56:59], a[40:43]
  v_exp_f32 v55, v55
  v_mfma_f32_16x16x32_bf16 a[44:47], v[108:111], v[56:59], a[44:47]
  v_add_f32 v28, v28, v55
  v_cvt_pk_bf16_f32 v63, v54, v55
  v_mfma_f32_16x16x32_bf16 a[48:51], v[112:115], v[56:59], a[48:51]
  v_exp_f32 v40, v40
  v_mfma_f32_16x16x32_bf16 a[52:55], v[116:119], v[56:59], a[52:55]
  v_add_f32 v29, v29, v40
  v_xor_b32 v11, 0x10000, v11
  v_mfma_f32_16x16x32_bf16 a[56:59], v[120:123], v[56:59], a[56:59]
  v_exp_f32 v41, v41
  v_mfma_f32_16x16x32_bf16 a[60:63], v[124:127], v[56:59], a[60:63]
  v_add_f32 v29, v29, v41
  v_cvt_pk_bf16_f32 v56, v40, v41
  v_mfma_f32_16x16x32_bf16 v[48:51], a[224:227], v[192:195], v[80:83]
  v_exp_f32 v42, v42
  v_mfma_f32_16x16x32_bf16 v[52:55], a[240:243], v[192:195], v[80:83]
  v_add_f32 v29, v29, v42
  v_xor_b32 v12, 0x10000, v12
  v_mfma_f32_16x16x32_bf16 v[48:51], a[228:231], v[196:199], v[48:51]
  v_exp_f32 v43, v43
  v_mfma_f32_16x16x32_bf16 v[52:55], a[244:247], v[196:199], v[52:55]
  v_add_f32 v29, v29, v43
  v_cvt_pk_bf16_f32 v57, v42, v43
  v_mfma_f32_16x16x32_bf16 v[48:51], a[232:235], v[200:203], v[48:51]
  v_exp_f32 v44, v44
  v_mfma_f32_16x16x32_bf16 v[52:55], a[248:251], v[200:203], v[52:55]
  v_add_f32 v29, v29, v44
  v_xor_b32 v13, 0x10000, v13
  v_mfma_f32_16x16x32_bf16 v[48:51], a[236:239], v[204:207], v[48:51]
  v_exp_f32 v45, v45
  v_mfma_f32_16x16x32_bf16 v[52:55], a[252:255], v[204:207], v[52:55]
  v_add_f32 v29, v29, v45
  v_cvt_pk_bf16_f32 v58, v44, v45
  v_mfma_f32_16x16x32_bf16 a[64:67], v[96:99], v[60:63], a[64:67]
  v_exp_f32 v46, v46
  v_mfma_f32_16x16x32_bf16 a[68:71], v[100:103], v[60:63], a[68:71]
  v_add_f32 v29, v29, v46
  v_xor_b32 v14, 0x10000, v14
  v_mfma_f32_16x16x32_bf16 a[72:75], v[104:107], v[60:63], a[72:75]
  v_exp_f32 v47, v47
  v_mfma_f32_16x16x32_bf16 a[76:79], v[108:111], v[60:63], a[76:79]
  v_add_f32 v29, v29, v47
  v_cvt_pk_bf16_f32 v59, v46, v47
  v_mfma_f32_16x16x32_bf16 a[80:83], v[112:115], v[60:63], a[80:83]
  v_exp_f32 v48, v48
  v_mfma_f32_16x16x32_bf16 a[84:87], v[116:119], v[60:63], a[84:87]
  v_add_f32 v30, v30, v48
  v_xor_b32 v15, 0x10000, v15
  v_mfma_f32_16x16x32_bf16 a[88:91], v[120:123], v[60:63], a[88:91]
  v_exp_f32 v49, v49
  v_mfma_f32_16x16x32_bf16 a[92:95], v[124:127], v[60:63], a[92:95]
  v_add_f32 v30, v30, v49
  v_cvt_pk_bf16_f32 v60, v48, v49
  v_mfma_f32_16x16x32_bf16 v[40:43], a[224:227], v[208:211], v[84:87]
  v_exp_f32 v50, v50
  v_mfma_f32_16x16x32_bf16 v[44:47], a[240:243], v[208:211], v[84:87]
  v_add_f32 v30, v30, v50
  v_xor_b32 v16, 0x10000, v16
  v_mfma_f32_16x16x32_bf16 v[40:43], a[228:231], v[212:215], v[40:43]
  v_exp_f32 v51, v51
  v_mfma_f32_16x16x32_bf16 v[44:47], a[244:247], v[212:215], v[44:47]
  v_add_f32 v30, v30, v51
  v_cvt_pk_bf16_f32 v61, v50, v51
  v_mfma_f32_16x16x32_bf16 v[40:43], a[232:235], v[216:219], v[40:43]
  v_exp_f32 v52, v52
  v_mfma_f32_16x16x32_bf16 v[44:47], a[248:251], v[216:219], v[44:47]
  v_add_f32 v30, v30, v52
  v_xor_b32 v17, 0x10000, v17
  v_mfma_f32_16x16x32_bf16 v[40:43], a[236:239], v[220:223], v[40:43]
  v_exp_f32 v53, v53
  v_mfma_f32_16x16x32_bf16 v[44:47], a[252:255], v[220:223], v[44:47]
  v_add_f32 v30, v30, v53
  v_cvt_pk_bf16_f32 v62, v52, v53
  v_mfma_f32_16x16x32_bf16 a[96:99], v[96:99], v[56:59], a[96:99]
  v_exp_f32 v54, v54
  v_mfma_f32_16x16x32_bf16 a[100:103], v[100:103], v[56:59], a[100:103]
  v_add_f32 v30, v30, v54
  v_xor_b32 v18, 0x10000, v18
  v_mfma_f32_16x16x32_bf16 a[104:107], v[104:107], v[56:59], a[104:107]
  v_exp_f32 v55, v55
  v_mfma_f32_16x16x32_bf16 a[108:111], v[108:111], v[56:59], a[108:111]
  v_add_f32 v30, v30, v55
  v_cvt_pk_bf16_f32 v63, v54, v55
  v_mfma_f32_16x16x32_bf16 a[112:115], v[112:115], v[56:59], a[112:115]
  v_exp_f32 v40, v40
  v_mfma_f32_16x16x32_bf16 a[116:119], v[116:119], v[56:59], a[116:119]
  v_add_f32 v31, v31, v40
  v_xor_b32 v19, 0x10000, v19
  v_mfma_f32_16x16x32_bf16 a[120:123], v[120:123], v[56:59], a[120:123]
  v_exp_f32 v41, v41
  v_mfma_f32_16x16x32_bf16 a[124:127], v[124:127], v[56:59], a[124:127]
  v_add_f32 v31, v31, v41
  v_cvt_pk_bf16_f32 v56, v40, v41
  s_waitcnt vmcnt(9)
  s_barrier
  v_mfma_f32_16x16x32_bf16 v[48:51], a[224:227], v[224:227], v[88:91]
  v_exp_f32 v42, v42
  v_mfma_f32_16x16x32_bf16 v[52:55], a[240:243], v[224:227], v[88:91]
  ds_read_b128 a[224:227], v8 offset:0
  v_add_f32 v31, v31, v42
  v_mfma_f32_16x16x32_bf16 v[48:51], a[228:231], v[228:231], v[48:51]
  ds_read_b128 a[240:243], v8 offset:4096
  v_exp_f32 v43, v43
  v_mfma_f32_16x16x32_bf16 v[52:55], a[244:247], v[228:231], v[52:55]
  ds_read_b128 a[228:231], v9 offset:0
  v_add_f32 v31, v31, v43
  v_cvt_pk_bf16_f32 v57, v42, v43
  v_mfma_f32_16x16x32_bf16 v[48:51], a[232:235], v[232:235], v[48:51]
  v_exp_f32 v44, v44
  v_mfma_f32_16x16x32_bf16 v[52:55], a[248:251], v[232:235], v[52:55]
  ds_read_b128 a[244:247], v9 offset:4096
  v_add_f32 v31, v31, v44
  v_mfma_f32_16x16x32_bf16 v[48:51], a[236:239], v[236:239], v[48:51]
  v_exp_f32 v45, v45
  v_mfma_f32_16x16x32_bf16 v[52:55], a[252:255], v[236:239], v[52:55]
  ds_read_b128 a[232:235], v10 offset:0
  v_add_f32 v31, v31, v45
  v_cvt_pk_bf16_f32 v58, v44, v45
  v_mfma_f32_16x16x32_bf16 a[128:131], v[96:99], v[60:63], a[128:131]
  v_exp_f32 v46, v46
  v_mfma_f32_16x16x32_bf16 a[132:135], v[100:103], v[60:63], a[132:135]
  ds_read_b128 a[248:251], v10 offset:4096
  v_add_f32 v31, v31, v46
  v_mfma_f32_16x16x32_bf16 a[136:139], v[104:107], v[60:63], a[136:139]
  v_exp_f32 v47, v47
  v_mfma_f32_16x16x32_bf16 a[140:143], v[108:111], v[60:63], a[140:143]
  ds_read_b128 a[236:239], v11 offset:0
  v_add_f32 v31, v31, v47
  v_cvt_pk_bf16_f32 v59, v46, v47
  v_mfma_f32_16x16x32_bf16 a[144:147], v[112:115], v[60:63], a[144:147]
  v_exp_f32 v48, v48
  v_mfma_f32_16x16x32_bf16 a[148:151], v[116:119], v[60:63], a[148:151]
  ds_read_b128 a[252:255], v11 offset:4096
  v_add_f32 v32, v32, v48
  v_mfma_f32_16x16x32_bf16 a[152:155], v[120:123], v[60:63], a[152:155]
  v_exp_f32 v49, v49
  v_mfma_f32_16x16x32_bf16 a[156:159], v[124:127], v[60:63], a[156:159]
  s_waitcnt lgkmcnt(7)
  v_add_f32 v32, v32, v49
  v_cvt_pk_bf16_f32 v60, v48, v49
  v_mfma_f32_16x16x32_bf16 v[40:43], a[224:227], v[128:131], v[64:67]
  s_waitcnt lgkmcnt(6)
  v_exp_f32 v50, v50
  v_mfma_f32_16x16x32_bf16 v[44:47], a[240:243], v[128:131], v[64:67]
  s_waitcnt lgkmcnt(5)
  v_add_f32 v32, v32, v50
  v_mfma_f32_16x16x32_bf16 v[40:43], a[228:231], v[132:135], v[40:43]
  s_waitcnt lgkmcnt(4)
  v_exp_f32 v51, v51
  v_mfma_f32_16x16x32_bf16 v[44:47], a[244:247], v[132:135], v[44:47]
  s_waitcnt lgkmcnt(3)
  v_add_f32 v32, v32, v51
  v_cvt_pk_bf16_f32 v61, v50, v51
  v_mfma_f32_16x16x32_bf16 v[40:43], a[232:235], v[136:139], v[40:43]
  s_waitcnt lgkmcnt(2)
  v_exp_f32 v52, v52
  v_mfma_f32_16x16x32_bf16 v[44:47], a[248:251], v[136:139], v[44:47]
  s_waitcnt lgkmcnt(1)
  v_add_f32 v32, v32, v52
  v_mfma_f32_16x16x32_bf16 v[40:43], a[236:239], v[140:143], v[40:43]
  s_waitcnt lgkmcnt(0)
  v_exp_f32 v53, v53
  v_mfma_f32_16x16x32_bf16 v[44:47], a[252:255], v[140:143], v[44:47]
  v_add_f32 v32, v32, v53
  v_cvt_pk_bf16_f32 v62, v52, v53
  v_mfma_f32_16x16x32_bf16 a[160:163], v[96:99], v[56:59], a[160:163]
  v_exp_f32 v54, v54
  v_mfma_f32_16x16x32_bf16 a[164:167], v[100:103], v[56:59], a[164:167]
  v_add_f32 v32, v32, v54
  v_mfma_f32_16x16x32_bf16 a[168:171], v[104:107], v[56:59], a[168:171]
  v_exp_f32 v55, v55
  v_mfma_f32_16x16x32_bf16 a[172:175], v[108:111], v[56:59], a[172:175]
  v_add_f32 v32, v32, v55
  v_cvt_pk_bf16_f32 v63, v54, v55
  v_mfma_f32_16x16x32_bf16 a[176:179], v[112:115], v[56:59], a[176:179]
  v_exp_f32 v40, v40
  v_mfma_f32_16x16x32_bf16 a[180:183], v[116:119], v[56:59], a[180:183]
  v_add_f32 v26, v26, v40
  v_mfma_f32_16x16x32_bf16 a[184:187], v[120:123], v[56:59], a[184:187]
  v_exp_f32 v41, v41
  v_mfma_f32_16x16x32_bf16 a[188:191], v[124:127], v[56:59], a[188:191]
  v_add_f32 v26, v26, v41
  v_cvt_pk_bf16_f32 v56, v40, v41
  v_mfma_f32_16x16x32_bf16 v[48:51], a[224:227], v[144:147], v[68:71]
  v_exp_f32 v42, v42
  v_mfma_f32_16x16x32_bf16 v[52:55], a[240:243], v[144:147], v[68:71]
  v_add_f32 v26, v26, v42
  v_mfma_f32_16x16x32_bf16 v[48:51], a[228:231], v[148:151], v[48:51]
  v_exp_f32 v43, v43
  v_mfma_f32_16x16x32_bf16 v[52:55], a[244:247], v[148:151], v[52:55]
  v_add_f32 v26, v26, v43
  v_cvt_pk_bf16_f32 v57, v42, v43
  v_mfma_f32_16x16x32_bf16 v[48:51], a[232:235], v[152:155], v[48:51]
  v_exp_f32 v44, v44
  v_mfma_f32_16x16x32_bf16 v[52:55], a[248:251], v[152:155], v[52:55]
  v_add_f32 v26, v26, v44
  v_mfma_f32_16x16x32_bf16 v[48:51], a[236:239], v[156:159], v[48:51]
  v_exp_f32 v45, v45
  v_mfma_f32_16x16x32_bf16 v[52:55], a[252:255], v[156:159], v[52:55]
  v_add_f32 v26, v26, v45
  v_cvt_pk_bf16_f32 v58, v44, v45
  v_mfma_f32_16x16x32_bf16 a[192:195], v[96:99], v[60:63], a[192:195]
  v_exp_f32 v46, v46
  v_mfma_f32_16x16x32_bf16 a[196:199], v[100:103], v[60:63], a[196:199]
  ds_read_b64_tr_b16 v[96:97], v12 offset:0
  ds_read_b64_tr_b16 v[98:99], v12 offset:4096
  v_add_f32 v26, v26, v46
  v_mfma_f32_16x16x32_bf16 a[200:203], v[104:107], v[60:63], a[200:203]
  ds_read_b64_tr_b16 v[100:101], v13 offset:0
  v_exp_f32 v47, v47
  v_mfma_f32_16x16x32_bf16 a[204:207], v[108:111], v[60:63], a[204:207]
  ds_read_b64_tr_b16 v[102:103], v13 offset:4096
  ds_read_b64_tr_b16 v[104:105], v14 offset:0
  v_add_f32 v26, v26, v47
  v_cvt_pk_bf16_f32 v59, v46, v47
  v_mfma_f32_16x16x32_bf16 a[208:211], v[112:115], v[60:63], a[208:211]
  ds_read_b64_tr_b16 v[106:107], v14 offset:4096
  v_exp_f32 v48, v48
  v_mfma_f32_16x16x32_bf16 a[212:215], v[116:119], v[60:63], a[212:215]
  ds_read_b64_tr_b16 v[108:109], v15 offset:0
  ds_read_b64_tr_b16 v[110:111], v15 offset:4096
  v_add_f32 v27, v27, v48
  v_mfma_f32_16x16x32_bf16 a[216:219], v[120:123], v[60:63], a[216:219]
  ds_read_b64_tr_b16 v[112:113], v16 offset:0
  v_exp_f32 v49, v49
  v_mfma_f32_16x16x32_bf16 a[220:223], v[124:127], v[60:63], a[220:223]
  ds_read_b64_tr_b16 v[114:115], v16 offset:4096
  ds_read_b64_tr_b16 v[116:117], v17 offset:0
  v_add_f32 v27, v27, v49
  v_cvt_pk_bf16_f32 v60, v48, v49
  v_mfma_f32_16x16x32_bf16 v[40:43], a[224:227], v[160:163], v[72:75]
  ds_read_b64_tr_b16 v[118:119], v17 offset:4096
  v_exp_f32 v50, v50
  v_mfma_f32_16x16x32_bf16 v[44:47], a[240:243], v[160:163], v[72:75]
  ds_read_b64_tr_b16 v[120:121], v18 offset:0
  ds_read_b64_tr_b16 v[122:123], v18 offset:4096
  v_add_f32 v27, v27, v50
  v_mfma_f32_16x16x32_bf16 v[40:43], a[228:231], v[164:167], v[40:43]
  ds_read_b64_tr_b16 v[124:125], v19 offset:0
  v_exp_f32 v51, v51
  v_mfma_f32_16x16x32_bf16 v[44:47], a[244:247], v[164:167], v[44:47]
  v_add_f32 v27, v27, v51
  v_cvt_pk_bf16_f32 v61, v50, v51
  v_mfma_f32_16x16x32_bf16 v[40:43], a[232:235], v[168:171], v[40:43]
  v_exp_f32 v52, v52
  v_mfma_f32_16x16x32_bf16 v[44:47], a[248:251], v[168:171], v[44:47]
  ds_read_b64_tr_b16 v[126:127], v19 offset:4096
  v_add_f32 v27, v27, v52
  v_mfma_f32_16x16x32_bf16 v[40:43], a[236:239], v[172:175], v[40:43]
  v_exp_f32 v53, v53
  v_mfma_f32_16x16x32_bf16 v[44:47], a[252:255], v[172:175], v[44:47]
  s_waitcnt lgkmcnt(14)
  v_add_f32 v27, v27, v53
  v_cvt_pk_bf16_f32 v62, v52, v53
  v_mfma_f32_16x16x32_bf16 a[0:3], v[96:99], v[56:59], a[0:3]
  s_waitcnt lgkmcnt(12)
  v_exp_f32 v54, v54
  v_mfma_f32_16x16x32_bf16 a[4:7], v[100:103], v[56:59], a[4:7]
  s_waitcnt lgkmcnt(10)
  v_add_f32 v27, v27, v54
  v_mfma_f32_16x16x32_bf16 a[8:11], v[104:107], v[56:59], a[8:11]
  s_waitcnt lgkmcnt(8)
  v_exp_f32 v55, v55
  v_mfma_f32_16x16x32_bf16 a[12:15], v[108:111], v[56:59], a[12:15]
  s_waitcnt lgkmcnt(6)
  v_add_f32 v27, v27, v55
  v_cvt_pk_bf16_f32 v63, v54, v55
  v_mfma_f32_16x16x32_bf16 a[16:19], v[112:115], v[56:59], a[16:19]
  s_waitcnt lgkmcnt(4)
  v_exp_f32 v40, v40
  v_mfma_f32_16x16x32_bf16 a[20:23], v[116:119], v[56:59], a[20:23]
  s_waitcnt lgkmcnt(2)
  v_add_f32 v28, v28, v40
  v_mfma_f32_16x16x32_bf16 a[24:27], v[120:123], v[56:59], a[24:27]
  s_waitcnt lgkmcnt(0)
  v_exp_f32 v41, v41
  v_mfma_f32_16x16x32_bf16 a[28:31], v[124:127], v[56:59], a[28:31]
  v_add_f32 v28, v28, v41
  v_cvt_pk_bf16_f32 v56, v40, v41
  v_mfma_f32_16x16x32_bf16 v[48:51], a[224:227], v[176:179], v[76:79]
  v_exp_f32 v42, v42
  v_mfma_f32_16x16x32_bf16 v[52:55], a[240:243], v[176:179], v[76:79]
  v_add_f32 v28, v28, v42
  v_mfma_f32_16x16x32_bf16 v[48:51], a[228:231], v[180:183], v[48:51]
  v_exp_f32 v43, v43
  v_mfma_f32_16x16x32_bf16 v[52:55], a[244:247], v[180:183], v[52:55]
  v_add_f32 v28, v28, v43
  v_cvt_pk_bf16_f32 v57, v42, v43
  v_mfma_f32_16x16x32_bf16 v[48:51], a[232:235], v[184:187], v[48:51]
  v_exp_f32 v44, v44
  v_mfma_f32_16x16x32_bf16 v[52:55], a[248:251], v[184:187], v[52:55]
  v_add_f32 v28, v28, v44
  v_mfma_f32_16x16x32_bf16 v[48:51], a[236:239], v[188:191], v[48:51]
  v_exp_f32 v45, v45
  v_mfma_f32_16x16x32_bf16 v[52:55], a[252:255], v[188:191], v[52:55]
  v_add_f32 v28, v28, v45
  v_cvt_pk_bf16_f32 v58, v44, v45
  v_mfma_f32_16x16x32_bf16 a[32:35], v[96:99], v[60:63], a[32:35]
  v_exp_f32 v46, v46
  v_mfma_f32_16x16x32_bf16 a[36:39], v[100:103], v[60:63], a[36:39]
  v_add_f32 v28, v28, v46
  v_mfma_f32_16x16x32_bf16 a[40:43], v[104:107], v[60:63], a[40:43]
  v_exp_f32 v47, v47
  v_mfma_f32_16x16x32_bf16 a[44:47], v[108:111], v[60:63], a[44:47]
  v_add_f32 v28, v28, v47
  v_cvt_pk_bf16_f32 v59, v46, v47
  v_mfma_f32_16x16x32_bf16 a[48:51], v[112:115], v[60:63], a[48:51]
  v_exp_f32 v48, v48
  v_mfma_f32_16x16x32_bf16 a[52:55], v[116:119], v[60:63], a[52:55]
  v_add_f32 v29, v29, v48
  v_mfma_f32_16x16x32_bf16 a[56:59], v[120:123], v[60:63], a[56:59]
  v_exp_f32 v49, v49
  v_mfma_f32_16x16x32_bf16 a[60:63], v[124:127], v[60:63], a[60:63]
  v_add_f32 v29, v29, v49
  v_cvt_pk_bf16_f32 v60, v48, v49
  v_mfma_f32_16x16x32_bf16 v[40:43], a[224:227], v[192:195], v[80:83]
  v_exp_f32 v50, v50
  v_mfma_f32_16x16x32_bf16 v[44:47], a[240:243], v[192:195], v[80:83]
  v_add_f32 v29, v29, v50
  v_mfma_f32_16x16x32_bf16 v[40:43], a[228:231], v[196:199], v[40:43]
  v_exp_f32 v51, v51
  v_mfma_f32_16x16x32_bf16 v[44:47], a[244:247], v[196:199], v[44:47]
  v_add_f32 v29, v29, v51
  v_cvt_pk_bf16_f32 v61, v50, v51
  v_mfma_f32_16x16x32_bf16 v[40:43], a[232:235], v[200:203], v[40:43]
  v_exp_f32 v52, v52
  v_mfma_f32_16x16x32_bf16 v[44:47], a[248:251], v[200:203], v[44:47]
  v_add_f32 v29, v29, v52
  v_mfma_f32_16x16x32_bf16 v[40:43], a[236:239], v[204:207], v[40:43]
  v_exp_f32 v53, v53
  v_mfma_f32_16x16x32_bf16 v[44:47], a[252:255], v[204:207], v[44:47]
  v_add_f32 v29, v29, v53
  v_cvt_pk_bf16_f32 v62, v52, v53
  v_mfma_f32_16x16x32_bf16 a[64:67], v[96:99], v[56:59], a[64:67]
  v_exp_f32 v54, v54
  v_mfma_f32_16x16x32_bf16 a[68:71], v[100:103], v[56:59], a[68:71]
  v_add_f32 v29, v29, v54
  v_mfma_f32_16x16x32_bf16 a[72:75], v[104:107], v[56:59], a[72:75]
  v_exp_f32 v55, v55
  v_mfma_f32_16x16x32_bf16 a[76:79], v[108:111], v[56:59], a[76:79]
  v_add_f32 v29, v29, v55
  v_cvt_pk_bf16_f32 v63, v54, v55
  v_mfma_f32_16x16x32_bf16 a[80:83], v[112:115], v[56:59], a[80:83]
  v_exp_f32 v40, v40
  v_mfma_f32_16x16x32_bf16 a[84:87], v[116:119], v[56:59], a[84:87]
  v_add_f32 v30, v30, v40
  v_mfma_f32_16x16x32_bf16 a[88:91], v[120:123], v[56:59], a[88:91]
  v_exp_f32 v41, v41
  v_mfma_f32_16x16x32_bf16 a[92:95], v[124:127], v[56:59], a[92:95]
  v_add_f32 v30, v30, v41
  v_cvt_pk_bf16_f32 v56, v40, v41
  v_mfma_f32_16x16x32_bf16 v[48:51], a[224:227], v[208:211], v[84:87]
  v_exp_f32 v42, v42
  v_mfma_f32_16x16x32_bf16 v[52:55], a[240:243], v[208:211], v[84:87]
  v_add_f32 v30, v30, v42
  v_mfma_f32_16x16x32_bf16 v[48:51], a[228:231], v[212:215], v[48:51]
  v_exp_f32 v43, v43
  v_mfma_f32_16x16x32_bf16 v[52:55], a[244:247], v[212:215], v[52:55]
  v_add_f32 v30, v30, v43
  v_cvt_pk_bf16_f32 v57, v42, v43
  v_mfma_f32_16x16x32_bf16 v[48:51], a[232:235], v[216:219], v[48:51]
  v_exp_f32 v44, v44
  v_mfma_f32_16x16x32_bf16 v[52:55], a[248:251], v[216:219], v[52:55]
  v_add_f32 v30, v30, v44
  v_mfma_f32_16x16x32_bf16 v[48:51], a[236:239], v[220:223], v[48:51]
  v_exp_f32 v45, v45
  v_mfma_f32_16x16x32_bf16 v[52:55], a[252:255], v[220:223], v[52:55]
  v_add_f32 v30, v30, v45
  v_cvt_pk_bf16_f32 v58, v44, v45
  v_mfma_f32_16x16x32_bf16 a[96:99], v[96:99], v[60:63], a[96:99]
  v_exp_f32 v46, v46
  v_mfma_f32_16x16x32_bf16 a[100:103], v[100:103], v[60:63], a[100:103]
  v_add_f32 v30, v30, v46
  v_mfma_f32_16x16x32_bf16 a[104:107], v[104:107], v[60:63], a[104:107]
  v_exp_f32 v47, v47
  v_mfma_f32_16x16x32_bf16 a[108:111], v[108:111], v[60:63], a[108:111]
  v_add_f32 v30, v30, v47
  v_cvt_pk_bf16_f32 v59, v46, v47
  v_mfma_f32_16x16x32_bf16 a[112:115], v[112:115], v[60:63], a[112:115]
  v_exp_f32 v48, v48
  v_mfma_f32_16x16x32_bf16 a[116:119], v[116:119], v[60:63], a[116:119]
  v_add_f32 v31, v31, v48
  v_mfma_f32_16x16x32_bf16 a[120:123], v[120:123], v[60:63], a[120:123]
  v_exp_f32 v49, v49
  v_mfma_f32_16x16x32_bf16 a[124:127], v[124:127], v[60:63], a[124:127]
  v_add_f32 v31, v31, v49
  v_cvt_pk_bf16_f32 v60, v48, v49
  s_waitcnt vmcnt(1)
  s_barrier
  v_mfma_f32_16x16x32_bf16 v[40:43], a[224:227], v[224:227], v[88:91]
  v_exp_f32 v50, v50
  v_mfma_f32_16x16x32_bf16 v[44:47], a[240:243], v[224:227], v[88:91]
  ds_read_b128 a[224:227], v8 offset:32768
  v_add_f32 v31, v31, v50
  v_mfma_f32_16x16x32_bf16 v[40:43], a[228:231], v[228:231], v[40:43]
  ds_read_b128 a[240:243], v8 offset:36864
  v_exp_f32 v51, v51
  v_mfma_f32_16x16x32_bf16 v[44:47], a[244:247], v[228:231], v[44:47]
  ds_read_b128 a[228:231], v9 offset:32768
  v_add_f32 v31, v31, v51
  v_cvt_pk_bf16_f32 v61, v50, v51
  v_mfma_f32_16x16x32_bf16 v[40:43], a[232:235], v[232:235], v[40:43]
  v_exp_f32 v52, v52
  v_mfma_f32_16x16x32_bf16 v[44:47], a[248:251], v[232:235], v[44:47]
  ds_read_b128 a[244:247], v9 offset:36864
  v_add_f32 v31, v31, v52
  v_mfma_f32_16x16x32_bf16 v[40:43], a[236:239], v[236:239], v[40:43]
  v_exp_f32 v53, v53
  v_mfma_f32_16x16x32_bf16 v[44:47], a[252:255], v[236:239], v[44:47]
  ds_read_b128 a[232:235], v10 offset:32768
  v_add_f32 v31, v31, v53
  v_cvt_pk_bf16_f32 v62, v52, v53
  v_mfma_f32_16x16x32_bf16 a[128:131], v[96:99], v[56:59], a[128:131]
  v_exp_f32 v54, v54
  v_mfma_f32_16x16x32_bf16 a[132:135], v[100:103], v[56:59], a[132:135]
  ds_read_b128 a[248:251], v10 offset:36864
  v_add_f32 v31, v31, v54
  v_mfma_f32_16x16x32_bf16 a[136:139], v[104:107], v[56:59], a[136:139]
  v_exp_f32 v55, v55
  v_mfma_f32_16x16x32_bf16 a[140:143], v[108:111], v[56:59], a[140:143]
  ds_read_b128 a[236:239], v11 offset:32768
  v_add_f32 v31, v31, v55
  v_cvt_pk_bf16_f32 v63, v54, v55
  v_mfma_f32_16x16x32_bf16 a[144:147], v[112:115], v[56:59], a[144:147]
  v_exp_f32 v40, v40
  v_mfma_f32_16x16x32_bf16 a[148:151], v[116:119], v[56:59], a[148:151]
  ds_read_b128 a[252:255], v11 offset:36864
  v_add_f32 v32, v32, v40
  v_mfma_f32_16x16x32_bf16 a[152:155], v[120:123], v[56:59], a[152:155]
  v_exp_f32 v41, v41
  v_mfma_f32_16x16x32_bf16 a[156:159], v[124:127], v[56:59], a[156:159]
  s_waitcnt lgkmcnt(7)
  v_add_f32 v32, v32, v41
  v_cvt_pk_bf16_f32 v56, v40, v41
  v_mfma_f32_16x16x32_bf16 v[48:51], a[224:227], v[128:131], v[64:67]
  s_waitcnt lgkmcnt(6)
  v_exp_f32 v42, v42
  v_mfma_f32_16x16x32_bf16 v[52:55], a[240:243], v[128:131], v[64:67]
  s_waitcnt lgkmcnt(5)
  v_add_f32 v32, v32, v42
  v_mfma_f32_16x16x32_bf16 v[48:51], a[228:231], v[132:135], v[48:51]
  s_waitcnt lgkmcnt(4)
  v_exp_f32 v43, v43
  v_mfma_f32_16x16x32_bf16 v[52:55], a[244:247], v[132:135], v[52:55]
  s_waitcnt lgkmcnt(3)
  v_add_f32 v32, v32, v43
  v_cvt_pk_bf16_f32 v57, v42, v43
  v_mfma_f32_16x16x32_bf16 v[48:51], a[232:235], v[136:139], v[48:51]
  s_waitcnt lgkmcnt(2)
  v_exp_f32 v44, v44
  v_mfma_f32_16x16x32_bf16 v[52:55], a[248:251], v[136:139], v[52:55]
  s_waitcnt lgkmcnt(1)
  v_add_f32 v32, v32, v44
  v_mfma_f32_16x16x32_bf16 v[48:51], a[236:239], v[140:143], v[48:51]
  s_waitcnt lgkmcnt(0)
  v_exp_f32 v45, v45
  v_mfma_f32_16x16x32_bf16 v[52:55], a[252:255], v[140:143], v[52:55]
  v_add_f32 v32, v32, v45
  v_cvt_pk_bf16_f32 v58, v44, v45
  v_mfma_f32_16x16x32_bf16 a[160:163], v[96:99], v[60:63], a[160:163]
  v_exp_f32 v46, v46
  v_mfma_f32_16x16x32_bf16 a[164:167], v[100:103], v[60:63], a[164:167]
  v_add_f32 v32, v32, v46
  v_mfma_f32_16x16x32_bf16 a[168:171], v[104:107], v[60:63], a[168:171]
  v_exp_f32 v47, v47
  v_mfma_f32_16x16x32_bf16 a[172:175], v[108:111], v[60:63], a[172:175]
  v_add_f32 v32, v32, v47
  v_cvt_pk_bf16_f32 v59, v46, v47
  v_mfma_f32_16x16x32_bf16 a[176:179], v[112:115], v[60:63], a[176:179]
  v_exp_f32 v48, v48
  v_mfma_f32_16x16x32_bf16 a[180:183], v[116:119], v[60:63], a[180:183]
  v_add_f32 v26, v26, v48
  v_mfma_f32_16x16x32_bf16 a[184:187], v[120:123], v[60:63], a[184:187]
  v_exp_f32 v49, v49
  v_mfma_f32_16x16x32_bf16 a[188:191], v[124:127], v[60:63], a[188:191]
  v_add_f32 v26, v26, v49
  v_cvt_pk_bf16_f32 v60, v48, v49
  v_mfma_f32_16x16x32_bf16 v[40:43], a[224:227], v[144:147], v[68:71]
  v_exp_f32 v50, v50
  v_mfma_f32_16x16x32_bf16 v[44:47], a[240:243], v[144:147], v[68:71]
  v_add_f32 v26, v26, v50
  v_mfma_f32_16x16x32_bf16 v[40:43], a[228:231], v[148:151], v[40:43]
  v_exp_f32 v51, v51
  v_mfma_f32_16x16x32_bf16 v[44:47], a[244:247], v[148:151], v[44:47]
  v_add_f32 v26, v26, v51
  v_cvt_pk_bf16_f32 v61, v50, v51
  v_mfma_f32_16x16x32_bf16 v[40:43], a[232:235], v[152:155], v[40:43]
  v_exp_f32 v52, v52
  v_mfma_f32_16x16x32_bf16 v[44:47], a[248:251], v[152:155], v[44:47]
  v_add_f32 v26, v26, v52
  v_mfma_f32_16x16x32_bf16 v[40:43], a[236:239], v[156:159], v[40:43]
  v_exp_f32 v53, v53
  v_mfma_f32_16x16x32_bf16 v[44:47], a[252:255], v[156:159], v[44:47]
  v_add_f32 v26, v26, v53
  v_cvt_pk_bf16_f32 v62, v52, v53
  v_mfma_f32_16x16x32_bf16 a[192:195], v[96:99], v[56:59], a[192:195]
  v_exp_f32 v54, v54
  v_mfma_f32_16x16x32_bf16 a[196:199], v[100:103], v[56:59], a[196:199]
  ds_read_b64_tr_b16 v[96:97], v12 offset:32768
  ds_read_b64_tr_b16 v[98:99], v12 offset:36864
  v_add_f32 v26, v26, v54
  v_mfma_f32_16x16x32_bf16 a[200:203], v[104:107], v[56:59], a[200:203]
  ds_read_b64_tr_b16 v[100:101], v13 offset:32768
  v_exp_f32 v55, v55
  v_mfma_f32_16x16x32_bf16 a[204:207], v[108:111], v[56:59], a[204:207]
  ds_read_b64_tr_b16 v[102:103], v13 offset:36864
  ds_read_b64_tr_b16 v[104:105], v14 offset:32768
  v_add_f32 v26, v26, v55
  v_cvt_pk_bf16_f32 v63, v54, v55
  v_mfma_f32_16x16x32_bf16 a[208:211], v[112:115], v[56:59], a[208:211]
  ds_read_b64_tr_b16 v[106:107], v14 offset:36864
  v_exp_f32 v40, v40
  v_mfma_f32_16x16x32_bf16 a[212:215], v[116:119], v[56:59], a[212:215]
  ds_read_b64_tr_b16 v[108:109], v15 offset:32768
  ds_read_b64_tr_b16 v[110:111], v15 offset:36864
  v_add_f32 v27, v27, v40
  v_mfma_f32_16x16x32_bf16 a[216:219], v[120:123], v[56:59], a[216:219]
  ds_read_b64_tr_b16 v[112:113], v16 offset:32768
  v_exp_f32 v41, v41
  v_mfma_f32_16x16x32_bf16 a[220:223], v[124:127], v[56:59], a[220:223]
  ds_read_b64_tr_b16 v[114:115], v16 offset:36864
  ds_read_b64_tr_b16 v[116:117], v17 offset:32768
  v_add_f32 v27, v27, v41
  v_cvt_pk_bf16_f32 v56, v40, v41
  v_mfma_f32_16x16x32_bf16 v[48:51], a[224:227], v[160:163], v[72:75]
  ds_read_b64_tr_b16 v[118:119], v17 offset:36864
  v_exp_f32 v42, v42
  v_mfma_f32_16x16x32_bf16 v[52:55], a[240:243], v[160:163], v[72:75]
  ds_read_b64_tr_b16 v[120:121], v18 offset:32768
  ds_read_b64_tr_b16 v[122:123], v18 offset:36864
  v_add_f32 v27, v27, v42
  v_mfma_f32_16x16x32_bf16 v[48:51], a[228:231], v[164:167], v[48:51]
  ds_read_b64_tr_b16 v[124:125], v19 offset:32768
  v_exp_f32 v43, v43
  v_mfma_f32_16x16x32_bf16 v[52:55], a[244:247], v[164:167], v[52:55]
  v_add_f32 v27, v27, v43
  v_cvt_pk_bf16_f32 v57, v42, v43
  v_mfma_f32_16x16x32_bf16 v[48:51], a[232:235], v[168:171], v[48:51]
  v_exp_f32 v44, v44
  v_mfma_f32_16x16x32_bf16 v[52:55], a[248:251], v[168:171], v[52:55]
  ds_read_b64_tr_b16 v[126:127], v19 offset:36864
  v_add_f32 v27, v27, v44
  v_mfma_f32_16x16x32_bf16 v[48:51], a[236:239], v[172:175], v[48:51]
  v_exp_f32 v45, v45
  v_mfma_f32_16x16x32_bf16 v[52:55], a[252:255], v[172:175], v[52:55]
  s_waitcnt lgkmcnt(14)
  v_add_f32 v27, v27, v45
  v_cvt_pk_bf16_f32 v58, v44, v45
  v_mfma_f32_16x16x32_bf16 a[0:3], v[96:99], v[60:63], a[0:3]
  s_waitcnt lgkmcnt(12)
  v_exp_f32 v46, v46
  v_mfma_f32_16x16x32_bf16 a[4:7], v[100:103], v[60:63], a[4:7]
  s_waitcnt lgkmcnt(10)
  v_add_f32 v27, v27, v46
  v_mfma_f32_16x16x32_bf16 a[8:11], v[104:107], v[60:63], a[8:11]
  s_waitcnt lgkmcnt(8)
  v_exp_f32 v47, v47
  v_mfma_f32_16x16x32_bf16 a[12:15], v[108:111], v[60:63], a[12:15]
  s_waitcnt lgkmcnt(6)
  v_add_f32 v27, v27, v47
  v_cvt_pk_bf16_f32 v59, v46, v47
  v_mfma_f32_16x16x32_bf16 a[16:19], v[112:115], v[60:63], a[16:19]
  s_waitcnt lgkmcnt(4)
  v_exp_f32 v48, v48
  v_mfma_f32_16x16x32_bf16 a[20:23], v[116:119], v[60:63], a[20:23]
  s_waitcnt lgkmcnt(2)
  v_add_f32 v28, v28, v48
  v_mfma_f32_16x16x32_bf16 a[24:27], v[120:123], v[60:63], a[24:27]
  s_waitcnt lgkmcnt(0)
  v_exp_f32 v49, v49
  v_mfma_f32_16x16x32_bf16 a[28:31], v[124:127], v[60:63], a[28:31]
  v_add_f32 v28, v28, v49
  v_cvt_pk_bf16_f32 v60, v48, v49
  s_waitcnt lgkmcnt(0) vmcnt(1)
  s_barrier
  v_mfma_f32_16x16x32_bf16 v[40:43], a[224:227], v[176:179], v[76:79]
  v_exp_f32 v50, v50
  v_mfma_f32_16x16x32_bf16 v[44:47], a[240:243], v[176:179], v[76:79]
  ds_write_b128 v247, a[16:19] offset:0
  v_add_f32 v28, v28, v50
  v_mfma_f32_16x16x32_bf16 v[40:43], a[228:231], v[180:183], v[40:43]
  v_exp_f32 v51, v51
  v_mfma_f32_16x16x32_bf16 v[44:47], a[244:247], v[180:183], v[44:47]
  v_add_f32 v28, v28, v51
  v_cvt_pk_bf16_f32 v61, v50, v51
  v_mfma_f32_16x16x32_bf16 v[40:43], a[232:235], v[184:187], v[40:43]
  v_exp_f32 v52, v52
  v_mfma_f32_16x16x32_bf16 v[44:47], a[248:251], v[184:187], v[44:47]
  ds_write_b128 v247, a[20:23] offset:1024
  v_add_f32 v28, v28, v52
  v_mfma_f32_16x16x32_bf16 v[40:43], a[236:239], v[188:191], v[40:43]
  v_exp_f32 v53, v53
  v_mfma_f32_16x16x32_bf16 v[44:47], a[252:255], v[188:191], v[44:47]
  v_add_f32 v28, v28, v53
  v_cvt_pk_bf16_f32 v62, v52, v53
  v_mfma_f32_16x16x32_bf16 a[32:35], v[96:99], v[56:59], a[32:35]
  v_exp_f32 v54, v54
  v_mfma_f32_16x16x32_bf16 a[36:39], v[100:103], v[56:59], a[36:39]
  ds_write_b128 v247, a[24:27] offset:2048
  v_add_f32 v28, v28, v54
  v_mfma_f32_16x16x32_bf16 a[40:43], v[104:107], v[56:59], a[40:43]
  v_exp_f32 v55, v55
  v_mfma_f32_16x16x32_bf16 a[44:47], v[108:111], v[56:59], a[44:47]
  v_add_f32 v28, v28, v55
  v_cvt_pk_bf16_f32 v63, v54, v55
  v_mfma_f32_16x16x32_bf16 a[48:51], v[112:115], v[56:59], a[48:51]
  v_exp_f32 v40, v40
  v_mfma_f32_16x16x32_bf16 a[52:55], v[116:119], v[56:59], a[52:55]
  ds_write_b128 v247, a[28:31] offset:3072
  v_add_f32 v29, v29, v40
  v_mfma_f32_16x16x32_bf16 a[56:59], v[120:123], v[56:59], a[56:59]
  v_exp_f32 v41, v41
  v_mfma_f32_16x16x32_bf16 a[60:63], v[124:127], v[56:59], a[60:63]
  v_add_f32 v29, v29, v41
  v_cvt_pk_bf16_f32 v56, v40, v41
  v_mfma_f32_16x16x32_bf16 v[48:51], a[224:227], v[192:195], v[80:83]
  v_exp_f32 v42, v42
  v_mfma_f32_16x16x32_bf16 v[52:55], a[240:243], v[192:195], v[80:83]
  ds_write_b128 v247, a[48:51] offset:4096
  v_add_f32 v29, v29, v42
  v_mfma_f32_16x16x32_bf16 v[48:51], a[228:231], v[196:199], v[48:51]
  v_exp_f32 v43, v43
  s_add_u32 m0, s37, 131072
  v_mfma_f32_16x16x32_bf16 v[52:55], a[244:247], v[196:199], v[52:55]
  global_load_lds_dwordx4 v92, s[14:15] offset:0
  v_add_f32 v29, v29, v43
  v_cvt_pk_bf16_f32 v57, v42, v43
  v_mfma_f32_16x16x32_bf16 v[48:51], a[232:235], v[200:203], v[48:51]
  v_exp_f32 v44, v44
  v_mfma_f32_16x16x32_bf16 v[52:55], a[248:251], v[200:203], v[52:55]
  ds_write_b128 v247, a[52:55] offset:5120
  v_add_f32 v29, v29, v44
  v_mfma_f32_16x16x32_bf16 v[48:51], a[236:239], v[204:207], v[48:51]
  v_exp_f32 v45, v45
  v_mfma_f32_16x16x32_bf16 v[52:55], a[252:255], v[204:207], v[52:55]
  global_load_lds_dwordx4 v93, s[14:15] offset:1024
  v_add_f32 v29, v29, v45
  v_cvt_pk_bf16_f32 v58, v44, v45
  v_mfma_f32_16x16x32_bf16 a[64:67], v[96:99], v[60:63], a[64:67]
  v_exp_f32 v46, v46
  s_add_u32 s38, s38, 0x8000
  s_and_b32 s38, s38, 0xfffff
  v_mfma_f32_16x16x32_bf16 a[68:71], v[100:103], v[60:63], a[68:71]
  ds_write_b128 v247, a[56:59] offset:6144
  v_add_f32 v29, v29, v46
  v_mfma_f32_16x16x32_bf16 a[72:75], v[104:107], v[60:63], a[72:75]
  v_exp_f32 v47, v47
  s_add_u32 s14, s56, s38
  s_addc_u32 s15, s57, 0
  v_mfma_f32_16x16x32_bf16 a[76:79], v[108:111], v[60:63], a[76:79]
  v_add_f32 v29, v29, v47
  v_cvt_pk_bf16_f32 v59, v46, v47
  v_mfma_f32_16x16x32_bf16 a[80:83], v[112:115], v[60:63], a[80:83]
  v_exp_f32 v48, v48
  v_mfma_f32_16x16x32_bf16 a[84:87], v[116:119], v[60:63], a[84:87]
  ds_write_b128 v247, a[60:63] offset:7168
  v_add_f32 v30, v30, v48
  v_mfma_f32_16x16x32_bf16 a[88:91], v[120:123], v[60:63], a[88:91]
  v_exp_f32 v49, v49
  v_mfma_f32_16x16x32_bf16 a[92:95], v[124:127], v[60:63], a[92:95]
  v_add_f32 v30, v30, v49
  v_cvt_pk_bf16_f32 v60, v48, v49
  v_mfma_f32_16x16x32_bf16 v[40:43], a[224:227], v[208:211], v[84:87]
  v_exp_f32 v50, v50
  v_mfma_f32_16x16x32_bf16 v[44:47], a[240:243], v[208:211], v[84:87]
  ds_write_b128 v247, a[80:83] offset:8192
  v_add_f32 v30, v30, v50
  v_mfma_f32_16x16x32_bf16 v[40:43], a[228:231], v[212:215], v[40:43]
  v_exp_f32 v51, v51
  s_add_u32 m0, s37, 139264
  v_mfma_f32_16x16x32_bf16 v[44:47], a[244:247], v[212:215], v[44:47]
  global_load_lds_dwordx4 v92, s[14:15] offset:0
  v_add_f32 v30, v30, v51
  v_cvt_pk_bf16_f32 v61, v50, v51
  v_mfma_f32_16x16x32_bf16 v[40:43], a[232:235], v[216:219], v[40:43]
  v_exp_f32 v52, v52
  v_mfma_f32_16x16x32_bf16 v[44:47], a[248:251], v[216:219], v[44:47]
  ds_write_b128 v247, a[84:87] offset:9216
  v_add_f32 v30, v30, v52
  v_mfma_f32_16x16x32_bf16 v[40:43], a[236:239], v[220:223], v[40:43]
  v_exp_f32 v53, v53
  v_mfma_f32_16x16x32_bf16 v[44:47], a[252:255], v[220:223], v[44:47]
  global_load_lds_dwordx4 v93, s[14:15] offset:1024
  v_add_f32 v30, v30, v53
  v_cvt_pk_bf16_f32 v62, v52, v53
  v_mfma_f32_16x16x32_bf16 a[96:99], v[96:99], v[56:59], a[96:99]
  v_exp_f32 v54, v54
  s_add_u32 s38, s38, 0x8000
  s_and_b32 s38, s38, 0xfffff
  v_mfma_f32_16x16x32_bf16 a[100:103], v[100:103], v[56:59], a[100:103]
  ds_write_b128 v247, a[88:91] offset:10240
  v_add_f32 v30, v30, v54
  v_mfma_f32_16x16x32_bf16 a[104:107], v[104:107], v[56:59], a[104:107]
  v_exp_f32 v55, v55
  s_add_u32 s14, s56, s38
  s_addc_u32 s15, s57, 0
  v_mfma_f32_16x16x32_bf16 a[108:111], v[108:111], v[56:59], a[108:111]
  v_add_f32 v30, v30, v55
  v_cvt_pk_bf16_f32 v63, v54, v55
  v_mfma_f32_16x16x32_bf16 a[112:115], v[112:115], v[56:59], a[112:115]
  v_exp_f32 v40, v40
  v_mfma_f32_16x16x32_bf16 a[116:119], v[116:119], v[56:59], a[116:119]
  ds_write_b128 v247, a[92:95] offset:11264
  v_add_f32 v31, v31, v40
  v_mfma_f32_16x16x32_bf16 a[120:123], v[120:123], v[56:59], a[120:123]
  v_exp_f32 v41, v41
  v_mfma_f32_16x16x32_bf16 a[124:127], v[124:127], v[56:59], a[124:127]
  v_add_f32 v31, v31, v41
  v_cvt_pk_bf16_f32 v56, v40, v41
  v_mfma_f32_16x16x32_bf16 v[48:51], a[224:227], v[224:227], v[88:91]
  v_exp_f32 v42, v42
  v_mfma_f32_16x16x32_bf16 v[52:55], a[240:243], v[224:227], v[88:91]
  ds_write_b128 v247, a[112:115] offset:12288
  v_add_f32 v31, v31, v42
  v_mfma_f32_16x16x32_bf16 v[48:51], a[228:231], v[228:231], v[48:51]
  v_exp_f32 v43, v43
  s_add_u32 m0, s37, 147456
  v_mfma_f32_16x16x32_bf16 v[52:55], a[244:247], v[228:231], v[52:55]
  global_load_lds_dwordx4 v92, s[14:15] offset:0
  v_add_f32 v31, v31, v43
  v_cvt_pk_bf16_f32 v57, v42, v43
  v_mfma_f32_16x16x32_bf16 v[48:51], a[232:235], v[232:235], v[48:51]
  v_exp_f32 v44, v44
  v_mfma_f32_16x16x32_bf16 v[52:55], a[248:251], v[232:235], v[52:55]
  ds_write_b128 v247, a[116:119] offset:13312
  v_add_f32 v31, v31, v44
  v_mfma_f32_16x16x32_bf16 v[48:51], a[236:239], v[236:239], v[48:51]
  v_exp_f32 v45, v45
  v_mfma_f32_16x16x32_bf16 v[52:55], a[252:255], v[236:239], v[52:55]
  global_load_lds_dwordx4 v93, s[14:15] offset:1024
  v_add_f32 v31, v31, v45
  v_cvt_pk_bf16_f32 v58, v44, v45
  v_mfma_f32_16x16x32_bf16 a[128:131], v[96:99], v[60:63], a[128:131]
  v_exp_f32 v46, v46
  s_add_u32 s38, s38, 0x8000
  s_and_b32 s38, s38, 0xfffff
  v_mfma_f32_16x16x32_bf16 a[132:135], v[100:103], v[60:63], a[132:135]
  ds_write_b128 v247, a[120:123] offset:14336
  v_add_f32 v31, v31, v46
  v_mfma_f32_16x16x32_bf16 a[136:139], v[104:107], v[60:63], a[136:139]
  v_exp_f32 v47, v47
  s_add_u32 s14, s56, s38
  s_addc_u32 s15, s57, 0
  v_mfma_f32_16x16x32_bf16 a[140:143], v[108:111], v[60:63], a[140:143]
  v_add_f32 v31, v31, v47
  v_cvt_pk_bf16_f32 v59, v46, v47
  v_mfma_f32_16x16x32_bf16 a[144:147], v[112:115], v[60:63], a[144:147]
  v_exp_f32 v48, v48
  v_mfma_f32_16x16x32_bf16 a[148:151], v[116:119], v[60:63], a[148:151]
  ds_write_b128 v247, a[124:127] offset:15360
  v_add_f32 v32, v32, v48
  v_mfma_f32_16x16x32_bf16 a[152:155], v[120:123], v[60:63], a[152:155]
  v_exp_f32 v49, v49
  v_mfma_f32_16x16x32_bf16 a[156:159], v[124:127], v[60:63], a[156:159]
  v_add_f32 v32, v32, v49
  v_cvt_pk_bf16_f32 v60, v48, v49
  s_nop 0
  v_exp_f32 v50, v50
  s_nop 0
  ds_write_b128 v247, a[144:147] offset:16384
  v_add_f32 v32, v32, v50
  s_nop 0
  v_exp_f32 v51, v51
  s_add_u32 m0, s37, 155648
  s_nop 0
  global_load_lds_dwordx4 v92, s[14:15] offset:0
  v_add_f32 v32, v32, v51
  v_cvt_pk_bf16_f32 v61, v50, v51
  s_nop 0
  v_exp_f32 v52, v52
  s_nop 0
  ds_write_b128 v247, a[148:151] offset:17408
  v_add_f32 v32, v32, v52
  s_nop 0
  v_exp_f32 v53, v53
  s_nop 0
  global_load_lds_dwordx4 v93, s[14:15] offset:1024
  v_add_f32 v32, v32, v53
  v_cvt_pk_bf16_f32 v62, v52, v53
  v_mfma_f32_16x16x32_bf16 a[160:163], v[96:99], v[56:59], a[160:163]
  v_exp_f32 v54, v54
  s_add_u32 s38, s38, 0x8000
  s_and_b32 s38, s38, 0xfffff
  v_mfma_f32_16x16x32_bf16 a[164:167], v[100:103], v[56:59], a[164:167]
  ds_write_b128 v247, a[152:155] offset:18432
  v_add_f32 v32, v32, v54
  v_mfma_f32_16x16x32_bf16 a[168:171], v[104:107], v[56:59], a[168:171]
  v_exp_f32 v55, v55
  s_add_u32 s14, s56, s38
  s_addc_u32 s15, s57, 0
  v_mfma_f32_16x16x32_bf16 a[172:175], v[108:111], v[56:59], a[172:175]
  v_add_f32 v32, v32, v55
  v_cvt_pk_bf16_f32 v63, v54, v55
  v_mfma_f32_16x16x32_bf16 a[176:179], v[112:115], v[56:59], a[176:179]
  v_mfma_f32_16x16x32_bf16 a[180:183], v[116:119], v[56:59], a[180:183]
  ds_write_b128 v247, a[156:159] offset:19456
  v_mfma_f32_16x16x32_bf16 a[184:187], v[120:123], v[56:59], a[184:187]
  v_mfma_f32_16x16x32_bf16 a[188:191], v[124:127], v[56:59], a[188:191]
  s_nop 0
  s_nop 0
  s_nop 0
  s_nop 0
  s_nop 0
  s_nop 0
  ds_write_b128 v247, a[176:179] offset:20480
  s_nop 0
  s_nop 0
  v_mfma_f32_16x16x32_bf16 a[192:195], v[96:99], v[60:63], a[192:195]
  v_mfma_f32_16x16x32_bf16 a[196:199], v[100:103], v[60:63], a[196:199]
  ds_write_b128 v247, a[180:183] offset:21504
  v_mfma_f32_16x16x32_bf16 a[200:203], v[104:107], v[60:63], a[200:203]
  v_mfma_f32_16x16x32_bf16 a[204:207], v[108:111], v[60:63], a[204:207]
  ds_write_b128 v247, a[184:187] offset:22528
  v_mfma_f32_16x16x32_bf16 a[208:211], v[112:115], v[60:63], a[208:211]
  v_mfma_f32_16x16x32_bf16 a[212:215], v[116:119], v[60:63], a[212:215]
  ds_write_b128 v247, a[188:191] offset:23552
  v_mfma_f32_16x16x32_bf16 a[216:219], v[120:123], v[60:63], a[216:219]
  v_mfma_f32_16x16x32_bf16 a[220:223], v[124:127], v[60:63], a[220:223]
  s_waitcnt vmcnt(8)
  global_load_dword v243, v240, s[88:89]
  s_cmp_lg_u32 s3, 0
  s_cbranch_scc1 L_nonce_skip
  v_readfirstlane_b32 s64, v244
  v_readfirstlane_b32 s65, v245
  s_cmp_lg_u32 s64, 0
  s_cbranch_scc1 L_nonce_ok
  s_mov_b32 s25, 0
L_nonce:
  global_load_dwordx2 v[244:245], v241, s[86:87] sc1
  s_waitcnt vmcnt(0)
  v_readfirstlane_b32 s64, v244
  v_readfirstlane_b32 s65, v245
  s_cmp_lg_u32 s64, 0
  s_cbranch_scc1 L_nonce_ok
  s_add_u32 s25, s25, 1
  s_cmp_lt_u32 s25, 1048576
  s_cbranch_scc1 L_nonce
L_nonce_ok:
  v_mov_b32 v35, 31232
  ds_write_b64 v35, v[244:245]
L_nonce_skip:
  s_mov_b32 s4, s88
  s_mov_b32 s5, s89
  s_mov_b32 s10, s90
  s_mov_b32 s11, s91
  s_lshr_b32 s46, s45, 3
  s_and_b32 s47, s45, 3
  s_bfe_u32 s48, s45, 0x10002
  v_lshlrev_b32 v6, 2, v2
  s_lshl_b32 s20, s3, 15
  v_add_u32 v6, s20, v6
  s_xor_b32 s21, s3, 1
  s_lshl_b32 s21, s21, 15
  v_lshlrev_b32 v7, 4, v2
  v_add_u32 v7, s21, v7
  v_lshlrev_b32 v34, 2, v2
  v_add_u32 v34, s21, v34
  v_add_f32 v35, v26, v27
  v_add_f32 v35, v35, v28
  v_add_f32 v35, v35, v29
  v_add_f32 v35, v35, v30
  v_add_f32 v35, v35, v31
  v_add_f32 v35, v35, v32
  s_mov_b32 s25, 0x4e800000
  v_cmp_nge_f32 vcc, s25, v35
  s_nop 3
  s_cmp_lg_u64 vcc, 0
  s_cselect_b32 s25, 1, 0
  v_mov_b32 v35, s25
  ds_write_b32 v6, v35 offset:30720
  ds_write_b32 v6, v26 offset:28672
  ds_write_b32 v6, v27 offset:28928
  ds_write_b32 v6, v28 offset:29184
  ds_write_b32 v6, v29 offset:29440
  ds_write_b32 v6, v30 offset:29696
  ds_write_b32 v6, v31 offset:29952
  ds_write_b32 v6, v32 offset:30208
  ds_write_b128 v247, a[208:211] offset:24576
  ds_write_b128 v247, a[212:215] offset:25600
  ds_write_b128 v247, a[216:219] offset:26624
  ds_write_b128 v247, a[220:223] offset:27648
  s_waitcnt lgkmcnt(0)
  s_barrier
  v_and_b32 v35, 3, v2
  v_lshlrev_b32 v35, 15, v35
  ds_read_b32 v35, v35 offset:30720
  v_mov_b32 v36, 31232
  ds_read_b64 v[36:37], v36
  s_waitcnt lgkmcnt(0)
  v_readfirstlane_b32 s64, v36
  v_readfirstlane_b32 s65, v37
  v_cmp_ne_u32 vcc, 0, v35
  s_nop 3
  s_cmp_eq_u64 vcc, 0
  s_cselect_b32 s25, 1, s60
  s_cmp_eq_u32 s25, 0
  s_cbranch_scc1 L_slow
  ds_read_b32 v64, v34 offset:28672
  ds_read_b32 v65, v34 offset:28928
  ds_read_b32 v66, v34 offset:29184
  ds_read_b32 v67, v34 offset:29440
  ds_read_b32 v68, v34 offset:29696
  ds_read_b32 v69, v34 offset:29952
  ds_read_b32 v70, v34 offset:30208
  ds_read_b128 v[128:131], v7 offset:0
  ds_read_b128 v[132:135], v7 offset:1024
  ds_read_b128 v[136:139], v7 offset:2048
  ds_read_b128 v[140:143], v7 offset:3072
  ds_read_b128 v[144:147], v7 offset:4096
  ds_read_b128 v[148:151], v7 offset:5120
  ds_read_b128 v[152:155], v7 offset:6144
  ds_read_b128 v[156:159], v7 offset:7168
  ds_read_b128 v[160:163], v7 offset:8192
  ds_read_b128 v[164:167], v7 offset:9216
  ds_read_b128 v[168:171], v7 offset:10240
  ds_read_b128 v[172:175], v7 offset:11264
  ds_read_b128 v[176:179], v7 offset:12288
  ds_read_b128 v[180:183], v7 offset:13312
  ds_read_b128 v[184:187], v7 offset:14336
  ds_read_b128 v[188:191], v7 offset:15360
  ds_read_b128 v[192:195], v7 offset:16384
  ds_read_b128 v[196:199], v7 offset:17408
  ds_read_b128 v[200:203], v7 offset:18432
  ds_read_b128 v[204:207], v7 offset:19456
  ds_read_b128 v[208:211], v7 offset:20480
  ds_read_b128 v[212:215], v7 offset:21504
  ds_read_b128 v[216:219], v7 offset:22528
  ds_read_b128 v[220:223], v7 offset:23552
  ds_read_b128 v[224:227], v7 offset:24576
  ds_read_b128 v[228:231], v7 offset:25600
  ds_read_b128 v[232:235], v7 offset:26624
  ds_read_b128 v[236:239], v7 offset:27648
  s_waitcnt lgkmcnt(0)
  s_barrier
  v_add_f32 v26, v26, v64
  v_add_f32 v27, v27, v65
  v_add_f32 v28, v28, v66
  v_add_f32 v29, v29, v67
  v_add_f32 v30, v30, v68
  v_add_f32 v31, v31, v69
  v_add_f32 v32, v32, v70
  v_mov_b32 v64, v26
  v_mov_b32 v65, v27
  v_mov_b32 v66, v28
  v_mov_b32 v67, v29
  v_mov_b32 v68, v30
  v_mov_b32 v69, v31
  v_mov_b32 v70, v32
  s_nop 0
  v_permlane16_swap_b32 v26, v64
  v_permlane16_swap_b32 v27, v65
  v_permlane16_swap_b32 v28, v66
  v_permlane16_swap_b32 v29, v67
  v_permlane16_swap_b32 v30, v68
  v_permlane16_swap_b32 v31, v69
  v_permlane16_swap_b32 v32, v70
  s_nop 0
  v_add_f32 v26, v26, v64
  v_add_f32 v27, v27, v65
  v_add_f32 v28, v28, v66
  v_add_f32 v29, v29, v67
  v_add_f32 v30, v30, v68
  v_add_f32 v31, v31, v69
  v_add_f32 v32, v32, v70
  v_mov_b32 v64, v26
  v_mov_b32 v65, v27
  v_mov_b32 v66, v28
  v_mov_b32 v67, v29
  v_mov_b32 v68, v30
  v_mov_b32 v69, v31
  v_mov_b32 v70, v32
  s_nop 0
  v_permlane32_swap_b32 v26, v64
  v_permlane32_swap_b32 v27, v65
  v_permlane32_swap_b32 v28, v66
  v_permlane32_swap_b32 v29, v67
  v_permlane32_swap_b32 v30, v68
  v_permlane32_swap_b32 v31, v69
  v_permlane32_swap_b32 v32, v70
  s_nop 0
  v_add_f32 v26, v26, v64
  v_add_f32 v27, v27, v65
  v_add_f32 v28, v28, v66
  v_add_f32 v29, v29, v67
  v_add_f32 v30, v30, v68
  v_add_f32 v31, v31, v69
  v_add_f32 v32, v32, v70
  v_rcp_f32 v26, v26
  v_rcp_f32 v27, v27
  v_rcp_f32 v28, v28
  v_rcp_f32 v29, v29
  v_rcp_f32 v30, v30
  v_rcp_f32 v31, v31
  v_rcp_f32 v32, v32
  s_mul_i32 s20, s44, 14
  s_mul_i32 s21, s33, 7
  s_add_u32 s20, s20, s21
  s_lshl_b32 s20, s20, 5
  s_add_u32 s20, s20, s45
  s_lshl_b32 s20, s20, 12
  s_lshl_b32 s21, s34, 11
  s_add_u32 s20, s20, s21
  s_add_u32 s20, s20, 0
  v_lshlrev_b32 v5, 4, v2
  v_add_u32 v5, s20, v5
  v_lshlrev_b32 v6, 4, v2
  s_lshl_b32 s21, s34, 11
  s_add_u32 s21, s21, 98304
  v_add_u32 v6, s21, v6
  s_cmp_eq_u32 s33, s48
  v_accvgpr_read_b32 v40, a0
  v_accvgpr_read_b32 v41, a1
  v_accvgpr_read_b32 v42, a2
  v_accvgpr_read_b32 v43, a3
  v_accvgpr_read_b32 v44, a4
  v_accvgpr_read_b32 v45, a5
  v_accvgpr_read_b32 v46, a6
  v_accvgpr_read_b32 v47, a7
  v_accvgpr_read_b32 v48, a8
  v_accvgpr_read_b32 v49, a9
  v_accvgpr_read_b32 v50, a10
  v_accvgpr_read_b32 v51, a11
  v_accvgpr_read_b32 v52, a12
  v_accvgpr_read_b32 v53, a13
  v_accvgpr_read_b32 v54, a14
  v_accvgpr_read_b32 v55, a15
  v_pk_add_f32 v[40:41], v[40:41], v[128:129]
  v_pk_add_f32 v[42:43], v[42:43], v[130:131]
  v_pk_add_f32 v[44:45], v[44:45], v[132:133]
  v_pk_add_f32 v[46:47], v[46:47], v[134:135]
  v_pk_add_f32 v[48:49], v[48:49], v[136:137]
  v_pk_add_f32 v[50:51], v[50:51], v[138:139]
  v_pk_add_f32 v[52:53], v[52:53], v[140:141]
  v_pk_add_f32 v[54:55], v[54:55], v[142:143]
  v_pk_mul_f32 v[40:41], v[40:41], v[26:27] op_sel:[0,0] op_sel_hi:[1,0]
  v_pk_mul_f32 v[42:43], v[42:43], v[26:27] op_sel:[0,0] op_sel_hi:[1,0]
  v_pk_mul_f32 v[44:45], v[44:45], v[26:27] op_sel:[0,0] op_sel_hi:[1,0]
  v_pk_mul_f32 v[46:47], v[46:47], v[26:27] op_sel:[0,0] op_sel_hi:[1,0]
  v_pk_mul_f32 v[48:49], v[48:49], v[26:27] op_sel:[0,0] op_sel_hi:[1,0]
  v_pk_mul_f32 v[50:51], v[50:51], v[26:27] op_sel:[0,0] op_sel_hi:[1,0]
  v_pk_mul_f32 v[52:53], v[52:53], v[26:27] op_sel:[0,0] op_sel_hi:[1,0]
  v_pk_mul_f32 v[54:55], v[54:55], v[26:27] op_sel:[0,0] op_sel_hi:[1,0]
  v_cvt_pk_bf16_f32 v96, v40, v41
  v_cvt_pk_bf16_f32 v97, v42, v43
  v_cvt_pk_bf16_f32 v98, v44, v45
  v_cvt_pk_bf16_f32 v99, v46, v47
  v_cvt_pk_bf16_f32 v100, v48, v49
  v_cvt_pk_bf16_f32 v101, v50, v51
  v_cvt_pk_bf16_f32 v102, v52, v53
  v_cvt_pk_bf16_f32 v103, v54, v55
  global_store_dwordx4 v5, v[96:99], s[8:9] sc1
  global_store_dwordx4 v5, v[100:103], s[8:9] offset:1024 sc1
  s_cbranch_scc0 L_noown0
  ds_write_b128 v6, v[96:99] offset:0
  ds_write_b128 v6, v[100:103] offset:1024
L_noown0:
  v_add_u32 v5, 0x20000, v5
  v_accvgpr_read_b32 v56, a32
  v_accvgpr_read_b32 v57, a33
  v_accvgpr_read_b32 v58, a34
  v_accvgpr_read_b32 v59, a35
  v_accvgpr_read_b32 v60, a36
  v_accvgpr_read_b32 v61, a37
  v_accvgpr_read_b32 v62, a38
  v_accvgpr_read_b32 v63, a39
  v_accvgpr_read_b32 v64, a40
  v_accvgpr_read_b32 v65, a41
  v_accvgpr_read_b32 v66, a42
  v_accvgpr_read_b32 v67, a43
  v_accvgpr_read_b32 v68, a44
  v_accvgpr_read_b32 v69, a45
  v_accvgpr_read_b32 v70, a46
  v_accvgpr_read_b32 v71, a47
  v_pk_add_f32 v[56:57], v[56:57], v[144:145]
  v_pk_add_f32 v[58:59], v[58:59], v[146:147]
  v_pk_add_f32 v[60:61], v[60:61], v[148:149]
  v_pk_add_f32 v[62:63], v[62:63], v[150:151]
  v_pk_add_f32 v[64:65], v[64:65], v[152:153]
  v_pk_add_f32 v[66:67], v[66:67], v[154:155]
  v_pk_add_f32 v[68:69], v[68:69], v[156:157]
  v_pk_add_f32 v[70:71], v[70:71], v[158:159]
  v_pk_mul_f32 v[56:57], v[56:57], v[26:27] op_sel:[0,1] op_sel_hi:[1,1]
  v_pk_mul_f32 v[58:59], v[58:59], v[26:27] op_sel:[0,1] op_sel_hi:[1,1]
  v_pk_mul_f32 v[60:61], v[60:61], v[26:27] op_sel:[0,1] op_sel_hi:[1,1]
  v_pk_mul_f32 v[62:63], v[62:63], v[26:27] op_sel:[0,1] op_sel_hi:[1,1]
  v_pk_mul_f32 v[64:65], v[64:65], v[26:27] op_sel:[0,1] op_sel_hi:[1,1]
  v_pk_mul_f32 v[66:67], v[66:67], v[26:27] op_sel:[0,1] op_sel_hi:[1,1]
  v_pk_mul_f32 v[68:69], v[68:69], v[26:27] op_sel:[0,1] op_sel_hi:[1,1]
  v_pk_mul_f32 v[70:71], v[70:71], v[26:27] op_sel:[0,1] op_sel_hi:[1,1]
  v_cvt_pk_bf16_f32 v104, v56, v57
  v_cvt_pk_bf16_f32 v105, v58, v59
  v_cvt_pk_bf16_f32 v106, v60, v61
  v_cvt_pk_bf16_f32 v107, v62, v63
  v_cvt_pk_bf16_f32 v108, v64, v65
  v_cvt_pk_bf16_f32 v109, v66, v67
  v_cvt_pk_bf16_f32 v110, v68, v69
  v_cvt_pk_bf16_f32 v111, v70, v71
  global_store_dwordx4 v5, v[104:107], s[8:9] sc1
  global_store_dwordx4 v5, v[108:111], s[8:9] offset:1024 sc1
  s_cbranch_scc0 L_noown1
  ds_write_b128 v6, v[104:107] offset:4096
  ds_write_b128 v6, v[108:111] offset:5120
L_noown1:
  v_add_u32 v5, 0x20000, v5
  v_accvgpr_read_b32 v40, a64
  v_accvgpr_read_b32 v41, a65
  v_accvgpr_read_b32 v42, a66
  v_accvgpr_read_b32 v43, a67
  v_accvgpr_read_b32 v44, a68
  v_accvgpr_read_b32 v45, a69
  v_accvgpr_read_b32 v46, a70
  v_accvgpr_read_b32 v47, a71
  v_accvgpr_read_b32 v48, a72
  v_accvgpr_read_b32 v49, a73
  v_accvgpr_read_b32 v50, a74
  v_accvgpr_read_b32 v51, a75
  v_accvgpr_read_b32 v52, a76
  v_accvgpr_read_b32 v53, a77
  v_accvgpr_read_b32 v54, a78
  v_accvgpr_read_b32 v55, a79
  v_pk_add_f32 v[40:41], v[40:41], v[160:161]
  v_pk_add_f32 v[42:43], v[42:43], v[162:163]
  v_pk_add_f32 v[44:45], v[44:45], v[164:165]
  v_pk_add_f32 v[46:47], v[46:47], v[166:167]
  v_pk_add_f32 v[48:49], v[48:49], v[168:169]
  v_pk_add_f32 v[50:51], v[50:51], v[170:171]
  v_pk_add_f32 v[52:53], v[52:53], v[172:173]
  v_pk_add_f32 v[54:55], v[54:55], v[174:175]
  v_pk_mul_f32 v[40:41], v[40:41], v[28:29] op_sel:[0,0] op_sel_hi:[1,0]
  v_pk_mul_f32 v[42:43], v[42:43], v[28:29] op_sel:[0,0] op_sel_hi:[1,0]
  v_pk_mul_f32 v[44:45], v[44:45], v[28:29] op_sel:[0,0] op_sel_hi:[1,0]
  v_pk_mul_f32 v[46:47], v[46:47], v[28:29] op_sel:[0,0] op_sel_hi:[1,0]
  v_pk_mul_f32 v[48:49], v[48:49], v[28:29] op_sel:[0,0] op_sel_hi:[1,0]
  v_pk_mul_f32 v[50:51], v[50:51], v[28:29] op_sel:[0,0] op_sel_hi:[1,0]
  v_pk_mul_f32 v[52:53], v[52:53], v[28:29] op_sel:[0,0] op_sel_hi:[1,0]
  v_pk_mul_f32 v[54:55], v[54:55], v[28:29] op_sel:[0,0] op_sel_hi:[1,0]
  v_cvt_pk_bf16_f32 v112, v40, v41
  v_cvt_pk_bf16_f32 v113, v42, v43
  v_cvt_pk_bf16_f32 v114, v44, v45
  v_cvt_pk_bf16_f32 v115, v46, v47
  v_cvt_pk_bf16_f32 v116, v48, v49
  v_cvt_pk_bf16_f32 v117, v50, v51
  v_cvt_pk_bf16_f32 v118, v52, v53
  v_cvt_pk_bf16_f32 v119, v54, v55
  global_store_dwordx4 v5, v[112:115], s[8:9] sc1
  global_store_dwordx4 v5, v[116:119], s[8:9] offset:1024 sc1
  s_cbranch_scc0 L_noown2
  ds_write_b128 v6, v[112:115] offset:8192
  ds_write_b128 v6, v[116:119] offset:9216
L_noown2:
  v_add_u32 v5, 0x20000, v5
  v_accvgpr_read_b32 v56, a96
  v_accvgpr_read_b32 v57, a97
  v_accvgpr_read_b32 v58, a98
  v_accvgpr_read_b32 v59, a99
  v_accvgpr_read_b32 v60, a100
  v_accvgpr_read_b32 v61, a101
  v_accvgpr_read_b32 v62, a102
  v_accvgpr_read_b32 v63, a103
  v_accvgpr_read_b32 v64, a104
  v_accvgpr_read_b32 v65, a105
  v_accvgpr_read_b32 v66, a106
  v_accvgpr_read_b32 v67, a107
  v_accvgpr_read_b32 v68, a108
  v_accvgpr_read_b32 v69, a109
  v_accvgpr_read_b32 v70, a110
  v_accvgpr_read_b32 v71, a111
  v_pk_add_f32 v[56:57], v[56:57], v[176:177]
  v_pk_add_f32 v[58:59], v[58:59], v[178:179]
  v_pk_add_f32 v[60:61], v[60:61], v[180:181]
  v_pk_add_f32 v[62:63], v[62:63], v[182:183]
  v_pk_add_f32 v[64:65], v[64:65], v[184:185]
  v_pk_add_f32 v[66:67], v[66:67], v[186:187]
  v_pk_add_f32 v[68:69], v[68:69], v[188:189]
  v_pk_add_f32 v[70:71], v[70:71], v[190:191]
  v_pk_mul_f32 v[56:57], v[56:57], v[28:29] op_sel:[0,1] op_sel_hi:[1,1]
  v_pk_mul_f32 v[58:59], v[58:59], v[28:29] op_sel:[0,1] op_sel_hi:[1,1]
  v_pk_mul_f32 v[60:61], v[60:61], v[28:29] op_sel:[0,1] op_sel_hi:[1,1]
  v_pk_mul_f32 v[62:63], v[62:63], v[28:29] op_sel:[0,1] op_sel_hi:[1,1]
  v_pk_mul_f32 v[64:65], v[64:65], v[28:29] op_sel:[0,1] op_sel_hi:[1,1]
  v_pk_mul_f32 v[66:67], v[66:67], v[28:29] op_sel:[0,1] op_sel_hi:[1,1]
  v_pk_mul_f32 v[68:69], v[68:69], v[28:29] op_sel:[0,1] op_sel_hi:[1,1]
  v_pk_mul_f32 v[70:71], v[70:71], v[28:29] op_sel:[0,1] op_sel_hi:[1,1]
  v_cvt_pk_bf16_f32 v120, v56, v57
  v_cvt_pk_bf16_f32 v121, v58, v59
  v_cvt_pk_bf16_f32 v122, v60, v61
  v_cvt_pk_bf16_f32 v123, v62, v63
  v_cvt_pk_bf16_f32 v124, v64, v65
  v_cvt_pk_bf16_f32 v125, v66, v67
  v_cvt_pk_bf16_f32 v126, v68, v69
  v_cvt_pk_bf16_f32 v127, v70, v71
  global_store_dwordx4 v5, v[120:123], s[8:9] sc1
  global_store_dwordx4 v5, v[124:127], s[8:9] offset:1024 sc1
  s_cbranch_scc0 L_noown3
  ds_write_b128 v6, v[120:123] offset:12288
  ds_write_b128 v6, v[124:127] offset:13312
L_noown3:
  v_add_u32 v5, 0x20000, v5
  v_accvgpr_read_b32 v40, a128
  v_accvgpr_read_b32 v41, a129
  v_accvgpr_read_b32 v42, a130
  v_accvgpr_read_b32 v43, a131
  v_accvgpr_read_b32 v44, a132
  v_accvgpr_read_b32 v45, a133
  v_accvgpr_read_b32 v46, a134
  v_accvgpr_read_b32 v47, a135
  v_accvgpr_read_b32 v48, a136
  v_accvgpr_read_b32 v49, a137
  v_accvgpr_read_b32 v50, a138
  v_accvgpr_read_b32 v51, a139
  v_accvgpr_read_b32 v52, a140
  v_accvgpr_read_b32 v53, a141
  v_accvgpr_read_b32 v54, a142
  v_accvgpr_read_b32 v55, a143
  v_pk_add_f32 v[40:41], v[40:41], v[192:193]
  v_pk_add_f32 v[42:43], v[42:43], v[194:195]
  v_pk_add_f32 v[44:45], v[44:45], v[196:197]
  v_pk_add_f32 v[46:47], v[46:47], v[198:199]
  v_pk_add_f32 v[48:49], v[48:49], v[200:201]
  v_pk_add_f32 v[50:51], v[50:51], v[202:203]
  v_pk_add_f32 v[52:53], v[52:53], v[204:205]
  v_pk_add_f32 v[54:55], v[54:55], v[206:207]
  v_pk_mul_f32 v[40:41], v[40:41], v[30:31] op_sel:[0,0] op_sel_hi:[1,0]
  v_pk_mul_f32 v[42:43], v[42:43], v[30:31] op_sel:[0,0] op_sel_hi:[1,0]
  v_pk_mul_f32 v[44:45], v[44:45], v[30:31] op_sel:[0,0] op_sel_hi:[1,0]
  v_pk_mul_f32 v[46:47], v[46:47], v[30:31] op_sel:[0,0] op_sel_hi:[1,0]
  v_pk_mul_f32 v[48:49], v[48:49], v[30:31] op_sel:[0,0] op_sel_hi:[1,0]
  v_pk_mul_f32 v[50:51], v[50:51], v[30:31] op_sel:[0,0] op_sel_hi:[1,0]
  v_pk_mul_f32 v[52:53], v[52:53], v[30:31] op_sel:[0,0] op_sel_hi:[1,0]
  v_pk_mul_f32 v[54:55], v[54:55], v[30:31] op_sel:[0,0] op_sel_hi:[1,0]
  v_cvt_pk_bf16_f32 v96, v40, v41
  v_cvt_pk_bf16_f32 v97, v42, v43
  v_cvt_pk_bf16_f32 v98, v44, v45
  v_cvt_pk_bf16_f32 v99, v46, v47
  v_cvt_pk_bf16_f32 v100, v48, v49
  v_cvt_pk_bf16_f32 v101, v50, v51
  v_cvt_pk_bf16_f32 v102, v52, v53
  v_cvt_pk_bf16_f32 v103, v54, v55
  global_store_dwordx4 v5, v[96:99], s[8:9] sc1
  global_store_dwordx4 v5, v[100:103], s[8:9] offset:1024 sc1
  s_cbranch_scc0 L_noown4
  ds_write_b128 v6, v[96:99] offset:16384
  ds_write_b128 v6, v[100:103] offset:17408
L_noown4:
  v_add_u32 v5, 0x20000, v5
  v_accvgpr_read_b32 v56, a160
  v_accvgpr_read_b32 v57, a161
  v_accvgpr_read_b32 v58, a162
  v_accvgpr_read_b32 v59, a163
  v_accvgpr_read_b32 v60, a164
  v_accvgpr_read_b32 v61, a165
  v_accvgpr_read_b32 v62, a166
  v_accvgpr_read_b32 v63, a167
  v_accvgpr_read_b32 v64, a168
  v_accvgpr_read_b32 v65, a169
  v_accvgpr_read_b32 v66, a170
  v_accvgpr_read_b32 v67, a171
  v_accvgpr_read_b32 v68, a172
  v_accvgpr_read_b32 v69, a173
  v_accvgpr_read_b32 v70, a174
  v_accvgpr_read_b32 v71, a175
  v_pk_add_f32 v[56:57], v[56:57], v[208:209]
  v_pk_add_f32 v[58:59], v[58:59], v[210:211]
  v_pk_add_f32 v[60:61], v[60:61], v[212:213]
  v_pk_add_f32 v[62:63], v[62:63], v[214:215]
  v_pk_add_f32 v[64:65], v[64:65], v[216:217]
  v_pk_add_f32 v[66:67], v[66:67], v[218:219]
  v_pk_add_f32 v[68:69], v[68:69], v[220:221]
  v_pk_add_f32 v[70:71], v[70:71], v[222:223]
  v_pk_mul_f32 v[56:57], v[56:57], v[30:31] op_sel:[0,1] op_sel_hi:[1,1]
  v_pk_mul_f32 v[58:59], v[58:59], v[30:31] op_sel:[0,1] op_sel_hi:[1,1]
  v_pk_mul_f32 v[60:61], v[60:61], v[30:31] op_sel:[0,1] op_sel_hi:[1,1]
  v_pk_mul_f32 v[62:63], v[62:63], v[30:31] op_sel:[0,1] op_sel_hi:[1,1]
  v_pk_mul_f32 v[64:65], v[64:65], v[30:31] op_sel:[0,1] op_sel_hi:[1,1]
  v_pk_mul_f32 v[66:67], v[66:67], v[30:31] op_sel:[0,1] op_sel_hi:[1,1]
  v_pk_mul_f32 v[68:69], v[68:69], v[30:31] op_sel:[0,1] op_sel_hi:[1,1]
  v_pk_mul_f32 v[70:71], v[70:71], v[30:31] op_sel:[0,1] op_sel_hi:[1,1]
  v_cvt_pk_bf16_f32 v104, v56, v57
  v_cvt_pk_bf16_f32 v105, v58, v59
  v_cvt_pk_bf16_f32 v106, v60, v61
  v_cvt_pk_bf16_f32 v107, v62, v63
  v_cvt_pk_bf16_f32 v108, v64, v65
  v_cvt_pk_bf16_f32 v109, v66, v67
  v_cvt_pk_bf16_f32 v110, v68, v69
  v_cvt_pk_bf16_f32 v111, v70, v71
  global_store_dwordx4 v5, v[104:107], s[8:9] sc1
  global_store_dwordx4 v5, v[108:111], s[8:9] offset:1024 sc1
  s_cbranch_scc0 L_noown5
  ds_write_b128 v6, v[104:107] offset:20480
  ds_write_b128 v6, v[108:111] offset:21504
L_noown5:
  v_add_u32 v5, 0x20000, v5
  v_accvgpr_read_b32 v40, a192
  v_accvgpr_read_b32 v41, a193
  v_accvgpr_read_b32 v42, a194
  v_accvgpr_read_b32 v43, a195
  v_accvgpr_read_b32 v44, a196
  v_accvgpr_read_b32 v45, a197
  v_accvgpr_read_b32 v46, a198
  v_accvgpr_read_b32 v47, a199
  v_accvgpr_read_b32 v48, a200
  v_accvgpr_read_b32 v49, a201
  v_accvgpr_read_b32 v50, a202
  v_accvgpr_read_b32 v51, a203
  v_accvgpr_read_b32 v52, a204
  v_accvgpr_read_b32 v53, a205
  v_accvgpr_read_b32 v54, a206
  v_accvgpr_read_b32 v55, a207
  v_pk_add_f32 v[40:41], v[40:41], v[224:225]
  v_pk_add_f32 v[42:43], v[42:43], v[226:227]
  v_pk_add_f32 v[44:45], v[44:45], v[228:229]
  v_pk_add_f32 v[46:47], v[46:47], v[230:231]
  v_pk_add_f32 v[48:49], v[48:49], v[232:233]
  v_pk_add_f32 v[50:51], v[50:51], v[234:235]
  v_pk_add_f32 v[52:53], v[52:53], v[236:237]
  v_pk_add_f32 v[54:55], v[54:55], v[238:239]
  v_pk_mul_f32 v[40:41], v[40:41], v[32:33] op_sel:[0,0] op_sel_hi:[1,0]
  v_pk_mul_f32 v[42:43], v[42:43], v[32:33] op_sel:[0,0] op_sel_hi:[1,0]
  v_pk_mul_f32 v[44:45], v[44:45], v[32:33] op_sel:[0,0] op_sel_hi:[1,0]
  v_pk_mul_f32 v[46:47], v[46:47], v[32:33] op_sel:[0,0] op_sel_hi:[1,0]
  v_pk_mul_f32 v[48:49], v[48:49], v[32:33] op_sel:[0,0] op_sel_hi:[1,0]
  v_pk_mul_f32 v[50:51], v[50:51], v[32:33] op_sel:[0,0] op_sel_hi:[1,0]
  v_pk_mul_f32 v[52:53], v[52:53], v[32:33] op_sel:[0,0] op_sel_hi:[1,0]
  v_pk_mul_f32 v[54:55], v[54:55], v[32:33] op_sel:[0,0] op_sel_hi:[1,0]
  v_cvt_pk_bf16_f32 v112, v40, v41
  v_cvt_pk_bf16_f32 v113, v42, v43
  v_cvt_pk_bf16_f32 v114, v44, v45
  v_cvt_pk_bf16_f32 v115, v46, v47
  v_cvt_pk_bf16_f32 v116, v48, v49
  v_cvt_pk_bf16_f32 v117, v50, v51
  v_cvt_pk_bf16_f32 v118, v52, v53
  v_cvt_pk_bf16_f32 v119, v54, v55
  global_store_dwordx4 v5, v[112:115], s[8:9] sc1
  global_store_dwordx4 v5, v[116:119], s[8:9] offset:1024 sc1
  s_cbranch_scc0 L_noown6
  ds_write_b128 v6, v[112:115] offset:24576
  ds_write_b128 v6, v[116:119] offset:25600
L_noown6:
  v_lshrrev_b32 v4, 4, v2
  v_bfe_u32 v5, v2, 2, 2
  v_lshl_add_u32 v6, v4, 2, v5
  v_and_b32 v7, 7, v6
  v_lshlrev_b32 v6, 8, v6
  v_and_b32 v34, 3, v2
  v_lshl_add_u32 v6, v34, 3, v6
  v_add_u32 v6, 0x20000, v6
  v_lshlrev_b32 v7, 5, v7
  s_lshl_b32 s36, s46, 6
  v_xor_b32 v7, s36, v7
  v_xor_b32 v34, 0, v7
  v_add_u32 v12, v6, v34
  v_xor_b32 v34, 32, v7
  v_add_u32 v13, v6, v34
  v_xor_b32 v34, 64, v7
  v_add_u32 v14, v6, v34
  v_xor_b32 v34, 96, v7
  v_add_u32 v15, v6, v34
  v_xor_b32 v34, 128, v7
  v_add_u32 v16, v6, v34
  v_xor_b32 v34, 160, v7
  v_add_u32 v17, v6, v34
  v_xor_b32 v34, 192, v7
  v_add_u32 v18, v6, v34
  v_xor_b32 v34, 224, v7
  v_add_u32 v19, v6, v34
  s_mul_i32 s20, s44, 14
  s_mul_i32 s21, s48, 7
  s_add_u32 s20, s20, s21
  s_lshl_b32 s21, s3, 1
  s_add_u32 s22, s21, 1
  s_min_u32 s22, s22, 6
  s_add_u32 s21, s21, s20
  s_add_u32 s22, s22, s20
  s_lshl_b32 s21, s21, 17
  s_lshl_b32 s22, s22, 17
  s_lshl_b32 s23, s46, 15
  s_add_u32 s21, s21, s23
  s_add_u32 s22, s22, s23
  v_lshlrev_b32 v5, 4, v2
  v_add_u32 v22, s21, v5
  v_add_u32 v23, s22, v5
  s_add_u32 s58, s8, 0
  s_addc_u32 s59, s9, 0
  s_and_b32 s39, s45, 7
  s_lshl_b32 s39, s39, 12
  s_add_u32 s18, s58, s39
  s_addc_u32 s19, s59, 0
  s_add_u32 s39, s39, 4096
  s_and_b32 s39, s39, 0x7fff
  s_add_u32 s18, s58, s39
  s_addc_u32 s19, s59, 0
  s_lshl_b32 s21, s3, 1
  s_add_u32 s22, s21, 1
  s_min_u32 s22, s22, 6
  s_lshl_b32 s21, s21, 12
  s_lshl_b32 s22, s22, 12
  v_lshlrev_b32 v5, 4, v2
  v_add_u32 v5, 98304, v5
  v_add_u32 v6, s21, v5
  v_add_u32 v7, s22, v5
  s_waitcnt lgkmcnt(0) vmcnt(15)
  s_barrier
  ds_read_b128 a[64:67], v6 offset:0
  ds_read_b128 a[68:71], v7 offset:0
  ds_read_b128 a[72:75], v6 offset:1024
  ds_read_b128 a[76:79], v7 offset:1024
  ds_read_b128 a[80:83], v6 offset:2048
  ds_read_b128 a[84:87], v7 offset:2048
  ds_read_b128 a[88:91], v6 offset:3072
  ds_read_b128 a[92:95], v7 offset:3072
  ds_read_b64_tr_b16 v[192:193], v12 offset:0
  ds_read_b64_tr_b16 v[194:195], v12 offset:4096
  ds_read_b64_tr_b16 v[196:197], v13 offset:0
  ds_read_b64_tr_b16 v[198:199], v13 offset:4096
  ds_read_b64_tr_b16 v[200:201], v14 offset:0
  ds_read_b64_tr_b16 v[202:203], v14 offset:4096
  ds_read_b64_tr_b16 v[204:205], v15 offset:0
  ds_read_b64_tr_b16 v[206:207], v15 offset:4096
  ds_read_b64_tr_b16 v[208:209], v16 offset:0
  ds_read_b64_tr_b16 v[210:211], v16 offset:4096
  ds_read_b64_tr_b16 v[212:213], v17 offset:0
  ds_read_b64_tr_b16 v[214:215], v17 offset:4096
  ds_read_b64_tr_b16 v[216:217], v18 offset:0
  ds_read_b64_tr_b16 v[218:219], v18 offset:4096
  ds_read_b64_tr_b16 v[220:221], v19 offset:0
  ds_read_b64_tr_b16 v[222:223], v19 offset:4096
  s_waitcnt lgkmcnt(0)
  v_mfma_f32_16x16x32_bf16 a[0:3], v[192:195], a[64:67], 0
  ds_read_b64_tr_b16 v[224:225], v12 offset:8192
  s_add_u32 m0, s37, 0
  v_mfma_f32_16x16x32_bf16 a[32:35], v[192:195], a[68:71], 0
  ds_read_b64_tr_b16 v[226:227], v12 offset:12288
  global_load_lds_dwordx4 v92, s[14:15] offset:0
  v_mfma_f32_16x16x32_bf16 a[4:7], v[196:199], a[64:67], 0
  ds_read_b64_tr_b16 v[228:229], v13 offset:8192
  v_mfma_f32_16x16x32_bf16 a[36:39], v[196:199], a[68:71], 0
  ds_read_b64_tr_b16 v[230:231], v13 offset:12288
  global_load_lds_dwordx4 v93, s[14:15] offset:1024
  s_add_u32 s38, s38, 0x8000
  s_and_b32 s38, s38, 0xfffff
  s_add_u32 s14, s56, s38
  s_addc_u32 s15, s57, 0
  v_mfma_f32_16x16x32_bf16 a[8:11], v[200:203], a[64:67], 0
  ds_read_b64_tr_b16 v[232:233], v14 offset:8192
  s_add_u32 m0, s37, 8192
  v_mfma_f32_16x16x32_bf16 a[40:43], v[200:203], a[68:71], 0
  ds_read_b64_tr_b16 v[234:235], v14 offset:12288
  global_load_lds_dwordx4 v92, s[14:15] offset:0
  v_mfma_f32_16x16x32_bf16 a[12:15], v[204:207], a[64:67], 0
  ds_read_b64_tr_b16 v[236:237], v15 offset:8192
  v_mfma_f32_16x16x32_bf16 a[44:47], v[204:207], a[68:71], 0
  ds_read_b64_tr_b16 v[238:239], v15 offset:12288
  global_load_lds_dwordx4 v93, s[14:15] offset:1024
  s_add_u32 s38, s38, 0x8000
  s_and_b32 s38, s38, 0xfffff
  s_add_u32 s14, s56, s38
  s_addc_u32 s15, s57, 0
  v_mfma_f32_16x16x32_bf16 a[16:19], v[208:211], a[64:67], 0
  ds_read_b64_tr_b16 v[240:241], v16 offset:8192
  v_mfma_f32_16x16x32_bf16 a[48:51], v[208:211], a[68:71], 0
  ds_read_b64_tr_b16 v[242:243], v16 offset:12288
  v_mfma_f32_16x16x32_bf16 a[20:23], v[212:215], a[64:67], 0
  ds_read_b64_tr_b16 v[244:245], v17 offset:8192
  v_mfma_f32_16x16x32_bf16 a[52:55], v[212:215], a[68:71], 0
  ds_read_b64_tr_b16 v[246:247], v17 offset:12288
  v_mfma_f32_16x16x32_bf16 a[24:27], v[216:219], a[64:67], 0
  ds_read_b64_tr_b16 v[248:249], v18 offset:8192
  v_mfma_f32_16x16x32_bf16 a[56:59], v[216:219], a[68:71], 0
  ds_read_b64_tr_b16 v[250:251], v18 offset:12288
  v_mfma_f32_16x16x32_bf16 a[28:31], v[220:223], a[64:67], 0
  ds_read_b64_tr_b16 v[252:253], v19 offset:8192
  v_mfma_f32_16x16x32_bf16 a[60:63], v[220:223], a[68:71], 0
  ds_read_b64_tr_b16 v[254:255], v19 offset:12288
  s_waitcnt lgkmcnt(14)
  v_mfma_f32_16x16x32_bf16 a[0:3], v[224:227], a[72:75], a[0:3]
  ds_read_b64_tr_b16 v[192:193], v12 offset:16384
  s_add_u32 m0, s37, 16384
  v_mfma_f32_16x16x32_bf16 a[32:35], v[224:227], a[76:79], a[32:35]
  s_waitcnt lgkmcnt(13)
  ds_read_b64_tr_b16 v[194:195], v12 offset:20480
  global_load_lds_dwordx4 v92, s[14:15] offset:0
  v_mfma_f32_16x16x32_bf16 a[4:7], v[228:231], a[72:75], a[4:7]
  ds_read_b64_tr_b16 v[196:197], v13 offset:16384
  v_mfma_f32_16x16x32_bf16 a[36:39], v[228:231], a[76:79], a[36:39]
  s_waitcnt lgkmcnt(13)
  ds_read_b64_tr_b16 v[198:199], v13 offset:20480
  global_load_lds_dwordx4 v93, s[14:15] offset:1024
  s_add_u32 s38, s38, 0x8000
  s_and_b32 s38, s38, 0xfffff
  s_add_u32 s14, s56, s38
  s_addc_u32 s15, s57, 0
  v_mfma_f32_16x16x32_bf16 a[8:11], v[232:235], a[72:75], a[8:11]
  ds_read_b64_tr_b16 v[200:201], v14 offset:16384
  s_add_u32 m0, s37, 24576
  v_mfma_f32_16x16x32_bf16 a[40:43], v[232:235], a[76:79], a[40:43]
  s_waitcnt lgkmcnt(13)
  ds_read_b64_tr_b16 v[202:203], v14 offset:20480
  global_load_lds_dwordx4 v92, s[14:15] offset:0
  v_mfma_f32_16x16x32_bf16 a[12:15], v[236:239], a[72:75], a[12:15]
  ds_read_b64_tr_b16 v[204:205], v15 offset:16384
  v_mfma_f32_16x16x32_bf16 a[44:47], v[236:239], a[76:79], a[44:47]
  s_waitcnt lgkmcnt(13)
  ds_read_b64_tr_b16 v[206:207], v15 offset:20480
  global_load_lds_dwordx4 v93, s[14:15] offset:1024
  s_add_u32 s38, s38, 0x8000
  s_and_b32 s38, s38, 0xfffff
  s_add_u32 s14, s56, s38
  s_addc_u32 s15, s57, 0
  v_mfma_f32_16x16x32_bf16 a[16:19], v[240:243], a[72:75], a[16:19]
  ds_read_b64_tr_b16 v[208:209], v16 offset:16384
  v_mfma_f32_16x16x32_bf16 a[48:51], v[240:243], a[76:79], a[48:51]
  s_waitcnt lgkmcnt(13)
  ds_read_b64_tr_b16 v[210:211], v16 offset:20480
  v_mfma_f32_16x16x32_bf16 a[20:23], v[244:247], a[72:75], a[20:23]
  ds_read_b64_tr_b16 v[212:213], v17 offset:16384
  v_mfma_f32_16x16x32_bf16 a[52:55], v[244:247], a[76:79], a[52:55]
  s_waitcnt lgkmcnt(13)
  ds_read_b64_tr_b16 v[214:215], v17 offset:20480
  v_mfma_f32_16x16x32_bf16 a[24:27], v[248:251], a[72:75], a[24:27]
  ds_read_b64_tr_b16 v[216:217], v18 offset:16384
  v_mfma_f32_16x16x32_bf16 a[56:59], v[248:251], a[76:79], a[56:59]
  s_waitcnt lgkmcnt(13)
  ds_read_b64_tr_b16 v[218:219], v18 offset:20480
  v_mfma_f32_16x16x32_bf16 a[28:31], v[252:255], a[72:75], a[28:31]
  ds_read_b64_tr_b16 v[220:221], v19 offset:16384
  v_mfma_f32_16x16x32_bf16 a[60:63], v[252:255], a[76:79], a[60:63]
  ds_read_b64_tr_b16 v[222:223], v19 offset:20480
  s_waitcnt lgkmcnt(14)
  v_mfma_f32_16x16x32_bf16 a[0:3], v[192:195], a[80:83], a[0:3]
  ds_read_b64_tr_b16 v[224:225], v12 offset:24576
  s_add_u32 m0, s37, 32768
  v_mfma_f32_16x16x32_bf16 a[32:35], v[192:195], a[84:87], a[32:35]
  s_waitcnt lgkmcnt(13)
  ds_read_b64_tr_b16 v[226:227], v12 offset:28672
  global_load_lds_dwordx4 v92, s[14:15] offset:0
  v_mfma_f32_16x16x32_bf16 a[4:7], v[196:199], a[80:83], a[4:7]
  ds_read_b64_tr_b16 v[228:229], v13 offset:24576
  v_mfma_f32_16x16x32_bf16 a[36:39], v[196:199], a[84:87], a[36:39]
  s_waitcnt lgkmcnt(13)
  ds_read_b64_tr_b16 v[230:231], v13 offset:28672
  global_load_lds_dwordx4 v93, s[14:15] offset:1024
  s_add_u32 s38, s38, 0x8000
  s_and_b32 s38, s38, 0xfffff
  s_add_u32 s14, s56, s38
  s_addc_u32 s15, s57, 0
  v_mfma_f32_16x16x32_bf16 a[8:11], v[200:203], a[80:83], a[8:11]
  ds_read_b64_tr_b16 v[232:233], v14 offset:24576
  s_add_u32 m0, s37, 40960
  v_mfma_f32_16x16x32_bf16 a[40:43], v[200:203], a[84:87], a[40:43]
  s_waitcnt lgkmcnt(13)
  ds_read_b64_tr_b16 v[234:235], v14 offset:28672
  global_load_lds_dwordx4 v92, s[14:15] offset:0
  v_mfma_f32_16x16x32_bf16 a[12:15], v[204:207], a[80:83], a[12:15]
  ds_read_b64_tr_b16 v[236:237], v15 offset:24576
  v_mfma_f32_16x16x32_bf16 a[44:47], v[204:207], a[84:87], a[44:47]
  s_waitcnt lgkmcnt(13)
  ds_read_b64_tr_b16 v[238:239], v15 offset:28672
  global_load_lds_dwordx4 v93, s[14:15] offset:1024
  s_add_u32 s38, s38, 0x8000
  s_and_b32 s38, s38, 0xfffff
  s_add_u32 s14, s56, s38
  s_addc_u32 s15, s57, 0
  v_mfma_f32_16x16x32_bf16 a[16:19], v[208:211], a[80:83], a[16:19]
  ds_read_b64_tr_b16 v[240:241], v16 offset:24576
  v_mfma_f32_16x16x32_bf16 a[48:51], v[208:211], a[84:87], a[48:51]
  s_waitcnt lgkmcnt(13)
  ds_read_b64_tr_b16 v[242:243], v16 offset:28672
  v_mfma_f32_16x16x32_bf16 a[20:23], v[212:215], a[80:83], a[20:23]
  ds_read_b64_tr_b16 v[244:245], v17 offset:24576
  v_mfma_f32_16x16x32_bf16 a[52:55], v[212:215], a[84:87], a[52:55]
  s_waitcnt lgkmcnt(13)
  ds_read_b64_tr_b16 v[246:247], v17 offset:28672
  v_mfma_f32_16x16x32_bf16 a[24:27], v[216:219], a[80:83], a[24:27]
  ds_read_b64_tr_b16 v[248:249], v18 offset:24576
  v_mfma_f32_16x16x32_bf16 a[56:59], v[216:219], a[84:87], a[56:59]
  s_waitcnt lgkmcnt(13)
  ds_read_b64_tr_b16 v[250:251], v18 offset:28672
  v_mfma_f32_16x16x32_bf16 a[28:31], v[220:223], a[80:83], a[28:31]
  ds_read_b64_tr_b16 v[252:253], v19 offset:24576
  v_mfma_f32_16x16x32_bf16 a[60:63], v[220:223], a[84:87], a[60:63]
  ds_read_b64_tr_b16 v[254:255], v19 offset:28672
  s_waitcnt lgkmcnt(14)
  v_mfma_f32_16x16x32_bf16 a[0:3], v[224:227], a[88:91], a[0:3]
  s_add_u32 m0, s37, 49152
  v_mfma_f32_16x16x32_bf16 a[32:35], v[224:227], a[92:95], a[32:35]
  s_waitcnt lgkmcnt(12)
  global_load_lds_dwordx4 v92, s[14:15] offset:0
  v_mfma_f32_16x16x32_bf16 a[4:7], v[228:231], a[88:91], a[4:7]
  v_mfma_f32_16x16x32_bf16 a[36:39], v[228:231], a[92:95], a[36:39]
  s_waitcnt lgkmcnt(10)
  global_load_lds_dwordx4 v93, s[14:15] offset:1024
  s_add_u32 s38, s38, 0x8000
  s_and_b32 s38, s38, 0xfffff
  s_add_u32 s14, s56, s38
  s_addc_u32 s15, s57, 0
  v_mfma_f32_16x16x32_bf16 a[8:11], v[232:235], a[88:91], a[8:11]
  s_add_u32 m0, s37, 57344
  v_mfma_f32_16x16x32_bf16 a[40:43], v[232:235], a[92:95], a[40:43]
  s_waitcnt lgkmcnt(8)
  global_load_lds_dwordx4 v92, s[14:15] offset:0
  v_mfma_f32_16x16x32_bf16 a[12:15], v[236:239], a[88:91], a[12:15]
  v_mfma_f32_16x16x32_bf16 a[44:47], v[236:239], a[92:95], a[44:47]
  s_waitcnt lgkmcnt(6)
  global_load_lds_dwordx4 v93, s[14:15] offset:1024
  s_add_u32 s38, s38, 0x8000
  s_and_b32 s38, s38, 0xfffff
  s_add_u32 s14, s56, s38
  s_addc_u32 s15, s57, 0
  v_mfma_f32_16x16x32_bf16 a[16:19], v[240:243], a[88:91], a[16:19]
  v_mfma_f32_16x16x32_bf16 a[48:51], v[240:243], a[92:95], a[48:51]
  s_waitcnt lgkmcnt(4)
  v_mfma_f32_16x16x32_bf16 a[20:23], v[244:247], a[88:91], a[20:23]
  v_mfma_f32_16x16x32_bf16 a[52:55], v[244:247], a[92:95], a[52:55]
  s_waitcnt lgkmcnt(2)
  v_mfma_f32_16x16x32_bf16 a[24:27], v[248:251], a[88:91], a[24:27]
  v_mfma_f32_16x16x32_bf16 a[56:59], v[248:251], a[92:95], a[56:59]
  s_waitcnt lgkmcnt(0)
  v_mfma_f32_16x16x32_bf16 a[28:31], v[252:255], a[88:91], a[28:31]
  v_mfma_f32_16x16x32_bf16 a[60:63], v[252:255], a[92:95], a[60:63]
  s_waitcnt vmcnt(16)
  s_barrier
  v_cmp_eq_u32 vcc, 0, v0
  s_and_saveexec_b64 s[20:21], vcc
  s_cbranch_execz L_f1_done
  s_lshl_b32 s22, s44, 2
  s_add_u32 s22, s22, s46
  s_lshl_b32 s22, s22, 7
  s_and_b32 s23, s45, 7
  s_lshl_b32 s23, s23, 3
  s_add_u32 s22, s22, s23
  s_add_u32 s22, s22, 33554432
  v_mov_b32 v34, s22
  v_mov_b32 v36, s64
  v_mov_b32 v37, s65
  global_store_dwordx2 v34, v[36:37], s[8:9] sc1
L_f1_done:
  s_mov_b64 exec, s[20:21]
  s_add_u32 m0, s37, 65536
  s_nop 0
  global_load_lds_dwordx4 v92, s[14:15] offset:0
  global_load_lds_dwordx4 v93, s[14:15] offset:1024
  s_add_u32 s38, s38, 0x8000
  s_and_b32 s38, s38, 0xfffff
  s_add_u32 s14, s56, s38
  s_addc_u32 s15, s57, 0
  s_add_u32 m0, s37, 73728
  s_nop 0
  global_load_lds_dwordx4 v92, s[14:15] offset:0
  global_load_lds_dwordx4 v93, s[14:15] offset:1024
  s_add_u32 s38, s38, 0x8000
  s_and_b32 s38, s38, 0xfffff
  s_add_u32 s14, s56, s38
  s_addc_u32 s15, s57, 0
  s_add_u32 m0, s37, 81920
  s_nop 0
  global_load_lds_dwordx4 v92, s[14:15] offset:0
  global_load_lds_dwordx4 v93, s[14:15] offset:1024
  s_add_u32 s38, s38, 0x8000
  s_and_b32 s38, s38, 0xfffff
  s_add_u32 s14, s56, s38
  s_addc_u32 s15, s57, 0
  s_add_u32 m0, s37, 90112
  s_nop 0
  global_load_lds_dwordx4 v92, s[14:15] offset:0
  global_load_lds_dwordx4 v93, s[14:15] offset:1024
  s_add_u32 s38, s38, 0x8000
  s_and_b32 s38, s38, 0xfffff
  s_add_u32 s14, s56, s38
  s_addc_u32 s15, s57, 0
  s_add_u32 m0, s37, 98304
  s_nop 0
  global_load_lds_dwordx4 v92, s[14:15] offset:0
  global_load_lds_dwordx4 v93, s[14:15] offset:1024
  s_add_u32 s38, s38, 0x8000
  s_and_b32 s38, s38, 0xfffff
  s_add_u32 s14, s56, s38
  s_addc_u32 s15, s57, 0
  s_add_u32 m0, s37, 106496
  s_nop 0
  global_load_lds_dwordx4 v92, s[14:15] offset:0
  global_load_lds_dwordx4 v93, s[14:15] offset:1024
  s_add_u32 s38, s38, 0x8000
  s_and_b32 s38, s38, 0xfffff
  s_add_u32 s14, s56, s38
  s_addc_u32 s15, s57, 0
  s_add_u32 m0, s37, 114688
  s_nop 0
  global_load_lds_dwordx4 v92, s[14:15] offset:0
  global_load_lds_dwordx4 v93, s[14:15] offset:1024
  s_add_u32 s38, s38, 0x8000
  s_and_b32 s38, s38, 0xfffff
  s_add_u32 s14, s56, s38
  s_addc_u32 s15, s57, 0
  s_add_u32 m0, s37, 122880
  s_nop 0
  global_load_lds_dwordx4 v92, s[14:15] offset:0
  global_load_lds_dwordx4 v93, s[14:15] offset:1024
  s_add_u32 s38, s38, 0x8000
  s_and_b32 s38, s38, 0xfffff
  s_add_u32 s14, s56, s38
  s_addc_u32 s15, s57, 0
  s_lshl_b32 s22, s44, 2
  s_add_u32 s22, s22, s46
  s_lshl_b32 s22, s22, 7
  s_add_u32 s22, s22, 33554432
  v_and_b32 v34, 7, v2
  v_lshlrev_b32 v34, 3, v34
  v_add_u32 v34, s22, v34
  s_mov_b32 s25, 0
  s_mov_b64 exec, 0xff
  global_load_dwordx2 v[36:37], v34, s[8:9] sc1
  s_sleep 3
  global_load_dwordx2 v[38:39], v34, s[8:9] sc1
  s_sleep 3
  global_load_dwordx2 v[24:25], v34, s[8:9] sc1
  s_sleep 3
L_poll1:
  global_load_dwordx2 v[26:27], v34, s[8:9] sc1
  s_waitcnt vmcnt(3)
  v_cmp_ne_u32 vcc, s64, v36
  v_cmp_ne_u32 s[26:27], s65, v37
  s_nop 3
  s_or_b64 s[26:27], vcc, s[26:27]
  s_cbranch_scc0 L_poll1_ok
  global_load_dwordx2 v[36:37], v34, s[8:9] sc1
  s_waitcnt vmcnt(3)
  v_cmp_ne_u32 vcc, s64, v38
  v_cmp_ne_u32 s[26:27], s65, v39
  s_nop 3
  s_or_b64 s[26:27], vcc, s[26:27]
  s_cbranch_scc0 L_poll1_ok
  global_load_dwordx2 v[38:39], v34, s[8:9] sc1
  s_waitcnt vmcnt(3)
  v_cmp_ne_u32 vcc, s64, v24
  v_cmp_ne_u32 s[26:27], s65, v25
  s_nop 3
  s_or_b64 s[26:27], vcc, s[26:27]
  s_cbranch_scc0 L_poll1_ok
  global_load_dwordx2 v[24:25], v34, s[8:9] sc1
  s_waitcnt vmcnt(3)
  v_cmp_ne_u32 vcc, s64, v26
  v_cmp_ne_u32 s[26:27], s65, v27
  s_nop 3
  s_or_b64 s[26:27], vcc, s[26:27]
  s_cbranch_scc0 L_poll1_ok
  s_add_u32 s25, s25, 1
  s_cmp_lt_u32 s25, 1048576
  s_cbranch_scc1 L_poll1
L_poll1_ok:
  s_mov_b64 exec, -1
  global_load_dwordx4 a[96:99], v22, s[18:19] offset:0 sc1
  global_load_dwordx4 a[100:103], v23, s[18:19] offset:0 sc1
  global_load_dwordx4 a[104:107], v22, s[18:19] offset:1024 sc1
  global_load_dwordx4 a[108:111], v23, s[18:19] offset:1024 sc1
  global_load_dwordx4 a[112:115], v22, s[18:19] offset:2048 sc1
  global_load_dwordx4 a[116:119], v23, s[18:19] offset:2048 sc1
  s_barrier
  v_add_u32 v12, 0xfffe0000, v12
  v_add_u32 v13, 0xfffe0000, v13
  v_add_u32 v14, 0xfffe0000, v14
  v_add_u32 v15, 0xfffe0000, v15
  v_add_u32 v16, 0xfffe0000, v16
  v_add_u32 v17, 0xfffe0000, v17
  v_add_u32 v18, 0xfffe0000, v18
  v_add_u32 v19, 0xfffe0000, v19
  ds_read_b64_tr_b16 v[192:193], v12 offset:0
  ds_read_b64_tr_b16 v[194:195], v12 offset:4096
  ds_read_b64_tr_b16 v[196:197], v13 offset:0
  ds_read_b64_tr_b16 v[198:199], v13 offset:4096
  ds_read_b64_tr_b16 v[200:201], v14 offset:0
  ds_read_b64_tr_b16 v[202:203], v14 offset:4096
  ds_read_b64_tr_b16 v[204:205], v15 offset:0
  ds_read_b64_tr_b16 v[206:207], v15 offset:4096
  ds_read_b64_tr_b16 v[208:209], v16 offset:0
  ds_read_b64_tr_b16 v[210:211], v16 offset:4096
  ds_read_b64_tr_b16 v[212:213], v17 offset:0
  ds_read_b64_tr_b16 v[214:215], v17 offset:4096
  ds_read_b64_tr_b16 v[216:217], v18 offset:0
  ds_read_b64_tr_b16 v[218:219], v18 offset:4096
  ds_read_b64_tr_b16 v[220:221], v19 offset:0
  ds_read_b64_tr_b16 v[222:223], v19 offset:4096
  s_waitcnt vmcnt(4)
  s_waitcnt lgkmcnt(14)
  v_mfma_f32_16x16x32_bf16 a[0:3], v[192:195], a[96:99], a[0:3]
  ds_read_b64_tr_b16 v[224:225], v12 offset:8192
  v_mfma_f32_16x16x32_bf16 a[32:35], v[192:195], a[100:103], a[32:35]
  s_waitcnt lgkmcnt(13)
  ds_read_b64_tr_b16 v[226:227], v12 offset:12288
  v_mfma_f32_16x16x32_bf16 a[4:7], v[196:199], a[96:99], a[4:7]
  ds_read_b64_tr_b16 v[228:229], v13 offset:8192
  v_mfma_f32_16x16x32_bf16 a[36:39], v[196:199], a[100:103], a[36:39]
  s_waitcnt lgkmcnt(13)
  ds_read_b64_tr_b16 v[230:231], v13 offset:12288
  v_mfma_f32_16x16x32_bf16 a[8:11], v[200:203], a[96:99], a[8:11]
  ds_read_b64_tr_b16 v[232:233], v14 offset:8192
  v_mfma_f32_16x16x32_bf16 a[40:43], v[200:203], a[100:103], a[40:43]
  s_waitcnt lgkmcnt(13)
  ds_read_b64_tr_b16 v[234:235], v14 offset:12288
  v_mfma_f32_16x16x32_bf16 a[12:15], v[204:207], a[96:99], a[12:15]
  ds_read_b64_tr_b16 v[236:237], v15 offset:8192
  v_mfma_f32_16x16x32_bf16 a[44:47], v[204:207], a[100:103], a[44:47]
  s_waitcnt lgkmcnt(13)
  ds_read_b64_tr_b16 v[238:239], v15 offset:12288
  v_mfma_f32_16x16x32_bf16 a[16:19], v[208:211], a[96:99], a[16:19]
  ds_read_b64_tr_b16 v[240:241], v16 offset:8192
  v_mfma_f32_16x16x32_bf16 a[48:51], v[208:211], a[100:103], a[48:51]
  s_waitcnt lgkmcnt(13)
  ds_read_b64_tr_b16 v[242:243], v16 offset:12288
  global_load_dwordx4 a[120:123], v22, s[18:19] offset:3072 sc1
  v_mfma_f32_16x16x32_bf16 a[20:23], v[212:215], a[96:99], a[20:23]
  ds_read_b64_tr_b16 v[244:245], v17 offset:8192
  v_mfma_f32_16x16x32_bf16 a[52:55], v[212:215], a[100:103], a[52:55]
  s_waitcnt lgkmcnt(13)
  ds_read_b64_tr_b16 v[246:247], v17 offset:12288
  global_load_dwordx4 a[124:127], v23, s[18:19] offset:3072 sc1
  s_add_u32 s39, s39, 4096
  s_and_b32 s39, s39, 0x7fff
  s_add_u32 s18, s58, s39
  s_addc_u32 s19, s59, 0
  v_mfma_f32_16x16x32_bf16 a[24:27], v[216:219], a[96:99], a[24:27]
  ds_read_b64_tr_b16 v[248:249], v18 offset:8192
  v_mfma_f32_16x16x32_bf16 a[56:59], v[216:219], a[100:103], a[56:59]
  s_waitcnt lgkmcnt(13)
  ds_read_b64_tr_b16 v[250:251], v18 offset:12288
  global_load_dwordx4 a[64:67], v22, s[18:19] offset:0 sc1
  v_mfma_f32_16x16x32_bf16 a[28:31], v[220:223], a[96:99], a[28:31]
  ds_read_b64_tr_b16 v[252:253], v19 offset:8192
  v_mfma_f32_16x16x32_bf16 a[60:63], v[220:223], a[100:103], a[60:63]
  ds_read_b64_tr_b16 v[254:255], v19 offset:12288
  global_load_dwordx4 a[68:71], v23, s[18:19] offset:0 sc1
  s_waitcnt vmcnt(6)
  s_waitcnt lgkmcnt(14)
  v_mfma_f32_16x16x32_bf16 a[0:3], v[224:227], a[104:107], a[0:3]
  ds_read_b64_tr_b16 v[192:193], v12 offset:16384
  s_add_u32 m0, s37, 131072
  v_mfma_f32_16x16x32_bf16 a[32:35], v[224:227], a[108:111], a[32:35]
  s_waitcnt lgkmcnt(13)
  ds_read_b64_tr_b16 v[194:195], v12 offset:20480
  global_load_lds_dwordx4 v92, s[14:15] offset:0
  v_mfma_f32_16x16x32_bf16 a[4:7], v[228:231], a[104:107], a[4:7]
  ds_read_b64_tr_b16 v[196:197], v13 offset:16384
  v_mfma_f32_16x16x32_bf16 a[36:39], v[228:231], a[108:111], a[36:39]
  s_waitcnt lgkmcnt(13)
  ds_read_b64_tr_b16 v[198:199], v13 offset:20480
  global_load_lds_dwordx4 v93, s[14:15] offset:1024
  s_add_u32 s38, s38, 0x8000
  s_and_b32 s38, s38, 0xfffff
  s_add_u32 s14, s56, s38
  s_addc_u32 s15, s57, 0
  v_mfma_f32_16x16x32_bf16 a[8:11], v[232:235], a[104:107], a[8:11]
  ds_read_b64_tr_b16 v[200:201], v14 offset:16384
  s_add_u32 m0, s37, 139264
  v_mfma_f32_16x16x32_bf16 a[40:43], v[232:235], a[108:111], a[40:43]
  s_waitcnt lgkmcnt(13)
  ds_read_b64_tr_b16 v[202:203], v14 offset:20480
  global_load_lds_dwordx4 v92, s[14:15] offset:0
  v_mfma_f32_16x16x32_bf16 a[12:15], v[236:239], a[104:107], a[12:15]
  ds_read_b64_tr_b16 v[204:205], v15 offset:16384
  v_mfma_f32_16x16x32_bf16 a[44:47], v[236:239], a[108:111], a[44:47]
  s_waitcnt lgkmcnt(13)
  ds_read_b64_tr_b16 v[206:207], v15 offset:20480
  global_load_lds_dwordx4 v93, s[14:15] offset:1024
  s_add_u32 s38, s38, 0x8000
  s_and_b32 s38, s38, 0xfffff
  s_add_u32 s14, s56, s38
  s_addc_u32 s15, s57, 0
  v_mfma_f32_16x16x32_bf16 a[16:19], v[240:243], a[104:107], a[16:19]
  ds_read_b64_tr_b16 v[208:209], v16 offset:16384
  v_mfma_f32_16x16x32_bf16 a[48:51], v[240:243], a[108:111], a[48:51]
  s_waitcnt lgkmcnt(13)
  ds_read_b64_tr_b16 v[210:211], v16 offset:20480
  global_load_dwordx4 a[72:75], v22, s[18:19] offset:1024 sc1
  v_mfma_f32_16x16x32_bf16 a[20:23], v[244:247], a[104:107], a[20:23]
  ds_read_b64_tr_b16 v[212:213], v17 offset:16384
  v_mfma_f32_16x16x32_bf16 a[52:55], v[244:247], a[108:111], a[52:55]
  s_waitcnt lgkmcnt(13)
  ds_read_b64_tr_b16 v[214:215], v17 offset:20480
  global_load_dwordx4 a[76:79], v23, s[18:19] offset:1024 sc1
  v_mfma_f32_16x16x32_bf16 a[24:27], v[248:251], a[104:107], a[24:27]
  ds_read_b64_tr_b16 v[216:217], v18 offset:16384
  v_mfma_f32_16x16x32_bf16 a[56:59], v[248:251], a[108:111], a[56:59]
  s_waitcnt lgkmcnt(13)
  ds_read_b64_tr_b16 v[218:219], v18 offset:20480
  global_load_dwordx4 a[80:83], v22, s[18:19] offset:2048 sc1
  v_mfma_f32_16x16x32_bf16 a[28:31], v[252:255], a[104:107], a[28:31]
  ds_read_b64_tr_b16 v[220:221], v19 offset:16384
  v_mfma_f32_16x16x32_bf16 a[60:63], v[252:255], a[108:111], a[60:63]
  ds_read_b64_tr_b16 v[222:223], v19 offset:20480
  global_load_dwordx4 a[84:87], v23, s[18:19] offset:2048 sc1
  s_waitcnt vmcnt(12)
  s_waitcnt lgkmcnt(14)
  v_mfma_f32_16x16x32_bf16 a[0:3], v[192:195], a[112:115], a[0:3]
  ds_read_b64_tr_b16 v[224:225], v12 offset:24576
  s_add_u32 m0, s37, 147456
  v_mfma_f32_16x16x32_bf16 a[32:35], v[192:195], a[116:119], a[32:35]
  s_waitcnt lgkmcnt(13)
  ds_read_b64_tr_b16 v[226:227], v12 offset:28672
  global_load_lds_dwordx4 v92, s[14:15] offset:0
  v_mfma_f32_16x16x32_bf16 a[4:7], v[196:199], a[112:115], a[4:7]
  ds_read_b64_tr_b16 v[228:229], v13 offset:24576
  v_mfma_f32_16x16x32_bf16 a[36:39], v[196:199], a[116:119], a[36:39]
  s_waitcnt lgkmcnt(13)
  ds_read_b64_tr_b16 v[230:231], v13 offset:28672
  global_load_lds_dwordx4 v93, s[14:15] offset:1024
  s_add_u32 s38, s38, 0x8000
  s_and_b32 s38, s38, 0xfffff
  s_add_u32 s14, s56, s38
  s_addc_u32 s15, s57, 0
  v_mfma_f32_16x16x32_bf16 a[8:11], v[200:203], a[112:115], a[8:11]
  ds_read_b64_tr_b16 v[232:233], v14 offset:24576
  s_add_u32 m0, s37, 155648
  v_mfma_f32_16x16x32_bf16 a[40:43], v[200:203], a[116:119], a[40:43]
  s_waitcnt lgkmcnt(13)
  ds_read_b64_tr_b16 v[234:235], v14 offset:28672
  global_load_lds_dwordx4 v92, s[14:15] offset:0
  v_mfma_f32_16x16x32_bf16 a[12:15], v[204:207], a[112:115], a[12:15]
  ds_read_b64_tr_b16 v[236:237], v15 offset:24576
  v_mfma_f32_16x16x32_bf16 a[44:47], v[204:207], a[116:119], a[44:47]
  s_waitcnt lgkmcnt(13)
  ds_read_b64_tr_b16 v[238:239], v15 offset:28672
  global_load_lds_dwordx4 v93, s[14:15] offset:1024
  s_add_u32 s38, s38, 0x8000
  s_and_b32 s38, s38, 0xfffff
  s_add_u32 s14, s56, s38
  s_addc_u32 s15, s57, 0
  v_mfma_f32_16x16x32_bf16 a[16:19], v[208:211], a[112:115], a[16:19]
  ds_read_b64_tr_b16 v[240:241], v16 offset:24576
  v_mfma_f32_16x16x32_bf16 a[48:51], v[208:211], a[116:119], a[48:51]
  s_waitcnt lgkmcnt(13)
  ds_read_b64_tr_b16 v[242:243], v16 offset:28672
  global_load_dwordx4 a[88:91], v22, s[18:19] offset:3072 sc1
  v_mfma_f32_16x16x32_bf16 a[20:23], v[212:215], a[112:115], a[20:23]
  ds_read_b64_tr_b16 v[244:245], v17 offset:24576
  v_mfma_f32_16x16x32_bf16 a[52:55], v[212:215], a[116:119], a[52:55]
  s_waitcnt lgkmcnt(13)
  ds_read_b64_tr_b16 v[246:247], v17 offset:28672
  global_load_dwordx4 a[92:95], v23, s[18:19] offset:3072 sc1
  s_add_u32 s39, s39, 4096
  s_and_b32 s39, s39, 0x7fff
  s_add_u32 s18, s58, s39
  s_addc_u32 s19, s59, 0
  v_mfma_f32_16x16x32_bf16 a[24:27], v[216:219], a[112:115], a[24:27]
  ds_read_b64_tr_b16 v[248:249], v18 offset:24576
  v_mfma_f32_16x16x32_bf16 a[56:59], v[216:219], a[116:119], a[56:59]
  s_waitcnt lgkmcnt(13)
  ds_read_b64_tr_b16 v[250:251], v18 offset:28672
  global_load_dwordx4 a[96:99], v22, s[18:19] offset:0 sc1
  v_mfma_f32_16x16x32_bf16 a[28:31], v[220:223], a[112:115], a[28:31]
  ds_read_b64_tr_b16 v[252:253], v19 offset:24576
  v_mfma_f32_16x16x32_bf16 a[60:63], v[220:223], a[116:119], a[60:63]
  ds_read_b64_tr_b16 v[254:255], v19 offset:28672
  global_load_dwordx4 a[100:103], v23, s[18:19] offset:0 sc1
  s_waitcnt vmcnt(18)
  s_waitcnt lgkmcnt(14)
  v_mfma_f32_16x16x32_bf16 a[0:3], v[224:227], a[120:123], a[0:3]
  ds_read_b64_tr_b16 v[192:193], v12 offset:32768
  v_mfma_f32_16x16x32_bf16 a[32:35], v[224:227], a[124:127], a[32:35]
  s_waitcnt lgkmcnt(13)
  ds_read_b64_tr_b16 v[194:195], v12 offset:36864
  v_mfma_f32_16x16x32_bf16 a[4:7], v[228:231], a[120:123], a[4:7]
  ds_read_b64_tr_b16 v[196:197], v13 offset:32768
  v_mfma_f32_16x16x32_bf16 a[36:39], v[228:231], a[124:127], a[36:39]
  s_waitcnt lgkmcnt(13)
  ds_read_b64_tr_b16 v[198:199], v13 offset:36864
  v_mfma_f32_16x16x32_bf16 a[8:11], v[232:235], a[120:123], a[8:11]
  ds_read_b64_tr_b16 v[200:201], v14 offset:32768
  v_mfma_f32_16x16x32_bf16 a[40:43], v[232:235], a[124:127], a[40:43]
  s_waitcnt lgkmcnt(13)
  ds_read_b64_tr_b16 v[202:203], v14 offset:36864
  v_mfma_f32_16x16x32_bf16 a[12:15], v[236:239], a[120:123], a[12:15]
  ds_read_b64_tr_b16 v[204:205], v15 offset:32768
  v_mfma_f32_16x16x32_bf16 a[44:47], v[236:239], a[124:127], a[44:47]
  s_waitcnt lgkmcnt(13)
  ds_read_b64_tr_b16 v[206:207], v15 offset:36864
  v_mfma_f32_16x16x32_bf16 a[16:19], v[240:243], a[120:123], a[16:19]
  ds_read_b64_tr_b16 v[208:209], v16 offset:32768
  v_mfma_f32_16x16x32_bf16 a[48:51], v[240:243], a[124:127], a[48:51]
  s_waitcnt lgkmcnt(13)
  ds_read_b64_tr_b16 v[210:211], v16 offset:36864
  global_load_dwordx4 a[104:107], v22, s[18:19] offset:1024 sc1
  v_mfma_f32_16x16x32_bf16 a[20:23], v[244:247], a[120:123], a[20:23]
  ds_read_b64_tr_b16 v[212:213], v17 offset:32768
  v_mfma_f32_16x16x32_bf16 a[52:55], v[244:247], a[124:127], a[52:55]
  s_waitcnt lgkmcnt(13)
  ds_read_b64_tr_b16 v[214:215], v17 offset:36864
  global_load_dwordx4 a[108:111], v23, s[18:19] offset:1024 sc1
  v_mfma_f32_16x16x32_bf16 a[24:27], v[248:251], a[120:123], a[24:27]
  ds_read_b64_tr_b16 v[216:217], v18 offset:32768
  v_mfma_f32_16x16x32_bf16 a[56:59], v[248:251], a[124:127], a[56:59]
  s_waitcnt lgkmcnt(13)
  ds_read_b64_tr_b16 v[218:219], v18 offset:36864
  global_load_dwordx4 a[112:115], v22, s[18:19] offset:2048 sc1
  v_mfma_f32_16x16x32_bf16 a[28:31], v[252:255], a[120:123], a[28:31]
  ds_read_b64_tr_b16 v[220:221], v19 offset:32768
  v_mfma_f32_16x16x32_bf16 a[60:63], v[252:255], a[124:127], a[60:63]
  ds_read_b64_tr_b16 v[222:223], v19 offset:36864
  global_load_dwordx4 a[116:119], v23, s[18:19] offset:2048 sc1
  s_waitcnt vmcnt(20)
  s_waitcnt lgkmcnt(14)
  v_mfma_f32_16x16x32_bf16 a[0:3], v[192:195], a[64:67], a[0:3]
  ds_read_b64_tr_b16 v[224:225], v12 offset:40960
  v_mfma_f32_16x16x32_bf16 a[32:35], v[192:195], a[68:71], a[32:35]
  s_waitcnt lgkmcnt(13)
  ds_read_b64_tr_b16 v[226:227], v12 offset:45056
  v_mfma_f32_16x16x32_bf16 a[4:7], v[196:199], a[64:67], a[4:7]
  ds_read_b64_tr_b16 v[228:229], v13 offset:40960
  v_mfma_f32_16x16x32_bf16 a[36:39], v[196:199], a[68:71], a[36:39]
  s_waitcnt lgkmcnt(13)
  ds_read_b64_tr_b16 v[230:231], v13 offset:45056
  v_mfma_f32_16x16x32_bf16 a[8:11], v[200:203], a[64:67], a[8:11]
  ds_read_b64_tr_b16 v[232:233], v14 offset:40960
  v_mfma_f32_16x16x32_bf16 a[40:43], v[200:203], a[68:71], a[40:43]
  s_waitcnt lgkmcnt(13)
  ds_read_b64_tr_b16 v[234:235], v14 offset:45056
  v_mfma_f32_16x16x32_bf16 a[12:15], v[204:207], a[64:67], a[12:15]
  ds_read_b64_tr_b16 v[236:237], v15 offset:40960
  v_mfma_f32_16x16x32_bf16 a[44:47], v[204:207], a[68:71], a[44:47]
  s_waitcnt lgkmcnt(13)
  ds_read_b64_tr_b16 v[238:239], v15 offset:45056
  v_mfma_f32_16x16x32_bf16 a[16:19], v[208:211], a[64:67], a[16:19]
  ds_read_b64_tr_b16 v[240:241], v16 offset:40960
  v_mfma_f32_16x16x32_bf16 a[48:51], v[208:211], a[68:71], a[48:51]
  s_waitcnt lgkmcnt(13)
  ds_read_b64_tr_b16 v[242:243], v16 offset:45056
  global_load_dwordx4 a[120:123], v22, s[18:19] offset:3072 sc1
  v_mfma_f32_16x16x32_bf16 a[20:23], v[212:215], a[64:67], a[20:23]
  ds_read_b64_tr_b16 v[244:245], v17 offset:40960
  v_mfma_f32_16x16x32_bf16 a[52:55], v[212:215], a[68:71], a[52:55]
  s_waitcnt lgkmcnt(13)
  ds_read_b64_tr_b16 v[246:247], v17 offset:45056
  global_load_dwordx4 a[124:127], v23, s[18:19] offset:3072 sc1
  s_add_u32 s39, s39, 4096
  s_and_b32 s39, s39, 0x7fff
  s_add_u32 s18, s58, s39
  s_addc_u32 s19, s59, 0
  v_mfma_f32_16x16x32_bf16 a[24:27], v[216:219], a[64:67], a[24:27]
  ds_read_b64_tr_b16 v[248:249], v18 offset:40960
  v_mfma_f32_16x16x32_bf16 a[56:59], v[216:219], a[68:71], a[56:59]
  s_waitcnt lgkmcnt(13)
  ds_read_b64_tr_b16 v[250:251], v18 offset:45056
  v_mfma_f32_16x16x32_bf16 a[28:31], v[220:223], a[64:67], a[28:31]
  ds_read_b64_tr_b16 v[252:253], v19 offset:40960
  v_mfma_f32_16x16x32_bf16 a[60:63], v[220:223], a[68:71], a[60:63]
  ds_read_b64_tr_b16 v[254:255], v19 offset:45056
  s_waitcnt vmcnt(16)
  s_waitcnt lgkmcnt(14)
  v_mfma_f32_16x16x32_bf16 a[0:3], v[224:227], a[72:75], a[0:3]
  ds_read_b64_tr_b16 v[192:193], v12 offset:49152
  v_mfma_f32_16x16x32_bf16 a[32:35], v[224:227], a[76:79], a[32:35]
  s_waitcnt lgkmcnt(13)
  ds_read_b64_tr_b16 v[194:195], v12 offset:53248
  v_mfma_f32_16x16x32_bf16 a[4:7], v[228:231], a[72:75], a[4:7]
  ds_read_b64_tr_b16 v[196:197], v13 offset:49152
  v_mfma_f32_16x16x32_bf16 a[36:39], v[228:231], a[76:79], a[36:39]
  s_waitcnt lgkmcnt(13)
  ds_read_b64_tr_b16 v[198:199], v13 offset:53248
  v_mfma_f32_16x16x32_bf16 a[8:11], v[232:235], a[72:75], a[8:11]
  ds_read_b64_tr_b16 v[200:201], v14 offset:49152
  v_mfma_f32_16x16x32_bf16 a[40:43], v[232:235], a[76:79], a[40:43]
  s_waitcnt lgkmcnt(13)
  ds_read_b64_tr_b16 v[202:203], v14 offset:53248
  v_mfma_f32_16x16x32_bf16 a[12:15], v[236:239], a[72:75], a[12:15]
  ds_read_b64_tr_b16 v[204:205], v15 offset:49152
  v_mfma_f32_16x16x32_bf16 a[44:47], v[236:239], a[76:79], a[44:47]
  s_waitcnt lgkmcnt(13)
  ds_read_b64_tr_b16 v[206:207], v15 offset:53248
  v_mfma_f32_16x16x32_bf16 a[16:19], v[240:243], a[72:75], a[16:19]
  ds_read_b64_tr_b16 v[208:209], v16 offset:49152
  v_mfma_f32_16x16x32_bf16 a[48:51], v[240:243], a[76:79], a[48:51]
  s_waitcnt lgkmcnt(13)
  ds_read_b64_tr_b16 v[210:211], v16 offset:53248
  global_load_dwordx4 a[64:67], v22, s[18:19] offset:0 sc1
  v_mfma_f32_16x16x32_bf16 a[20:23], v[244:247], a[72:75], a[20:23]
  ds_read_b64_tr_b16 v[212:213], v17 offset:49152
  v_mfma_f32_16x16x32_bf16 a[52:55], v[244:247], a[76:79], a[52:55]
  s_waitcnt lgkmcnt(13)
  ds_read_b64_tr_b16 v[214:215], v17 offset:53248
  global_load_dwordx4 a[68:71], v23, s[18:19] offset:0 sc1
  v_mfma_f32_16x16x32_bf16 a[24:27], v[248:251], a[72:75], a[24:27]
  ds_read_b64_tr_b16 v[216:217], v18 offset:49152
  v_mfma_f32_16x16x32_bf16 a[56:59], v[248:251], a[76:79], a[56:59]
  s_waitcnt lgkmcnt(13)
  ds_read_b64_tr_b16 v[218:219], v18 offset:53248
  v_mfma_f32_16x16x32_bf16 a[28:31], v[252:255], a[72:75], a[28:31]
  ds_read_b64_tr_b16 v[220:221], v19 offset:49152
  v_mfma_f32_16x16x32_bf16 a[60:63], v[252:255], a[76:79], a[60:63]
  ds_read_b64_tr_b16 v[222:223], v19 offset:53248
  s_waitcnt vmcnt(16)
  s_waitcnt lgkmcnt(14)
  v_mfma_f32_16x16x32_bf16 a[0:3], v[192:195], a[80:83], a[0:3]
  ds_read_b64_tr_b16 v[224:225], v12 offset:57344
  v_mfma_f32_16x16x32_bf16 a[32:35], v[192:195], a[84:87], a[32:35]
  s_waitcnt lgkmcnt(13)
  ds_read_b64_tr_b16 v[226:227], v12 offset:61440
  v_mfma_f32_16x16x32_bf16 a[4:7], v[196:199], a[80:83], a[4:7]
  ds_read_b64_tr_b16 v[228:229], v13 offset:57344
  v_mfma_f32_16x16x32_bf16 a[36:39], v[196:199], a[84:87], a[36:39]
  s_waitcnt lgkmcnt(13)
  ds_read_b64_tr_b16 v[230:231], v13 offset:61440
  v_mfma_f32_16x16x32_bf16 a[8:11], v[200:203], a[80:83], a[8:11]
  ds_read_b64_tr_b16 v[232:233], v14 offset:57344
  v_mfma_f32_16x16x32_bf16 a[40:43], v[200:203], a[84:87], a[40:43]
  s_waitcnt lgkmcnt(13)
  ds_read_b64_tr_b16 v[234:235], v14 offset:61440
  v_mfma_f32_16x16x32_bf16 a[12:15], v[204:207], a[80:83], a[12:15]
  ds_read_b64_tr_b16 v[236:237], v15 offset:57344
  v_mfma_f32_16x16x32_bf16 a[44:47], v[204:207], a[84:87], a[44:47]
  s_waitcnt lgkmcnt(13)
  ds_read_b64_tr_b16 v[238:239], v15 offset:61440
  v_mfma_f32_16x16x32_bf16 a[16:19], v[208:211], a[80:83], a[16:19]
  ds_read_b64_tr_b16 v[240:241], v16 offset:57344
  v_mfma_f32_16x16x32_bf16 a[48:51], v[208:211], a[84:87], a[48:51]
  s_waitcnt lgkmcnt(13)
  ds_read_b64_tr_b16 v[242:243], v16 offset:61440
  global_load_dwordx4 a[72:75], v22, s[18:19] offset:1024 sc1
  v_mfma_f32_16x16x32_bf16 a[20:23], v[212:215], a[80:83], a[20:23]
  ds_read_b64_tr_b16 v[244:245], v17 offset:57344
  v_mfma_f32_16x16x32_bf16 a[52:55], v[212:215], a[84:87], a[52:55]
  s_waitcnt lgkmcnt(13)
  ds_read_b64_tr_b16 v[246:247], v17 offset:61440
  global_load_dwordx4 a[76:79], v23, s[18:19] offset:1024 sc1
  v_mfma_f32_16x16x32_bf16 a[24:27], v[216:219], a[80:83], a[24:27]
  ds_read_b64_tr_b16 v[248:249], v18 offset:57344
  v_mfma_f32_16x16x32_bf16 a[56:59], v[216:219], a[84:87], a[56:59]
  s_waitcnt lgkmcnt(13)
  ds_read_b64_tr_b16 v[250:251], v18 offset:61440
  v_mfma_f32_16x16x32_bf16 a[28:31], v[220:223], a[80:83], a[28:31]
  ds_read_b64_tr_b16 v[252:253], v19 offset:57344
  v_mfma_f32_16x16x32_bf16 a[60:63], v[220:223], a[84:87], a[60:63]
  ds_read_b64_tr_b16 v[254:255], v19 offset:61440
  s_waitcnt lgkmcnt(0)
  s_barrier
  s_waitcnt vmcnt(12)
  v_add_u32 v12, 0x10000, v12
  v_add_u32 v13, 0x10000, v13
  v_add_u32 v14, 0x10000, v14
  v_add_u32 v15, 0x10000, v15
  v_add_u32 v16, 0x10000, v16
  v_add_u32 v17, 0x10000, v17
  v_add_u32 v18, 0x10000, v18
  v_add_u32 v19, 0x10000, v19
  v_mfma_f32_16x16x32_bf16 a[0:3], v[224:227], a[88:91], a[0:3]
  ds_read_b64_tr_b16 v[192:193], v12 offset:0
  s_add_u32 m0, s37, 0
  v_mfma_f32_16x16x32_bf16 a[32:35], v[224:227], a[92:95], a[32:35]
  ds_read_b64_tr_b16 v[194:195], v12 offset:4096
  global_load_lds_dwordx4 v92, s[14:15] offset:0
  v_mfma_f32_16x16x32_bf16 a[4:7], v[228:231], a[88:91], a[4:7]
  ds_read_b64_tr_b16 v[196:197], v13 offset:0
  v_mfma_f32_16x16x32_bf16 a[36:39], v[228:231], a[92:95], a[36:39]
  ds_read_b64_tr_b16 v[198:199], v13 offset:4096
  global_load_lds_dwordx4 v93, s[14:15] offset:1024
  s_add_u32 s38, s38, 0x8000
  s_and_b32 s38, s38, 0xfffff
  s_add_u32 s14, s56, s38
  s_addc_u32 s15, s57, 0
  v_mfma_f32_16x16x32_bf16 a[8:11], v[232:235], a[88:91], a[8:11]
  ds_read_b64_tr_b16 v[200:201], v14 offset:0
  s_add_u32 m0, s37, 8192
  v_mfma_f32_16x16x32_bf16 a[40:43], v[232:235], a[92:95], a[40:43]
  ds_read_b64_tr_b16 v[202:203], v14 offset:4096
  global_load_lds_dwordx4 v92, s[14:15] offset:0
  v_mfma_f32_16x16x32_bf16 a[12:15], v[236:239], a[88:91], a[12:15]
  ds_read_b64_tr_b16 v[204:205], v15 offset:0
  v_mfma_f32_16x16x32_bf16 a[44:47], v[236:239], a[92:95], a[44:47]
  ds_read_b64_tr_b16 v[206:207], v15 offset:4096
  global_load_lds_dwordx4 v93, s[14:15] offset:1024
  s_add_u32 s38, s38, 0x8000
  s_and_b32 s38, s38, 0xfffff
  s_add_u32 s14, s56, s38
  s_addc_u32 s15, s57, 0
  v_mfma_f32_16x16x32_bf16 a[16:19], v[240:243], a[88:91], a[16:19]
  ds_read_b64_tr_b16 v[208:209], v16 offset:0
  v_mfma_f32_16x16x32_bf16 a[48:51], v[240:243], a[92:95], a[48:51]
  ds_read_b64_tr_b16 v[210:211], v16 offset:4096
  global_load_dwordx4 a[80:83], v22, s[18:19] offset:2048 sc1
  v_mfma_f32_16x16x32_bf16 a[20:23], v[244:247], a[88:91], a[20:23]
  ds_read_b64_tr_b16 v[212:213], v17 offset:0
  v_mfma_f32_16x16x32_bf16 a[52:55], v[244:247], a[92:95], a[52:55]
  ds_read_b64_tr_b16 v[214:215], v17 offset:4096
  global_load_dwordx4 a[84:87], v23, s[18:19] offset:2048 sc1
  v_mfma_f32_16x16x32_bf16 a[24:27], v[248:251], a[88:91], a[24:27]
  ds_read_b64_tr_b16 v[216:217], v18 offset:0
  v_mfma_f32_16x16x32_bf16 a[56:59], v[248:251], a[92:95], a[56:59]
  ds_read_b64_tr_b16 v[218:219], v18 offset:4096
  v_mfma_f32_16x16x32_bf16 a[28:31], v[252:255], a[88:91], a[28:31]
  ds_read_b64_tr_b16 v[220:221], v19 offset:0
  v_mfma_f32_16x16x32_bf16 a[60:63], v[252:255], a[92:95], a[60:63]
  ds_read_b64_tr_b16 v[222:223], v19 offset:4096
  s_waitcnt vmcnt(16)
  s_waitcnt lgkmcnt(14)
  v_mfma_f32_16x16x32_bf16 a[0:3], v[192:195], a[96:99], a[0:3]
  ds_read_b64_tr_b16 v[224:225], v12 offset:8192
  s_add_u32 m0, s37, 16384
  v_mfma_f32_16x16x32_bf16 a[32:35], v[192:195], a[100:103], a[32:35]
  s_waitcnt lgkmcnt(13)
  ds_read_b64_tr_b16 v[226:227], v12 offset:12288
  global_load_lds_dwordx4 v92, s[14:15] offset:0
  v_mfma_f32_16x16x32_bf16 a[4:7], v[196:199], a[96:99], a[4:7]
  ds_read_b64_tr_b16 v[228:229], v13 offset:8192
  v_mfma_f32_16x16x32_bf16 a[36:39], v[196:199], a[100:103], a[36:39]
  s_waitcnt lgkmcnt(13)
  ds_read_b64_tr_b16 v[230:231], v13 offset:12288
  global_load_lds_dwordx4 v93, s[14:15] offset:1024
  s_add_u32 s38, s38, 0x8000
  s_and_b32 s38, s38, 0xfffff
  s_add_u32 s14, s56, s38
  s_addc_u32 s15, s57, 0
  v_mfma_f32_16x16x32_bf16 a[8:11], v[200:203], a[96:99], a[8:11]
  ds_read_b64_tr_b16 v[232:233], v14 offset:8192
  s_add_u32 m0, s37, 24576
  v_mfma_f32_16x16x32_bf16 a[40:43], v[200:203], a[100:103], a[40:43]
  s_waitcnt lgkmcnt(13)
  ds_read_b64_tr_b16 v[234:235], v14 offset:12288
  global_load_lds_dwordx4 v92, s[14:15] offset:0
  v_mfma_f32_16x16x32_bf16 a[12:15], v[204:207], a[96:99], a[12:15]
  ds_read_b64_tr_b16 v[236:237], v15 offset:8192
  v_mfma_f32_16x16x32_bf16 a[44:47], v[204:207], a[100:103], a[44:47]
  s_waitcnt lgkmcnt(13)
  ds_read_b64_tr_b16 v[238:239], v15 offset:12288
  global_load_lds_dwordx4 v93, s[14:15] offset:1024
  s_add_u32 s38, s38, 0x8000
  s_and_b32 s38, s38, 0xfffff
  s_add_u32 s14, s56, s38
  s_addc_u32 s15, s57, 0
  v_mfma_f32_16x16x32_bf16 a[16:19], v[208:211], a[96:99], a[16:19]
  ds_read_b64_tr_b16 v[240:241], v16 offset:8192
  v_mfma_f32_16x16x32_bf16 a[48:51], v[208:211], a[100:103], a[48:51]
  s_waitcnt lgkmcnt(13)
  ds_read_b64_tr_b16 v[242:243], v16 offset:12288
  global_load_dwordx4 a[88:91], v22, s[18:19] offset:3072 sc1
  v_mfma_f32_16x16x32_bf16 a[20:23], v[212:215], a[96:99], a[20:23]
  ds_read_b64_tr_b16 v[244:245], v17 offset:8192
  v_mfma_f32_16x16x32_bf16 a[52:55], v[212:215], a[100:103], a[52:55]
  s_waitcnt lgkmcnt(13)
  ds_read_b64_tr_b16 v[246:247], v17 offset:12288
  global_load_dwordx4 a[92:95], v23, s[18:19] offset:3072 sc1
  s_add_u32 s39, s39, 4096
  s_and_b32 s39, s39, 0x7fff
  s_add_u32 s18, s58, s39
  s_addc_u32 s19, s59, 0
  v_mfma_f32_16x16x32_bf16 a[24:27], v[216:219], a[96:99], a[24:27]
  ds_read_b64_tr_b16 v[248:249], v18 offset:8192
  v_mfma_f32_16x16x32_bf16 a[56:59], v[216:219], a[100:103], a[56:59]
  s_waitcnt lgkmcnt(13)
  ds_read_b64_tr_b16 v[250:251], v18 offset:12288
  v_mfma_f32_16x16x32_bf16 a[28:31], v[220:223], a[96:99], a[28:31]
  ds_read_b64_tr_b16 v[252:253], v19 offset:8192
  v_mfma_f32_16x16x32_bf16 a[60:63], v[220:223], a[100:103], a[60:63]
  ds_read_b64_tr_b16 v[254:255], v19 offset:12288
  s_waitcnt vmcnt(20)
  s_waitcnt lgkmcnt(14)
  v_mfma_f32_16x16x32_bf16 a[0:3], v[224:227], a[104:107], a[0:3]
  ds_read_b64_tr_b16 v[192:193], v12 offset:16384
  s_add_u32 m0, s37, 32768
  v_mfma_f32_16x16x32_bf16 a[32:35], v[224:227], a[108:111], a[32:35]
  s_waitcnt lgkmcnt(13)
  ds_read_b64_tr_b16 v[194:195], v12 offset:20480
  global_load_lds_dwordx4 v92, s[14:15] offset:0
  v_mfma_f32_16x16x32_bf16 a[4:7], v[228:231], a[104:107], a[4:7]
  ds_read_b64_tr_b16 v[196:197], v13 offset:16384
  v_mfma_f32_16x16x32_bf16 a[36:39], v[228:231], a[108:111], a[36:39]
  s_waitcnt lgkmcnt(13)
  ds_read_b64_tr_b16 v[198:199], v13 offset:20480
  global_load_lds_dwordx4 v93, s[14:15] offset:1024
  s_add_u32 s38, s38, 0x8000
  s_and_b32 s38, s38, 0xfffff
  s_add_u32 s14, s56, s38
  s_addc_u32 s15, s57, 0
  v_mfma_f32_16x16x32_bf16 a[8:11], v[232:235], a[104:107], a[8:11]
  ds_read_b64_tr_b16 v[200:201], v14 offset:16384
  s_add_u32 m0, s37, 40960
  v_mfma_f32_16x16x32_bf16 a[40:43], v[232:235], a[108:111], a[40:43]
  s_waitcnt lgkmcnt(13)
  ds_read_b64_tr_b16 v[202:203], v14 offset:20480
  global_load_lds_dwordx4 v92, s[14:15] offset:0
  v_mfma_f32_16x16x32_bf16 a[12:15], v[236:239], a[104:107], a[12:15]
  ds_read_b64_tr_b16 v[204:205], v15 offset:16384
  v_mfma_f32_16x16x32_bf16 a[44:47], v[236:239], a[108:111], a[44:47]
  s_waitcnt lgkmcnt(13)
  ds_read_b64_tr_b16 v[206:207], v15 offset:20480
  global_load_lds_dwordx4 v93, s[14:15] offset:1024
  s_add_u32 s38, s38, 0x8000
  s_and_b32 s38, s38, 0xfffff
  s_add_u32 s14, s56, s38
  s_addc_u32 s15, s57, 0
  v_mfma_f32_16x16x32_bf16 a[16:19], v[240:243], a[104:107], a[16:19]
  ds_read_b64_tr_b16 v[208:209], v16 offset:16384
  v_mfma_f32_16x16x32_bf16 a[48:51], v[240:243], a[108:111], a[48:51]
  s_waitcnt lgkmcnt(13)
  ds_read_b64_tr_b16 v[210:211], v16 offset:20480
  global_load_dwordx4 a[96:99], v22, s[18:19] offset:0 sc1
  v_mfma_f32_16x16x32_bf16 a[20:23], v[244:247], a[104:107], a[20:23]
  ds_read_b64_tr_b16 v[212:213], v17 offset:16384
  v_mfma_f32_16x16x32_bf16 a[52:55], v[244:247], a[108:111], a[52:55]
  s_waitcnt lgkmcnt(13)
  ds_read_b64_tr_b16 v[214:215], v17 offset:20480
  global_load_dwordx4 a[100:103], v23, s[18:19] offset:0 sc1
  v_mfma_f32_16x16x32_bf16 a[24:27], v[248:251], a[104:107], a[24:27]
  ds_read_b64_tr_b16 v[216:217], v18 offset:16384
  v_mfma_f32_16x16x32_bf16 a[56:59], v[248:251], a[108:111], a[56:59]
  s_waitcnt lgkmcnt(13)
  ds_read_b64_tr_b16 v[218:219], v18 offset:20480
  v_mfma_f32_16x16x32_bf16 a[28:31], v[252:255], a[104:107], a[28:31]
  ds_read_b64_tr_b16 v[220:221], v19 offset:16384
  v_mfma_f32_16x16x32_bf16 a[60:63], v[252:255], a[108:111], a[60:63]
  ds_read_b64_tr_b16 v[222:223], v19 offset:20480
  s_waitcnt vmcnt(24)
  s_waitcnt lgkmcnt(14)
  v_mfma_f32_16x16x32_bf16 a[0:3], v[192:195], a[112:115], a[0:3]
  ds_read_b64_tr_b16 v[224:225], v12 offset:24576
  s_add_u32 m0, s37, 49152
  v_mfma_f32_16x16x32_bf16 a[32:35], v[192:195], a[116:119], a[32:35]
  s_waitcnt lgkmcnt(13)
  ds_read_b64_tr_b16 v[226:227], v12 offset:28672
  global_load_lds_dwordx4 v92, s[14:15] offset:0
  v_mfma_f32_16x16x32_bf16 a[4:7], v[196:199], a[112:115], a[4:7]
  ds_read_b64_tr_b16 v[228:229], v13 offset:24576
  v_mfma_f32_16x16x32_bf16 a[36:39], v[196:199], a[116:119], a[36:39]
  s_waitcnt lgkmcnt(13)
  ds_read_b64_tr_b16 v[230:231], v13 offset:28672
  global_load_lds_dwordx4 v93, s[14:15] offset:1024
  s_add_u32 s38, s38, 0x8000
  s_and_b32 s38, s38, 0xfffff
  s_add_u32 s14, s56, s38
  s_addc_u32 s15, s57, 0
  v_mfma_f32_16x16x32_bf16 a[8:11], v[200:203], a[112:115], a[8:11]
  ds_read_b64_tr_b16 v[232:233], v14 offset:24576
  s_add_u32 m0, s37, 57344
  v_mfma_f32_16x16x32_bf16 a[40:43], v[200:203], a[116:119], a[40:43]
  s_waitcnt lgkmcnt(13)
  ds_read_b64_tr_b16 v[234:235], v14 offset:28672
  global_load_lds_dwordx4 v92, s[14:15] offset:0
  v_mfma_f32_16x16x32_bf16 a[12:15], v[204:207], a[112:115], a[12:15]
  ds_read_b64_tr_b16 v[236:237], v15 offset:24576
  v_mfma_f32_16x16x32_bf16 a[44:47], v[204:207], a[116:119], a[44:47]
  s_waitcnt lgkmcnt(13)
  ds_read_b64_tr_b16 v[238:239], v15 offset:28672
  global_load_lds_dwordx4 v93, s[14:15] offset:1024
  s_add_u32 s38, s38, 0x8000
  s_and_b32 s38, s38, 0xfffff
  s_add_u32 s14, s56, s38
  s_addc_u32 s15, s57, 0
  v_mfma_f32_16x16x32_bf16 a[16:19], v[208:211], a[112:115], a[16:19]
  ds_read_b64_tr_b16 v[240:241], v16 offset:24576
  v_mfma_f32_16x16x32_bf16 a[48:51], v[208:211], a[116:119], a[48:51]
  s_waitcnt lgkmcnt(13)
  ds_read_b64_tr_b16 v[242:243], v16 offset:28672
  global_load_dwordx4 a[104:107], v22, s[18:19] offset:1024 sc1
  v_mfma_f32_16x16x32_bf16 a[20:23], v[212:215], a[112:115], a[20:23]
  ds_read_b64_tr_b16 v[244:245], v17 offset:24576
  v_mfma_f32_16x16x32_bf16 a[52:55], v[212:215], a[116:119], a[52:55]
  s_waitcnt lgkmcnt(13)
  ds_read_b64_tr_b16 v[246:247], v17 offset:28672
  global_load_dwordx4 a[108:111], v23, s[18:19] offset:1024 sc1
  v_mfma_f32_16x16x32_bf16 a[24:27], v[216:219], a[112:115], a[24:27]
  ds_read_b64_tr_b16 v[248:249], v18 offset:24576
  v_mfma_f32_16x16x32_bf16 a[56:59], v[216:219], a[116:119], a[56:59]
  s_waitcnt lgkmcnt(13)
  ds_read_b64_tr_b16 v[250:251], v18 offset:28672
  v_mfma_f32_16x16x32_bf16 a[28:31], v[220:223], a[112:115], a[28:31]
  ds_read_b64_tr_b16 v[252:253], v19 offset:24576
  v_mfma_f32_16x16x32_bf16 a[60:63], v[220:223], a[116:119], a[60:63]
  ds_read_b64_tr_b16 v[254:255], v19 offset:28672
  s_waitcnt vmcnt(28)
  s_waitcnt lgkmcnt(14)
  v_mfma_f32_16x16x32_bf16 a[0:3], v[224:227], a[120:123], a[0:3]
  ds_read_b64_tr_b16 v[192:193], v12 offset:32768
  v_mfma_f32_16x16x32_bf16 a[32:35], v[224:227], a[124:127], a[32:35]
  s_waitcnt lgkmcnt(13)
  ds_read_b64_tr_b16 v[194:195], v12 offset:36864
  v_mfma_f32_16x16x32_bf16 a[4:7], v[228:231], a[120:123], a[4:7]
  ds_read_b64_tr_b16 v[196:197], v13 offset:32768
  v_mfma_f32_16x16x32_bf16 a[36:39], v[228:231], a[124:127], a[36:39]
  s_waitcnt lgkmcnt(13)
  ds_read_b64_tr_b16 v[198:199], v13 offset:36864
  v_mfma_f32_16x16x32_bf16 a[8:11], v[232:235], a[120:123], a[8:11]
  ds_read_b64_tr_b16 v[200:201], v14 offset:32768
  v_mfma_f32_16x16x32_bf16 a[40:43], v[232:235], a[124:127], a[40:43]
  s_waitcnt lgkmcnt(13)
  ds_read_b64_tr_b16 v[202:203], v14 offset:36864
  v_mfma_f32_16x16x32_bf16 a[12:15], v[236:239], a[120:123], a[12:15]
  ds_read_b64_tr_b16 v[204:205], v15 offset:32768
  v_mfma_f32_16x16x32_bf16 a[44:47], v[236:239], a[124:127], a[44:47]
  s_waitcnt lgkmcnt(13)
  ds_read_b64_tr_b16 v[206:207], v15 offset:36864
  v_mfma_f32_16x16x32_bf16 a[16:19], v[240:243], a[120:123], a[16:19]
  ds_read_b64_tr_b16 v[208:209], v16 offset:32768
  v_mfma_f32_16x16x32_bf16 a[48:51], v[240:243], a[124:127], a[48:51]
  s_waitcnt lgkmcnt(13)
  ds_read_b64_tr_b16 v[210:211], v16 offset:36864
  global_load_dwordx4 a[112:115], v22, s[18:19] offset:2048 sc1
  v_mfma_f32_16x16x32_bf16 a[20:23], v[244:247], a[120:123], a[20:23]
  ds_read_b64_tr_b16 v[212:213], v17 offset:32768
  v_mfma_f32_16x16x32_bf16 a[52:55], v[244:247], a[124:127], a[52:55]
  s_waitcnt lgkmcnt(13)
  ds_read_b64_tr_b16 v[214:215], v17 offset:36864
  global_load_dwordx4 a[116:119], v23, s[18:19] offset:2048 sc1
  v_mfma_f32_16x16x32_bf16 a[24:27], v[248:251], a[120:123], a[24:27]
  ds_read_b64_tr_b16 v[216:217], v18 offset:32768
  v_mfma_f32_16x16x32_bf16 a[56:59], v[248:251], a[124:127], a[56:59]
  s_waitcnt lgkmcnt(13)
  ds_read_b64_tr_b16 v[218:219], v18 offset:36864
  v_mfma_f32_16x16x32_bf16 a[28:31], v[252:255], a[120:123], a[28:31]
  ds_read_b64_tr_b16 v[220:221], v19 offset:32768
  v_mfma_f32_16x16x32_bf16 a[60:63], v[252:255], a[124:127], a[60:63]
  ds_read_b64_tr_b16 v[222:223], v19 offset:36864
  s_waitcnt vmcnt(28)
  s_waitcnt lgkmcnt(14)
  v_mfma_f32_16x16x32_bf16 a[0:3], v[192:195], a[64:67], a[0:3]
  ds_read_b64_tr_b16 v[224:225], v12 offset:40960
  v_mfma_f32_16x16x32_bf16 a[32:35], v[192:195], a[68:71], a[32:35]
  s_waitcnt lgkmcnt(13)
  ds_read_b64_tr_b16 v[226:227], v12 offset:45056
  v_mfma_f32_16x16x32_bf16 a[4:7], v[196:199], a[64:67], a[4:7]
  ds_read_b64_tr_b16 v[228:229], v13 offset:40960
  v_mfma_f32_16x16x32_bf16 a[36:39], v[196:199], a[68:71], a[36:39]
  s_waitcnt lgkmcnt(13)
  ds_read_b64_tr_b16 v[230:231], v13 offset:45056
  v_mfma_f32_16x16x32_bf16 a[8:11], v[200:203], a[64:67], a[8:11]
  ds_read_b64_tr_b16 v[232:233], v14 offset:40960
  v_mfma_f32_16x16x32_bf16 a[40:43], v[200:203], a[68:71], a[40:43]
  s_waitcnt lgkmcnt(13)
  ds_read_b64_tr_b16 v[234:235], v14 offset:45056
  v_mfma_f32_16x16x32_bf16 a[12:15], v[204:207], a[64:67], a[12:15]
  ds_read_b64_tr_b16 v[236:237], v15 offset:40960
  v_mfma_f32_16x16x32_bf16 a[44:47], v[204:207], a[68:71], a[44:47]
  s_waitcnt lgkmcnt(13)
  ds_read_b64_tr_b16 v[238:239], v15 offset:45056
  v_mfma_f32_16x16x32_bf16 a[16:19], v[208:211], a[64:67], a[16:19]
  ds_read_b64_tr_b16 v[240:241], v16 offset:40960
  v_mfma_f32_16x16x32_bf16 a[48:51], v[208:211], a[68:71], a[48:51]
  s_waitcnt lgkmcnt(13)
  ds_read_b64_tr_b16 v[242:243], v16 offset:45056
  global_load_dwordx4 a[120:123], v22, s[18:19] offset:3072 sc1
  v_mfma_f32_16x16x32_bf16 a[20:23], v[212:215], a[64:67], a[20:23]
  ds_read_b64_tr_b16 v[244:245], v17 offset:40960
  v_mfma_f32_16x16x32_bf16 a[52:55], v[212:215], a[68:71], a[52:55]
  s_waitcnt lgkmcnt(13)
  ds_read_b64_tr_b16 v[246:247], v17 offset:45056
  global_load_dwordx4 a[124:127], v23, s[18:19] offset:3072 sc1
  s_add_u32 s39, s39, 4096
  s_and_b32 s39, s39, 0x7fff
  s_add_u32 s18, s58, s39
  s_addc_u32 s19, s59, 0
  v_mfma_f32_16x16x32_bf16 a[24:27], v[216:219], a[64:67], a[24:27]
  ds_read_b64_tr_b16 v[248:249], v18 offset:40960
  v_mfma_f32_16x16x32_bf16 a[56:59], v[216:219], a[68:71], a[56:59]
  s_waitcnt lgkmcnt(13)
  ds_read_b64_tr_b16 v[250:251], v18 offset:45056
  v_mfma_f32_16x16x32_bf16 a[28:31], v[220:223], a[64:67], a[28:31]
  ds_read_b64_tr_b16 v[252:253], v19 offset:40960
  v_mfma_f32_16x16x32_bf16 a[60:63], v[220:223], a[68:71], a[60:63]
  ds_read_b64_tr_b16 v[254:255], v19 offset:45056
  s_waitcnt vmcnt(28)
  s_waitcnt lgkmcnt(14)
  v_mfma_f32_16x16x32_bf16 a[0:3], v[224:227], a[72:75], a[0:3]
  ds_read_b64_tr_b16 v[192:193], v12 offset:49152
  v_mfma_f32_16x16x32_bf16 a[32:35], v[224:227], a[76:79], a[32:35]
  s_waitcnt lgkmcnt(13)
  ds_read_b64_tr_b16 v[194:195], v12 offset:53248
  v_mfma_f32_16x16x32_bf16 a[4:7], v[228:231], a[72:75], a[4:7]
  ds_read_b64_tr_b16 v[196:197], v13 offset:49152
  v_mfma_f32_16x16x32_bf16 a[36:39], v[228:231], a[76:79], a[36:39]
  s_waitcnt lgkmcnt(13)
  ds_read_b64_tr_b16 v[198:199], v13 offset:53248
  v_mfma_f32_16x16x32_bf16 a[8:11], v[232:235], a[72:75], a[8:11]
  ds_read_b64_tr_b16 v[200:201], v14 offset:49152
  v_mfma_f32_16x16x32_bf16 a[40:43], v[232:235], a[76:79], a[40:43]
  s_waitcnt lgkmcnt(13)
  ds_read_b64_tr_b16 v[202:203], v14 offset:53248
  v_mfma_f32_16x16x32_bf16 a[12:15], v[236:239], a[72:75], a[12:15]
  ds_read_b64_tr_b16 v[204:205], v15 offset:49152
  v_mfma_f32_16x16x32_bf16 a[44:47], v[236:239], a[76:79], a[44:47]
  s_waitcnt lgkmcnt(13)
  ds_read_b64_tr_b16 v[206:207], v15 offset:53248
  v_mfma_f32_16x16x32_bf16 a[16:19], v[240:243], a[72:75], a[16:19]
  ds_read_b64_tr_b16 v[208:209], v16 offset:49152
  v_mfma_f32_16x16x32_bf16 a[48:51], v[240:243], a[76:79], a[48:51]
  s_waitcnt lgkmcnt(13)
  ds_read_b64_tr_b16 v[210:211], v16 offset:53248
  global_load_dwordx4 a[64:67], v22, s[18:19] offset:0 sc1
  v_mfma_f32_16x16x32_bf16 a[20:23], v[244:247], a[72:75], a[20:23]
  ds_read_b64_tr_b16 v[212:213], v17 offset:49152
  v_mfma_f32_16x16x32_bf16 a[52:55], v[244:247], a[76:79], a[52:55]
  s_waitcnt lgkmcnt(13)
  ds_read_b64_tr_b16 v[214:215], v17 offset:53248
  global_load_dwordx4 a[68:71], v23, s[18:19] offset:0 sc1
  v_mfma_f32_16x16x32_bf16 a[24:27], v[248:251], a[72:75], a[24:27]
  ds_read_b64_tr_b16 v[216:217], v18 offset:49152
  v_mfma_f32_16x16x32_bf16 a[56:59], v[248:251], a[76:79], a[56:59]
  s_waitcnt lgkmcnt(13)
  ds_read_b64_tr_b16 v[218:219], v18 offset:53248
  v_mfma_f32_16x16x32_bf16 a[28:31], v[252:255], a[72:75], a[28:31]
  ds_read_b64_tr_b16 v[220:221], v19 offset:49152
  v_mfma_f32_16x16x32_bf16 a[60:63], v[252:255], a[76:79], a[60:63]
  ds_read_b64_tr_b16 v[222:223], v19 offset:53248
  s_waitcnt vmcnt(24)
  s_waitcnt lgkmcnt(14)
  v_mfma_f32_16x16x32_bf16 a[0:3], v[192:195], a[80:83], a[0:3]
  ds_read_b64_tr_b16 v[224:225], v12 offset:57344
  v_mfma_f32_16x16x32_bf16 a[32:35], v[192:195], a[84:87], a[32:35]
  s_waitcnt lgkmcnt(13)
  ds_read_b64_tr_b16 v[226:227], v12 offset:61440
  v_mfma_f32_16x16x32_bf16 a[4:7], v[196:199], a[80:83], a[4:7]
  ds_read_b64_tr_b16 v[228:229], v13 offset:57344
  v_mfma_f32_16x16x32_bf16 a[36:39], v[196:199], a[84:87], a[36:39]
  s_waitcnt lgkmcnt(13)
  ds_read_b64_tr_b16 v[230:231], v13 offset:61440
  v_mfma_f32_16x16x32_bf16 a[8:11], v[200:203], a[80:83], a[8:11]
  ds_read_b64_tr_b16 v[232:233], v14 offset:57344
  v_mfma_f32_16x16x32_bf16 a[40:43], v[200:203], a[84:87], a[40:43]
  s_waitcnt lgkmcnt(13)
  ds_read_b64_tr_b16 v[234:235], v14 offset:61440
  v_mfma_f32_16x16x32_bf16 a[12:15], v[204:207], a[80:83], a[12:15]
  ds_read_b64_tr_b16 v[236:237], v15 offset:57344
  v_mfma_f32_16x16x32_bf16 a[44:47], v[204:207], a[84:87], a[44:47]
  s_waitcnt lgkmcnt(13)
  ds_read_b64_tr_b16 v[238:239], v15 offset:61440
  v_mfma_f32_16x16x32_bf16 a[16:19], v[208:211], a[80:83], a[16:19]
  ds_read_b64_tr_b16 v[240:241], v16 offset:57344
  v_mfma_f32_16x16x32_bf16 a[48:51], v[208:211], a[84:87], a[48:51]
  s_waitcnt lgkmcnt(13)
  ds_read_b64_tr_b16 v[242:243], v16 offset:61440
  global_load_dwordx4 a[72:75], v22, s[18:19] offset:1024 sc1
  v_mfma_f32_16x16x32_bf16 a[20:23], v[212:215], a[80:83], a[20:23]
  ds_read_b64_tr_b16 v[244:245], v17 offset:57344
  v_mfma_f32_16x16x32_bf16 a[52:55], v[212:215], a[84:87], a[52:55]
  s_waitcnt lgkmcnt(13)
  ds_read_b64_tr_b16 v[246:247], v17 offset:61440
  global_load_dwordx4 a[76:79], v23, s[18:19] offset:1024 sc1
  v_mfma_f32_16x16x32_bf16 a[24:27], v[216:219], a[80:83], a[24:27]
  ds_read_b64_tr_b16 v[248:249], v18 offset:57344
  v_mfma_f32_16x16x32_bf16 a[56:59], v[216:219], a[84:87], a[56:59]
  s_waitcnt lgkmcnt(13)
  ds_read_b64_tr_b16 v[250:251], v18 offset:61440
  v_mfma_f32_16x16x32_bf16 a[28:31], v[220:223], a[80:83], a[28:31]
  ds_read_b64_tr_b16 v[252:253], v19 offset:57344
  v_mfma_f32_16x16x32_bf16 a[60:63], v[220:223], a[84:87], a[60:63]
  ds_read_b64_tr_b16 v[254:255], v19 offset:61440
  s_waitcnt vmcnt(10)
  s_barrier
  v_add_u32 v12, 0x10000, v12
  v_add_u32 v13, 0x10000, v13
  v_add_u32 v14, 0x10000, v14
  v_add_u32 v15, 0x10000, v15
  v_add_u32 v16, 0x10000, v16
  v_add_u32 v17, 0x10000, v17
  v_add_u32 v18, 0x10000, v18
  v_add_u32 v19, 0x10000, v19
  s_waitcnt lgkmcnt(14)
  v_mfma_f32_16x16x32_bf16 a[0:3], v[224:227], a[88:91], a[0:3]
  ds_read_b64_tr_b16 v[192:193], v12 offset:0
  v_mfma_f32_16x16x32_bf16 a[32:35], v[224:227], a[92:95], a[32:35]
  s_waitcnt lgkmcnt(13)
  ds_read_b64_tr_b16 v[194:195], v12 offset:4096
  v_mfma_f32_16x16x32_bf16 a[4:7], v[228:231], a[88:91], a[4:7]
  ds_read_b64_tr_b16 v[196:197], v13 offset:0
  v_mfma_f32_16x16x32_bf16 a[36:39], v[228:231], a[92:95], a[36:39]
  s_waitcnt lgkmcnt(13)
  ds_read_b64_tr_b16 v[198:199], v13 offset:4096
  v_mfma_f32_16x16x32_bf16 a[8:11], v[232:235], a[88:91], a[8:11]
  ds_read_b64_tr_b16 v[200:201], v14 offset:0
  v_mfma_f32_16x16x32_bf16 a[40:43], v[232:235], a[92:95], a[40:43]
  s_waitcnt lgkmcnt(13)
  ds_read_b64_tr_b16 v[202:203], v14 offset:4096
  v_mfma_f32_16x16x32_bf16 a[12:15], v[236:239], a[88:91], a[12:15]
  ds_read_b64_tr_b16 v[204:205], v15 offset:0
  v_mfma_f32_16x16x32_bf16 a[44:47], v[236:239], a[92:95], a[44:47]
  s_waitcnt lgkmcnt(13)
  ds_read_b64_tr_b16 v[206:207], v15 offset:4096
  v_mfma_f32_16x16x32_bf16 a[16:19], v[240:243], a[88:91], a[16:19]
  ds_read_b64_tr_b16 v[208:209], v16 offset:0
  v_mfma_f32_16x16x32_bf16 a[48:51], v[240:243], a[92:95], a[48:51]
  s_waitcnt lgkmcnt(13)
  ds_read_b64_tr_b16 v[210:211], v16 offset:4096
  global_load_dwordx4 a[80:83], v22, s[18:19] offset:2048 sc1
  v_mfma_f32_16x16x32_bf16 a[20:23], v[244:247], a[88:91], a[20:23]
  ds_read_b64_tr_b16 v[212:213], v17 offset:0
  v_mfma_f32_16x16x32_bf16 a[52:55], v[244:247], a[92:95], a[52:55]
  s_waitcnt lgkmcnt(13)
  ds_read_b64_tr_b16 v[214:215], v17 offset:4096
  global_load_dwordx4 a[84:87], v23, s[18:19] offset:2048 sc1
  v_mfma_f32_16x16x32_bf16 a[24:27], v[248:251], a[88:91], a[24:27]
  ds_read_b64_tr_b16 v[216:217], v18 offset:0
  v_mfma_f32_16x16x32_bf16 a[56:59], v[248:251], a[92:95], a[56:59]
  s_waitcnt lgkmcnt(13)
  ds_read_b64_tr_b16 v[218:219], v18 offset:4096
  v_mfma_f32_16x16x32_bf16 a[28:31], v[252:255], a[88:91], a[28:31]
  ds_read_b64_tr_b16 v[220:221], v19 offset:0
  v_mfma_f32_16x16x32_bf16 a[60:63], v[252:255], a[92:95], a[60:63]
  ds_read_b64_tr_b16 v[222:223], v19 offset:4096
  s_waitcnt lgkmcnt(14)
  v_mfma_f32_16x16x32_bf16 a[0:3], v[192:195], a[96:99], a[0:3]
  ds_read_b64_tr_b16 v[224:225], v12 offset:8192
  v_mfma_f32_16x16x32_bf16 a[32:35], v[192:195], a[100:103], a[32:35]
  s_waitcnt lgkmcnt(13)
  ds_read_b64_tr_b16 v[226:227], v12 offset:12288
  v_mfma_f32_16x16x32_bf16 a[4:7], v[196:199], a[96:99], a[4:7]
  ds_read_b64_tr_b16 v[228:229], v13 offset:8192
  v_mfma_f32_16x16x32_bf16 a[36:39], v[196:199], a[100:103], a[36:39]
  s_waitcnt lgkmcnt(13)
  ds_read_b64_tr_b16 v[230:231], v13 offset:12288
  v_mfma_f32_16x16x32_bf16 a[8:11], v[200:203], a[96:99], a[8:11]
  ds_read_b64_tr_b16 v[232:233], v14 offset:8192
  v_mfma_f32_16x16x32_bf16 a[40:43], v[200:203], a[100:103], a[40:43]
  s_waitcnt lgkmcnt(13)
  ds_read_b64_tr_b16 v[234:235], v14 offset:12288
  v_mfma_f32_16x16x32_bf16 a[12:15], v[204:207], a[96:99], a[12:15]
  ds_read_b64_tr_b16 v[236:237], v15 offset:8192
  v_mfma_f32_16x16x32_bf16 a[44:47], v[204:207], a[100:103], a[44:47]
  s_waitcnt lgkmcnt(13)
  ds_read_b64_tr_b16 v[238:239], v15 offset:12288
  v_mfma_f32_16x16x32_bf16 a[16:19], v[208:211], a[96:99], a[16:19]
  ds_read_b64_tr_b16 v[240:241], v16 offset:8192
  v_mfma_f32_16x16x32_bf16 a[48:51], v[208:211], a[100:103], a[48:51]
  s_waitcnt lgkmcnt(13)
  ds_read_b64_tr_b16 v[242:243], v16 offset:12288
  global_load_dwordx4 a[88:91], v22, s[18:19] offset:3072 sc1
  v_mfma_f32_16x16x32_bf16 a[20:23], v[212:215], a[96:99], a[20:23]
  ds_read_b64_tr_b16 v[244:245], v17 offset:8192
  v_mfma_f32_16x16x32_bf16 a[52:55], v[212:215], a[100:103], a[52:55]
  s_waitcnt lgkmcnt(13)
  ds_read_b64_tr_b16 v[246:247], v17 offset:12288
  global_load_dwordx4 a[92:95], v23, s[18:19] offset:3072 sc1
  s_add_u32 s39, s39, 4096
  s_and_b32 s39, s39, 0x7fff
  s_add_u32 s18, s58, s39
  s_addc_u32 s19, s59, 0
  v_mfma_f32_16x16x32_bf16 a[24:27], v[216:219], a[96:99], a[24:27]
  ds_read_b64_tr_b16 v[248:249], v18 offset:8192
  v_mfma_f32_16x16x32_bf16 a[56:59], v[216:219], a[100:103], a[56:59]
  s_waitcnt lgkmcnt(13)
  ds_read_b64_tr_b16 v[250:251], v18 offset:12288
  v_mfma_f32_16x16x32_bf16 a[28:31], v[220:223], a[96:99], a[28:31]
  ds_read_b64_tr_b16 v[252:253], v19 offset:8192
  v_mfma_f32_16x16x32_bf16 a[60:63], v[220:223], a[100:103], a[60:63]
  ds_read_b64_tr_b16 v[254:255], v19 offset:12288
  s_waitcnt vmcnt(12)
  s_waitcnt lgkmcnt(14)
  v_mfma_f32_16x16x32_bf16 a[0:3], v[224:227], a[104:107], a[0:3]
  ds_read_b64_tr_b16 v[192:193], v12 offset:16384
  v_mfma_f32_16x16x32_bf16 a[32:35], v[224:227], a[108:111], a[32:35]
  s_waitcnt lgkmcnt(13)
  ds_read_b64_tr_b16 v[194:195], v12 offset:20480
  v_mfma_f32_16x16x32_bf16 a[4:7], v[228:231], a[104:107], a[4:7]
  ds_read_b64_tr_b16 v[196:197], v13 offset:16384
  v_mfma_f32_16x16x32_bf16 a[36:39], v[228:231], a[108:111], a[36:39]
  s_waitcnt lgkmcnt(13)
  ds_read_b64_tr_b16 v[198:199], v13 offset:20480
  v_mfma_f32_16x16x32_bf16 a[8:11], v[232:235], a[104:107], a[8:11]
  ds_read_b64_tr_b16 v[200:201], v14 offset:16384
  v_mfma_f32_16x16x32_bf16 a[40:43], v[232:235], a[108:111], a[40:43]
  s_waitcnt lgkmcnt(13)
  ds_read_b64_tr_b16 v[202:203], v14 offset:20480
  v_mfma_f32_16x16x32_bf16 a[12:15], v[236:239], a[104:107], a[12:15]
  ds_read_b64_tr_b16 v[204:205], v15 offset:16384
  v_mfma_f32_16x16x32_bf16 a[44:47], v[236:239], a[108:111], a[44:47]
  s_waitcnt lgkmcnt(13)
  ds_read_b64_tr_b16 v[206:207], v15 offset:20480
  v_mfma_f32_16x16x32_bf16 a[16:19], v[240:243], a[104:107], a[16:19]
  ds_read_b64_tr_b16 v[208:209], v16 offset:16384
  v_mfma_f32_16x16x32_bf16 a[48:51], v[240:243], a[108:111], a[48:51]
  s_waitcnt lgkmcnt(13)
  ds_read_b64_tr_b16 v[210:211], v16 offset:20480
  global_load_dwordx4 a[96:99], v22, s[18:19] offset:0 sc1
  v_mfma_f32_16x16x32_bf16 a[20:23], v[244:247], a[104:107], a[20:23]
  ds_read_b64_tr_b16 v[212:213], v17 offset:16384
  v_mfma_f32_16x16x32_bf16 a[52:55], v[244:247], a[108:111], a[52:55]
  s_waitcnt lgkmcnt(13)
  ds_read_b64_tr_b16 v[214:215], v17 offset:20480
  global_load_dwordx4 a[100:103], v23, s[18:19] offset:0 sc1
  v_mfma_f32_16x16x32_bf16 a[24:27], v[248:251], a[104:107], a[24:27]
  ds_read_b64_tr_b16 v[216:217], v18 offset:16384
  v_mfma_f32_16x16x32_bf16 a[56:59], v[248:251], a[108:111], a[56:59]
  s_waitcnt lgkmcnt(13)
  ds_read_b64_tr_b16 v[218:219], v18 offset:20480
  v_mfma_f32_16x16x32_bf16 a[28:31], v[252:255], a[104:107], a[28:31]
  ds_read_b64_tr_b16 v[220:221], v19 offset:16384
  v_mfma_f32_16x16x32_bf16 a[60:63], v[252:255], a[108:111], a[60:63]
  ds_read_b64_tr_b16 v[222:223], v19 offset:20480
  s_waitcnt vmcnt(12)
  s_waitcnt lgkmcnt(14)
  v_mfma_f32_16x16x32_bf16 a[0:3], v[192:195], a[112:115], a[0:3]
  ds_read_b64_tr_b16 v[224:225], v12 offset:24576
  v_mfma_f32_16x16x32_bf16 a[32:35], v[192:195], a[116:119], a[32:35]
  s_waitcnt lgkmcnt(13)
  ds_read_b64_tr_b16 v[226:227], v12 offset:28672
  v_mfma_f32_16x16x32_bf16 a[4:7], v[196:199], a[112:115], a[4:7]
  ds_read_b64_tr_b16 v[228:229], v13 offset:24576
  v_mfma_f32_16x16x32_bf16 a[36:39], v[196:199], a[116:119], a[36:39]
  s_waitcnt lgkmcnt(13)
  ds_read_b64_tr_b16 v[230:231], v13 offset:28672
  v_mfma_f32_16x16x32_bf16 a[8:11], v[200:203], a[112:115], a[8:11]
  ds_read_b64_tr_b16 v[232:233], v14 offset:24576
  v_mfma_f32_16x16x32_bf16 a[40:43], v[200:203], a[116:119], a[40:43]
  s_waitcnt lgkmcnt(13)
  ds_read_b64_tr_b16 v[234:235], v14 offset:28672
  v_mfma_f32_16x16x32_bf16 a[12:15], v[204:207], a[112:115], a[12:15]
  ds_read_b64_tr_b16 v[236:237], v15 offset:24576
  v_mfma_f32_16x16x32_bf16 a[44:47], v[204:207], a[116:119], a[44:47]
  s_waitcnt lgkmcnt(13)
  ds_read_b64_tr_b16 v[238:239], v15 offset:28672
  v_mfma_f32_16x16x32_bf16 a[16:19], v[208:211], a[112:115], a[16:19]
  ds_read_b64_tr_b16 v[240:241], v16 offset:24576
  v_mfma_f32_16x16x32_bf16 a[48:51], v[208:211], a[116:119], a[48:51]
  s_waitcnt lgkmcnt(13)
  ds_read_b64_tr_b16 v[242:243], v16 offset:28672
  global_load_dwordx4 a[104:107], v22, s[18:19] offset:1024 sc1
  v_mfma_f32_16x16x32_bf16 a[20:23], v[212:215], a[112:115], a[20:23]
  ds_read_b64_tr_b16 v[244:245], v17 offset:24576
  v_mfma_f32_16x16x32_bf16 a[52:55], v[212:215], a[116:119], a[52:55]
  s_waitcnt lgkmcnt(13)
  ds_read_b64_tr_b16 v[246:247], v17 offset:28672
  global_load_dwordx4 a[108:111], v23, s[18:19] offset:1024 sc1
  v_mfma_f32_16x16x32_bf16 a[24:27], v[216:219], a[112:115], a[24:27]
  ds_read_b64_tr_b16 v[248:249], v18 offset:24576
  v_mfma_f32_16x16x32_bf16 a[56:59], v[216:219], a[116:119], a[56:59]
  s_waitcnt lgkmcnt(13)
  ds_read_b64_tr_b16 v[250:251], v18 offset:28672
  v_mfma_f32_16x16x32_bf16 a[28:31], v[220:223], a[112:115], a[28:31]
  ds_read_b64_tr_b16 v[252:253], v19 offset:24576
  v_mfma_f32_16x16x32_bf16 a[60:63], v[220:223], a[116:119], a[60:63]
  ds_read_b64_tr_b16 v[254:255], v19 offset:28672
  s_waitcnt vmcnt(12)
  v_add_u32 v12, 0xfffe0000, v12
  v_add_u32 v13, 0xfffe0000, v13
  v_add_u32 v14, 0xfffe0000, v14
  v_add_u32 v15, 0xfffe0000, v15
  v_add_u32 v16, 0xfffe0000, v16
  v_add_u32 v17, 0xfffe0000, v17
  v_add_u32 v18, 0xfffe0000, v18
  v_add_u32 v19, 0xfffe0000, v19
  s_waitcnt lgkmcnt(14)
  v_mfma_f32_16x16x32_bf16 a[0:3], v[224:227], a[120:123], a[0:3]
  ds_read_b64_tr_b16 v[192:193], v12 offset:0
  v_mfma_f32_16x16x32_bf16 a[32:35], v[224:227], a[124:127], a[32:35]
  s_waitcnt lgkmcnt(13)
  ds_read_b64_tr_b16 v[194:195], v12 offset:4096
  v_mfma_f32_16x16x32_bf16 a[4:7], v[228:231], a[120:123], a[4:7]
  ds_read_b64_tr_b16 v[196:197], v13 offset:0
  v_mfma_f32_16x16x32_bf16 a[36:39], v[228:231], a[124:127], a[36:39]
  s_waitcnt lgkmcnt(13)
  ds_read_b64_tr_b16 v[198:199], v13 offset:4096
  v_mfma_f32_16x16x32_bf16 a[8:11], v[232:235], a[120:123], a[8:11]
  ds_read_b64_tr_b16 v[200:201], v14 offset:0
  v_mfma_f32_16x16x32_bf16 a[40:43], v[232:235], a[124:127], a[40:43]
  s_waitcnt lgkmcnt(13)
  ds_read_b64_tr_b16 v[202:203], v14 offset:4096
  v_mfma_f32_16x16x32_bf16 a[12:15], v[236:239], a[120:123], a[12:15]
  ds_read_b64_tr_b16 v[204:205], v15 offset:0
  v_mfma_f32_16x16x32_bf16 a[44:47], v[236:239], a[124:127], a[44:47]
  s_waitcnt lgkmcnt(13)
  ds_read_b64_tr_b16 v[206:207], v15 offset:4096
  v_mfma_f32_16x16x32_bf16 a[16:19], v[240:243], a[120:123], a[16:19]
  ds_read_b64_tr_b16 v[208:209], v16 offset:0
  v_mfma_f32_16x16x32_bf16 a[48:51], v[240:243], a[124:127], a[48:51]
  s_waitcnt lgkmcnt(13)
  ds_read_b64_tr_b16 v[210:211], v16 offset:4096
  global_load_dwordx4 a[112:115], v22, s[18:19] offset:2048 sc1
  v_mfma_f32_16x16x32_bf16 a[20:23], v[244:247], a[120:123], a[20:23]
  ds_read_b64_tr_b16 v[212:213], v17 offset:0
  v_mfma_f32_16x16x32_bf16 a[52:55], v[244:247], a[124:127], a[52:55]
  s_waitcnt lgkmcnt(13)
  ds_read_b64_tr_b16 v[214:215], v17 offset:4096
  global_load_dwordx4 a[116:119], v23, s[18:19] offset:2048 sc1
  v_mfma_f32_16x16x32_bf16 a[24:27], v[248:251], a[120:123], a[24:27]
  ds_read_b64_tr_b16 v[216:217], v18 offset:0
  v_mfma_f32_16x16x32_bf16 a[56:59], v[248:251], a[124:127], a[56:59]
  s_waitcnt lgkmcnt(13)
  ds_read_b64_tr_b16 v[218:219], v18 offset:4096
  v_mfma_f32_16x16x32_bf16 a[28:31], v[252:255], a[120:123], a[28:31]
  ds_read_b64_tr_b16 v[220:221], v19 offset:0
  v_mfma_f32_16x16x32_bf16 a[60:63], v[252:255], a[124:127], a[60:63]
  ds_read_b64_tr_b16 v[222:223], v19 offset:4096
  s_waitcnt vmcnt(12)
  s_waitcnt lgkmcnt(14)
  v_mfma_f32_16x16x32_bf16 a[0:3], v[192:195], a[64:67], a[0:3]
  ds_read_b64_tr_b16 v[224:225], v12 offset:8192
  v_mfma_f32_16x16x32_bf16 a[32:35], v[192:195], a[68:71], a[32:35]
  s_waitcnt lgkmcnt(13)
  ds_read_b64_tr_b16 v[226:227], v12 offset:12288
  v_mfma_f32_16x16x32_bf16 a[4:7], v[196:199], a[64:67], a[4:7]
  ds_read_b64_tr_b16 v[228:229], v13 offset:8192
  v_mfma_f32_16x16x32_bf16 a[36:39], v[196:199], a[68:71], a[36:39]
  s_waitcnt lgkmcnt(13)
  ds_read_b64_tr_b16 v[230:231], v13 offset:12288
  v_mfma_f32_16x16x32_bf16 a[8:11], v[200:203], a[64:67], a[8:11]
  ds_read_b64_tr_b16 v[232:233], v14 offset:8192
  v_mfma_f32_16x16x32_bf16 a[40:43], v[200:203], a[68:71], a[40:43]
  s_waitcnt lgkmcnt(13)
  ds_read_b64_tr_b16 v[234:235], v14 offset:12288
  v_mfma_f32_16x16x32_bf16 a[12:15], v[204:207], a[64:67], a[12:15]
  ds_read_b64_tr_b16 v[236:237], v15 offset:8192
  v_mfma_f32_16x16x32_bf16 a[44:47], v[204:207], a[68:71], a[44:47]
  s_waitcnt lgkmcnt(13)
  ds_read_b64_tr_b16 v[238:239], v15 offset:12288
  v_mfma_f32_16x16x32_bf16 a[16:19], v[208:211], a[64:67], a[16:19]
  ds_read_b64_tr_b16 v[240:241], v16 offset:8192
  v_mfma_f32_16x16x32_bf16 a[48:51], v[208:211], a[68:71], a[48:51]
  s_waitcnt lgkmcnt(13)
  ds_read_b64_tr_b16 v[242:243], v16 offset:12288
  global_load_dwordx4 a[120:123], v22, s[18:19] offset:3072 sc1
  v_mfma_f32_16x16x32_bf16 a[20:23], v[212:215], a[64:67], a[20:23]
  ds_read_b64_tr_b16 v[244:245], v17 offset:8192
  v_mfma_f32_16x16x32_bf16 a[52:55], v[212:215], a[68:71], a[52:55]
  s_waitcnt lgkmcnt(13)
  ds_read_b64_tr_b16 v[246:247], v17 offset:12288
  global_load_dwordx4 a[124:127], v23, s[18:19] offset:3072 sc1
  s_add_u32 s39, s39, 4096
  s_and_b32 s39, s39, 0x7fff
  s_add_u32 s18, s58, s39
  s_addc_u32 s19, s59, 0
  v_mfma_f32_16x16x32_bf16 a[24:27], v[216:219], a[64:67], a[24:27]
  ds_read_b64_tr_b16 v[248:249], v18 offset:8192
  v_mfma_f32_16x16x32_bf16 a[56:59], v[216:219], a[68:71], a[56:59]
  s_waitcnt lgkmcnt(13)
  ds_read_b64_tr_b16 v[250:251], v18 offset:12288
  v_mfma_f32_16x16x32_bf16 a[28:31], v[220:223], a[64:67], a[28:31]
  ds_read_b64_tr_b16 v[252:253], v19 offset:8192
  v_mfma_f32_16x16x32_bf16 a[60:63], v[220:223], a[68:71], a[60:63]
  ds_read_b64_tr_b16 v[254:255], v19 offset:12288
  s_waitcnt vmcnt(12)
  s_waitcnt lgkmcnt(14)
  v_mfma_f32_16x16x32_bf16 a[0:3], v[224:227], a[72:75], a[0:3]
  ds_read_b64_tr_b16 v[192:193], v12 offset:16384
  v_mfma_f32_16x16x32_bf16 a[32:35], v[224:227], a[76:79], a[32:35]
  s_waitcnt lgkmcnt(13)
  ds_read_b64_tr_b16 v[194:195], v12 offset:20480
  v_mfma_f32_16x16x32_bf16 a[4:7], v[228:231], a[72:75], a[4:7]
  ds_read_b64_tr_b16 v[196:197], v13 offset:16384
  v_mfma_f32_16x16x32_bf16 a[36:39], v[228:231], a[76:79], a[36:39]
  s_waitcnt lgkmcnt(13)
  ds_read_b64_tr_b16 v[198:199], v13 offset:20480
  v_mfma_f32_16x16x32_bf16 a[8:11], v[232:235], a[72:75], a[8:11]
  ds_read_b64_tr_b16 v[200:201], v14 offset:16384
  v_mfma_f32_16x16x32_bf16 a[40:43], v[232:235], a[76:79], a[40:43]
  s_waitcnt lgkmcnt(13)
  ds_read_b64_tr_b16 v[202:203], v14 offset:20480
  v_mfma_f32_16x16x32_bf16 a[12:15], v[236:239], a[72:75], a[12:15]
  ds_read_b64_tr_b16 v[204:205], v15 offset:16384
  v_mfma_f32_16x16x32_bf16 a[44:47], v[236:239], a[76:79], a[44:47]
  s_waitcnt lgkmcnt(13)
  ds_read_b64_tr_b16 v[206:207], v15 offset:20480
  v_mfma_f32_16x16x32_bf16 a[16:19], v[240:243], a[72:75], a[16:19]
  ds_read_b64_tr_b16 v[208:209], v16 offset:16384
  v_mfma_f32_16x16x32_bf16 a[48:51], v[240:243], a[76:79], a[48:51]
  s_waitcnt lgkmcnt(13)
  ds_read_b64_tr_b16 v[210:211], v16 offset:20480
  v_mfma_f32_16x16x32_bf16 a[20:23], v[244:247], a[72:75], a[20:23]
  ds_read_b64_tr_b16 v[212:213], v17 offset:16384
  v_mfma_f32_16x16x32_bf16 a[52:55], v[244:247], a[76:79], a[52:55]
  s_waitcnt lgkmcnt(13)
  ds_read_b64_tr_b16 v[214:215], v17 offset:20480
  v_mfma_f32_16x16x32_bf16 a[24:27], v[248:251], a[72:75], a[24:27]
  ds_read_b64_tr_b16 v[216:217], v18 offset:16384
  v_mfma_f32_16x16x32_bf16 a[56:59], v[248:251], a[76:79], a[56:59]
  s_waitcnt lgkmcnt(13)
  ds_read_b64_tr_b16 v[218:219], v18 offset:20480
  v_mfma_f32_16x16x32_bf16 a[28:31], v[252:255], a[72:75], a[28:31]
  ds_read_b64_tr_b16 v[220:221], v19 offset:16384
  v_mfma_f32_16x16x32_bf16 a[60:63], v[252:255], a[76:79], a[60:63]
  ds_read_b64_tr_b16 v[222:223], v19 offset:20480
  s_waitcnt vmcnt(10)
  s_waitcnt lgkmcnt(14)
  v_mfma_f32_16x16x32_bf16 a[0:3], v[192:195], a[80:83], a[0:3]
  ds_read_b64_tr_b16 v[224:225], v12 offset:24576
  v_mfma_f32_16x16x32_bf16 a[32:35], v[192:195], a[84:87], a[32:35]
  s_waitcnt lgkmcnt(13)
  ds_read_b64_tr_b16 v[226:227], v12 offset:28672
  v_mfma_f32_16x16x32_bf16 a[4:7], v[196:199], a[80:83], a[4:7]
  ds_read_b64_tr_b16 v[228:229], v13 offset:24576
  v_mfma_f32_16x16x32_bf16 a[36:39], v[196:199], a[84:87], a[36:39]
  s_waitcnt lgkmcnt(13)
  ds_read_b64_tr_b16 v[230:231], v13 offset:28672
  v_mfma_f32_16x16x32_bf16 a[8:11], v[200:203], a[80:83], a[8:11]
  ds_read_b64_tr_b16 v[232:233], v14 offset:24576
  v_mfma_f32_16x16x32_bf16 a[40:43], v[200:203], a[84:87], a[40:43]
  s_waitcnt lgkmcnt(13)
  ds_read_b64_tr_b16 v[234:235], v14 offset:28672
  v_mfma_f32_16x16x32_bf16 a[12:15], v[204:207], a[80:83], a[12:15]
  ds_read_b64_tr_b16 v[236:237], v15 offset:24576
  v_mfma_f32_16x16x32_bf16 a[44:47], v[204:207], a[84:87], a[44:47]
  s_waitcnt lgkmcnt(13)
  ds_read_b64_tr_b16 v[238:239], v15 offset:28672
  v_mfma_f32_16x16x32_bf16 a[16:19], v[208:211], a[80:83], a[16:19]
  ds_read_b64_tr_b16 v[240:241], v16 offset:24576
  v_mfma_f32_16x16x32_bf16 a[48:51], v[208:211], a[84:87], a[48:51]
  s_waitcnt lgkmcnt(13)
  ds_read_b64_tr_b16 v[242:243], v16 offset:28672
  v_mfma_f32_16x16x32_bf16 a[20:23], v[212:215], a[80:83], a[20:23]
  ds_read_b64_tr_b16 v[244:245], v17 offset:24576
  v_mfma_f32_16x16x32_bf16 a[52:55], v[212:215], a[84:87], a[52:55]
  s_waitcnt lgkmcnt(13)
  ds_read_b64_tr_b16 v[246:247], v17 offset:28672
  v_mfma_f32_16x16x32_bf16 a[24:27], v[216:219], a[80:83], a[24:27]
  ds_read_b64_tr_b16 v[248:249], v18 offset:24576
  v_mfma_f32_16x16x32_bf16 a[56:59], v[216:219], a[84:87], a[56:59]
  s_waitcnt lgkmcnt(13)
  ds_read_b64_tr_b16 v[250:251], v18 offset:28672
  v_mfma_f32_16x16x32_bf16 a[28:31], v[220:223], a[80:83], a[28:31]
  ds_read_b64_tr_b16 v[252:253], v19 offset:24576
  v_mfma_f32_16x16x32_bf16 a[60:63], v[220:223], a[84:87], a[60:63]
  ds_read_b64_tr_b16 v[254:255], v19 offset:28672
  s_waitcnt vmcnt(8)
  s_waitcnt lgkmcnt(14)
  v_mfma_f32_16x16x32_bf16 a[0:3], v[224:227], a[88:91], a[0:3]
  ds_read_b64_tr_b16 v[192:193], v12 offset:32768
  v_mfma_f32_16x16x32_bf16 a[32:35], v[224:227], a[92:95], a[32:35]
  s_waitcnt lgkmcnt(13)
  ds_read_b64_tr_b16 v[194:195], v12 offset:36864
  v_mfma_f32_16x16x32_bf16 a[4:7], v[228:231], a[88:91], a[4:7]
  ds_read_b64_tr_b16 v[196:197], v13 offset:32768
  v_mfma_f32_16x16x32_bf16 a[36:39], v[228:231], a[92:95], a[36:39]
  s_waitcnt lgkmcnt(13)
  ds_read_b64_tr_b16 v[198:199], v13 offset:36864
  v_mfma_f32_16x16x32_bf16 a[8:11], v[232:235], a[88:91], a[8:11]
  ds_read_b64_tr_b16 v[200:201], v14 offset:32768
  v_mfma_f32_16x16x32_bf16 a[40:43], v[232:235], a[92:95], a[40:43]
  s_waitcnt lgkmcnt(13)
  ds_read_b64_tr_b16 v[202:203], v14 offset:36864
  v_mfma_f32_16x16x32_bf16 a[12:15], v[236:239], a[88:91], a[12:15]
  ds_read_b64_tr_b16 v[204:205], v15 offset:32768
  v_mfma_f32_16x16x32_bf16 a[44:47], v[236:239], a[92:95], a[44:47]
  s_waitcnt lgkmcnt(13)
  ds_read_b64_tr_b16 v[206:207], v15 offset:36864
  v_mfma_f32_16x16x32_bf16 a[16:19], v[240:243], a[88:91], a[16:19]
  ds_read_b64_tr_b16 v[208:209], v16 offset:32768
  v_mfma_f32_16x16x32_bf16 a[48:51], v[240:243], a[92:95], a[48:51]
  s_waitcnt lgkmcnt(13)
  ds_read_b64_tr_b16 v[210:211], v16 offset:36864
  v_mfma_f32_16x16x32_bf16 a[20:23], v[244:247], a[88:91], a[20:23]
  ds_read_b64_tr_b16 v[212:213], v17 offset:32768
  v_mfma_f32_16x16x32_bf16 a[52:55], v[244:247], a[92:95], a[52:55]
  s_waitcnt lgkmcnt(13)
  ds_read_b64_tr_b16 v[214:215], v17 offset:36864
  v_mfma_f32_16x16x32_bf16 a[24:27], v[248:251], a[88:91], a[24:27]
  ds_read_b64_tr_b16 v[216:217], v18 offset:32768
  v_mfma_f32_16x16x32_bf16 a[56:59], v[248:251], a[92:95], a[56:59]
  s_waitcnt lgkmcnt(13)
  ds_read_b64_tr_b16 v[218:219], v18 offset:36864
  v_mfma_f32_16x16x32_bf16 a[28:31], v[252:255], a[88:91], a[28:31]
  ds_read_b64_tr_b16 v[220:221], v19 offset:32768
  v_mfma_f32_16x16x32_bf16 a[60:63], v[252:255], a[92:95], a[60:63]
  ds_read_b64_tr_b16 v[222:223], v19 offset:36864
  s_waitcnt vmcnt(6)
  s_waitcnt lgkmcnt(14)
  v_mfma_f32_16x16x32_bf16 a[0:3], v[192:195], a[96:99], a[0:3]
  ds_read_b64_tr_b16 v[224:225], v12 offset:40960
  v_mfma_f32_16x16x32_bf16 a[32:35], v[192:195], a[100:103], a[32:35]
  s_waitcnt lgkmcnt(13)
  ds_read_b64_tr_b16 v[226:227], v12 offset:45056
  v_mfma_f32_16x16x32_bf16 a[4:7], v[196:199], a[96:99], a[4:7]
  ds_read_b64_tr_b16 v[228:229], v13 offset:40960
  v_mfma_f32_16x16x32_bf16 a[36:39], v[196:199], a[100:103], a[36:39]
  s_waitcnt lgkmcnt(13)
  ds_read_b64_tr_b16 v[230:231], v13 offset:45056
  v_mfma_f32_16x16x32_bf16 a[8:11], v[200:203], a[96:99], a[8:11]
  ds_read_b64_tr_b16 v[232:233], v14 offset:40960
  v_mfma_f32_16x16x32_bf16 a[40:43], v[200:203], a[100:103], a[40:43]
  s_waitcnt lgkmcnt(13)
  ds_read_b64_tr_b16 v[234:235], v14 offset:45056
  v_mfma_f32_16x16x32_bf16 a[12:15], v[204:207], a[96:99], a[12:15]
  ds_read_b64_tr_b16 v[236:237], v15 offset:40960
  v_mfma_f32_16x16x32_bf16 a[44:47], v[204:207], a[100:103], a[44:47]
  s_waitcnt lgkmcnt(13)
  ds_read_b64_tr_b16 v[238:239], v15 offset:45056
  v_mfma_f32_16x16x32_bf16 a[16:19], v[208:211], a[96:99], a[16:19]
  ds_read_b64_tr_b16 v[240:241], v16 offset:40960
  v_mfma_f32_16x16x32_bf16 a[48:51], v[208:211], a[100:103], a[48:51]
  s_waitcnt lgkmcnt(13)
  ds_read_b64_tr_b16 v[242:243], v16 offset:45056
  v_mfma_f32_16x16x32_bf16 a[20:23], v[212:215], a[96:99], a[20:23]
  ds_read_b64_tr_b16 v[244:245], v17 offset:40960
  v_mfma_f32_16x16x32_bf16 a[52:55], v[212:215], a[100:103], a[52:55]
  s_waitcnt lgkmcnt(13)
  ds_read_b64_tr_b16 v[246:247], v17 offset:45056
  v_mfma_f32_16x16x32_bf16 a[24:27], v[216:219], a[96:99], a[24:27]
  ds_read_b64_tr_b16 v[248:249], v18 offset:40960
  v_mfma_f32_16x16x32_bf16 a[56:59], v[216:219], a[100:103], a[56:59]
  s_waitcnt lgkmcnt(13)
  ds_read_b64_tr_b16 v[250:251], v18 offset:45056
  v_mfma_f32_16x16x32_bf16 a[28:31], v[220:223], a[96:99], a[28:31]
  ds_read_b64_tr_b16 v[252:253], v19 offset:40960
  v_mfma_f32_16x16x32_bf16 a[60:63], v[220:223], a[100:103], a[60:63]
  ds_read_b64_tr_b16 v[254:255], v19 offset:45056
  s_waitcnt vmcnt(4)
  s_waitcnt lgkmcnt(14)
  v_mfma_f32_16x16x32_bf16 a[0:3], v[224:227], a[104:107], a[0:3]
  ds_read_b64_tr_b16 v[192:193], v12 offset:49152
  v_mfma_f32_16x16x32_bf16 a[32:35], v[224:227], a[108:111], a[32:35]
  s_waitcnt lgkmcnt(13)
  ds_read_b64_tr_b16 v[194:195], v12 offset:53248
  v_mfma_f32_16x16x32_bf16 a[4:7], v[228:231], a[104:107], a[4:7]
  ds_read_b64_tr_b16 v[196:197], v13 offset:49152
  v_mfma_f32_16x16x32_bf16 a[36:39], v[228:231], a[108:111], a[36:39]
  s_waitcnt lgkmcnt(13)
  ds_read_b64_tr_b16 v[198:199], v13 offset:53248
  v_mfma_f32_16x16x32_bf16 a[8:11], v[232:235], a[104:107], a[8:11]
  ds_read_b64_tr_b16 v[200:201], v14 offset:49152
  v_mfma_f32_16x16x32_bf16 a[40:43], v[232:235], a[108:111], a[40:43]
  s_waitcnt lgkmcnt(13)
  ds_read_b64_tr_b16 v[202:203], v14 offset:53248
  v_mfma_f32_16x16x32_bf16 a[12:15], v[236:239], a[104:107], a[12:15]
  ds_read_b64_tr_b16 v[204:205], v15 offset:49152
  v_mfma_f32_16x16x32_bf16 a[44:47], v[236:239], a[108:111], a[44:47]
  s_waitcnt lgkmcnt(13)
  ds_read_b64_tr_b16 v[206:207], v15 offset:53248
  v_mfma_f32_16x16x32_bf16 a[16:19], v[240:243], a[104:107], a[16:19]
  ds_read_b64_tr_b16 v[208:209], v16 offset:49152
  v_mfma_f32_16x16x32_bf16 a[48:51], v[240:243], a[108:111], a[48:51]
  s_waitcnt lgkmcnt(13)
  ds_read_b64_tr_b16 v[210:211], v16 offset:53248
  v_mfma_f32_16x16x32_bf16 a[20:23], v[244:247], a[104:107], a[20:23]
  ds_read_b64_tr_b16 v[212:213], v17 offset:49152
  v_mfma_f32_16x16x32_bf16 a[52:55], v[244:247], a[108:111], a[52:55]
  s_waitcnt lgkmcnt(13)
  ds_read_b64_tr_b16 v[214:215], v17 offset:53248
  v_mfma_f32_16x16x32_bf16 a[24:27], v[248:251], a[104:107], a[24:27]
  ds_read_b64_tr_b16 v[216:217], v18 offset:49152
  v_mfma_f32_16x16x32_bf16 a[56:59], v[248:251], a[108:111], a[56:59]
  s_waitcnt lgkmcnt(13)
  ds_read_b64_tr_b16 v[218:219], v18 offset:53248
  v_mfma_f32_16x16x32_bf16 a[28:31], v[252:255], a[104:107], a[28:31]
  ds_read_b64_tr_b16 v[220:221], v19 offset:49152
  v_mfma_f32_16x16x32_bf16 a[60:63], v[252:255], a[108:111], a[60:63]
  ds_read_b64_tr_b16 v[222:223], v19 offset:53248
  s_waitcnt vmcnt(2)
  s_waitcnt lgkmcnt(14)
  v_mfma_f32_16x16x32_bf16 a[0:3], v[192:195], a[112:115], a[0:3]
  ds_read_b64_tr_b16 v[224:225], v12 offset:57344
  v_mfma_f32_16x16x32_bf16 a[32:35], v[192:195], a[116:119], a[32:35]
  s_waitcnt lgkmcnt(13)
  ds_read_b64_tr_b16 v[226:227], v12 offset:61440
  v_mfma_f32_16x16x32_bf16 a[4:7], v[196:199], a[112:115], a[4:7]
  ds_read_b64_tr_b16 v[228:229], v13 offset:57344
  v_mfma_f32_16x16x32_bf16 a[36:39], v[196:199], a[116:119], a[36:39]
  s_waitcnt lgkmcnt(13)
  ds_read_b64_tr_b16 v[230:231], v13 offset:61440
  v_mfma_f32_16x16x32_bf16 a[8:11], v[200:203], a[112:115], a[8:11]
  ds_read_b64_tr_b16 v[232:233], v14 offset:57344
  v_mfma_f32_16x16x32_bf16 a[40:43], v[200:203], a[116:119], a[40:43]
  s_waitcnt lgkmcnt(13)
  ds_read_b64_tr_b16 v[234:235], v14 offset:61440
  v_mfma_f32_16x16x32_bf16 a[12:15], v[204:207], a[112:115], a[12:15]
  ds_read_b64_tr_b16 v[236:237], v15 offset:57344
  v_mfma_f32_16x16x32_bf16 a[44:47], v[204:207], a[116:119], a[44:47]
  s_waitcnt lgkmcnt(13)
  ds_read_b64_tr_b16 v[238:239], v15 offset:61440
  v_mfma_f32_16x16x32_bf16 a[16:19], v[208:211], a[112:115], a[16:19]
  ds_read_b64_tr_b16 v[240:241], v16 offset:57344
  v_mfma_f32_16x16x32_bf16 a[48:51], v[208:211], a[116:119], a[48:51]
  s_waitcnt lgkmcnt(13)
  ds_read_b64_tr_b16 v[242:243], v16 offset:61440
  v_mfma_f32_16x16x32_bf16 a[20:23], v[212:215], a[112:115], a[20:23]
  ds_read_b64_tr_b16 v[244:245], v17 offset:57344
  v_mfma_f32_16x16x32_bf16 a[52:55], v[212:215], a[116:119], a[52:55]
  s_waitcnt lgkmcnt(13)
  ds_read_b64_tr_b16 v[246:247], v17 offset:61440
  v_mfma_f32_16x16x32_bf16 a[24:27], v[216:219], a[112:115], a[24:27]
  ds_read_b64_tr_b16 v[248:249], v18 offset:57344
  v_mfma_f32_16x16x32_bf16 a[56:59], v[216:219], a[116:119], a[56:59]
  s_waitcnt lgkmcnt(13)
  ds_read_b64_tr_b16 v[250:251], v18 offset:61440
  v_mfma_f32_16x16x32_bf16 a[28:31], v[220:223], a[112:115], a[28:31]
  ds_read_b64_tr_b16 v[252:253], v19 offset:57344
  v_mfma_f32_16x16x32_bf16 a[60:63], v[220:223], a[116:119], a[60:63]
  ds_read_b64_tr_b16 v[254:255], v19 offset:61440
  s_waitcnt vmcnt(0)
  s_waitcnt lgkmcnt(14)
  v_mfma_f32_16x16x32_bf16 a[0:3], v[224:227], a[120:123], a[0:3]
  v_mfma_f32_16x16x32_bf16 a[32:35], v[224:227], a[124:127], a[32:35]
  s_waitcnt lgkmcnt(12)
  v_mfma_f32_16x16x32_bf16 a[4:7], v[228:231], a[120:123], a[4:7]
  v_mfma_f32_16x16x32_bf16 a[36:39], v[228:231], a[124:127], a[36:39]
  s_waitcnt lgkmcnt(10)
  v_mfma_f32_16x16x32_bf16 a[8:11], v[232:235], a[120:123], a[8:11]
  v_mfma_f32_16x16x32_bf16 a[40:43], v[232:235], a[124:127], a[40:43]
  s_waitcnt lgkmcnt(8)
  v_mfma_f32_16x16x32_bf16 a[12:15], v[236:239], a[120:123], a[12:15]
  v_mfma_f32_16x16x32_bf16 a[44:47], v[236:239], a[124:127], a[44:47]
  s_waitcnt lgkmcnt(6)
  v_mfma_f32_16x16x32_bf16 a[16:19], v[240:243], a[120:123], a[16:19]
  v_mfma_f32_16x16x32_bf16 a[48:51], v[240:243], a[124:127], a[48:51]
  s_waitcnt lgkmcnt(4)
  v_mfma_f32_16x16x32_bf16 a[20:23], v[244:247], a[120:123], a[20:23]
  v_mfma_f32_16x16x32_bf16 a[52:55], v[244:247], a[124:127], a[52:55]
  s_waitcnt lgkmcnt(2)
  v_mfma_f32_16x16x32_bf16 a[24:27], v[248:251], a[120:123], a[24:27]
  v_mfma_f32_16x16x32_bf16 a[56:59], v[248:251], a[124:127], a[56:59]
  s_waitcnt lgkmcnt(0)
  v_mfma_f32_16x16x32_bf16 a[28:31], v[252:255], a[120:123], a[28:31]
  v_mfma_f32_16x16x32_bf16 a[60:63], v[252:255], a[124:127], a[60:63]
  s_lshl_b32 s20, s44, 1
  s_add_u32 s20, s20, s48
  s_lshl_b32 s20, s20, 2
  s_add_u32 s20, s20, s47
  s_lshl_b32 s20, s20, 4
  s_mul_i32 s20, s20, 14336
  s_add_u32 s20, s20, 16777216
  s_mul_i32 s21, s3, 2304
  s_add_u32 s20, s20, s21
  v_lshlrev_b32 v5, 4, v2
  v_add_u32 v5, s20, v5
  v_lshlrev_b32 v7, 2, v2
  v_add_u32 v7, s20, v7
  s_mul_i32 s63, s64, 0x9E3779B1
  s_mov_b32 s25, 0xffff0000
  v_accvgpr_read_b32 v64, a8
  v_accvgpr_read_b32 v65, a9
  v_accvgpr_read_b32 v66, a10
  v_accvgpr_read_b32 v67, a11
  v_accvgpr_read_b32 v68, a12
  v_accvgpr_read_b32 v69, a13
  v_accvgpr_read_b32 v70, a14
  v_accvgpr_read_b32 v71, a15
  v_accvgpr_read_b32 v72, a40
  v_accvgpr_read_b32 v73, a41
  v_accvgpr_read_b32 v74, a42
  v_accvgpr_read_b32 v75, a43
  v_accvgpr_read_b32 v76, a44
  v_accvgpr_read_b32 v77, a45
  v_accvgpr_read_b32 v78, a46
  v_accvgpr_read_b32 v79, a47
  v_cvt_pk_bf16_f32 v112, v64, v65
  v_cvt_pk_bf16_f32 v113, v66, v67
  v_cvt_pk_bf16_f32 v114, v68, v69
  v_cvt_pk_bf16_f32 v115, v70, v71
  v_cvt_pk_bf16_f32 v116, v72, v73
  v_cvt_pk_bf16_f32 v117, v74, v75
  v_cvt_pk_bf16_f32 v118, v76, v77
  v_cvt_pk_bf16_f32 v119, v78, v79
  v_alignbit_b32 v64, v112, v112, 30
  v_alignbit_b32 v65, v113, v113, 27
  v_alignbit_b32 v66, v114, v114, 24
  v_alignbit_b32 v67, v115, v115, 21
  v_alignbit_b32 v68, v116, v116, 18
  v_alignbit_b32 v69, v117, v117, 15
  v_alignbit_b32 v70, v118, v118, 12
  v_alignbit_b32 v71, v119, v119, 9
  v_add3_u32 v61, v64, v65, s63
  v_add3_u32 v61, v61, v66, v67
  v_add3_u32 v61, v61, v68, v69
  v_add3_u32 v61, v61, v70, v71
  s_xor_b32 s21, s46, 1
  s_lshl_b32 s21, s21, 2
  s_add_u32 s21, s21, s46
  s_mul_i32 s21, s21, 14336
  v_add_u32 v6, s21, v5
  v_add_u32 v4, s21, v7
  global_store_dwordx4 v6, v[112:115], s[8:9] sc1
  global_store_dwordx4 v6, v[116:119], s[8:9] offset:1024 sc1
  global_store_dword v4, v61, s[8:9] offset:2048 sc1
  v_accvgpr_read_b32 v80, a16
  v_accvgpr_read_b32 v81, a17
  v_accvgpr_read_b32 v82, a18
  v_accvgpr_read_b32 v83, a19
  v_accvgpr_read_b32 v84, a20
  v_accvgpr_read_b32 v85, a21
  v_accvgpr_read_b32 v86, a22
  v_accvgpr_read_b32 v87, a23
  v_accvgpr_read_b32 v88, a48
  v_accvgpr_read_b32 v89, a49
  v_accvgpr_read_b32 v90, a50
  v_accvgpr_read_b32 v91, a51
  v_accvgpr_read_b32 v92, a52
  v_accvgpr_read_b32 v93, a53
  v_accvgpr_read_b32 v94, a54
  v_accvgpr_read_b32 v95, a55
  v_cvt_pk_bf16_f32 v120, v80, v81
  v_cvt_pk_bf16_f32 v121, v82, v83
  v_cvt_pk_bf16_f32 v122, v84, v85
  v_cvt_pk_bf16_f32 v123, v86, v87
  v_cvt_pk_bf16_f32 v124, v88, v89
  v_cvt_pk_bf16_f32 v125, v90, v91
  v_cvt_pk_bf16_f32 v126, v92, v93
  v_cvt_pk_bf16_f32 v127, v94, v95
  v_alignbit_b32 v80, v120, v120, 30
  v_alignbit_b32 v81, v121, v121, 27
  v_alignbit_b32 v82, v122, v122, 24
  v_alignbit_b32 v83, v123, v123, 21
  v_alignbit_b32 v84, v124, v124, 18
  v_alignbit_b32 v85, v125, v125, 15
  v_alignbit_b32 v86, v126, v126, 12
  v_alignbit_b32 v87, v127, v127, 9
  v_add3_u32 v62, v80, v81, s63
  v_add3_u32 v62, v62, v82, v83
  v_add3_u32 v62, v62, v84, v85
  v_add3_u32 v62, v62, v86, v87
  s_xor_b32 s21, s46, 2
  s_lshl_b32 s21, s21, 2
  s_add_u32 s21, s21, s46
  s_mul_i32 s21, s21, 14336
  v_add_u32 v6, s21, v5
  v_add_u32 v4, s21, v7
  global_store_dwordx4 v6, v[120:123], s[8:9] sc1
  global_store_dwordx4 v6, v[124:127], s[8:9] offset:1024 sc1
  global_store_dword v4, v62, s[8:9] offset:2048 sc1
  v_accvgpr_read_b32 v96, a24
  v_accvgpr_read_b32 v97, a25
  v_accvgpr_read_b32 v98, a26
  v_accvgpr_read_b32 v99, a27
  v_accvgpr_read_b32 v100, a28
  v_accvgpr_read_b32 v101, a29
  v_accvgpr_read_b32 v102, a30
  v_accvgpr_read_b32 v103, a31
  v_accvgpr_read_b32 v104, a56
  v_accvgpr_read_b32 v105, a57
  v_accvgpr_read_b32 v106, a58
  v_accvgpr_read_b32 v107, a59
  v_accvgpr_read_b32 v108, a60
  v_accvgpr_read_b32 v109, a61
  v_accvgpr_read_b32 v110, a62
  v_accvgpr_read_b32 v111, a63
  v_cvt_pk_bf16_f32 v112, v96, v97
  v_cvt_pk_bf16_f32 v113, v98, v99
  v_cvt_pk_bf16_f32 v114, v100, v101
  v_cvt_pk_bf16_f32 v115, v102, v103
  v_cvt_pk_bf16_f32 v116, v104, v105
  v_cvt_pk_bf16_f32 v117, v106, v107
  v_cvt_pk_bf16_f32 v118, v108, v109
  v_cvt_pk_bf16_f32 v119, v110, v111
  v_alignbit_b32 v96, v112, v112, 30
  v_alignbit_b32 v97, v113, v113, 27
  v_alignbit_b32 v98, v114, v114, 24
  v_alignbit_b32 v99, v115, v115, 21
  v_alignbit_b32 v100, v116, v116, 18
  v_alignbit_b32 v101, v117, v117, 15
  v_alignbit_b32 v102, v118, v118, 12
  v_alignbit_b32 v103, v119, v119, 9
  v_add3_u32 v63, v96, v97, s63
  v_add3_u32 v63, v63, v98, v99
  v_add3_u32 v63, v63, v100, v101
  v_add3_u32 v63, v63, v102, v103
  s_xor_b32 s21, s46, 3
  s_lshl_b32 s21, s21, 2
  s_add_u32 s21, s21, s46
  s_mul_i32 s21, s21, 14336
  v_add_u32 v6, s21, v5
  v_add_u32 v4, s21, v7
  global_store_dwordx4 v6, v[112:115], s[8:9] sc1
  global_store_dwordx4 v6, v[116:119], s[8:9] offset:1024 sc1
  global_store_dword v4, v63, s[8:9] offset:2048 sc1
  v_accvgpr_read_b32 v40, a0
  v_accvgpr_read_b32 v41, a1
  v_accvgpr_read_b32 v42, a2
  v_accvgpr_read_b32 v43, a3
  v_accvgpr_read_b32 v44, a4
  v_accvgpr_read_b32 v45, a5
  v_accvgpr_read_b32 v46, a6
  v_accvgpr_read_b32 v47, a7
  v_accvgpr_read_b32 v48, a32
  v_accvgpr_read_b32 v49, a33
  v_accvgpr_read_b32 v50, a34
  v_accvgpr_read_b32 v51, a35
  v_accvgpr_read_b32 v52, a36
  v_accvgpr_read_b32 v53, a37
  v_accvgpr_read_b32 v54, a38
  v_accvgpr_read_b32 v55, a39
  s_xor_b32 s21, s46, 1
  s_lshl_b32 s22, s46, 2
  s_add_u32 s21, s21, s22
  s_mul_i32 s21, s21, 14336
  v_add_u32 v56, s21, v5
  v_add_u32 v64, s21, v7
  s_xor_b32 s21, s46, 2
  s_lshl_b32 s22, s46, 2
  s_add_u32 s21, s21, s22
  s_mul_i32 s21, s21, 14336
  v_add_u32 v57, s21, v5
  v_add_u32 v65, s21, v7
  s_xor_b32 s21, s46, 3
  s_lshl_b32 s22, s46, 2
  s_add_u32 s21, s21, s22
  s_mul_i32 s21, s21, 14336
  v_add_u32 v58, s21, v5
  v_add_u32 v66, s21, v7
  s_mov_b32 s31, 0
  global_load_dwordx4 v[128:131], v56, s[8:9] sc1
  global_load_dwordx4 v[132:135], v56, s[8:9] offset:1024 sc1
  global_load_dword v136, v64, s[8:9] offset:2048 sc1
  global_load_dwordx4 v[140:143], v57, s[8:9] sc1
  global_load_dwordx4 v[144:147], v57, s[8:9] offset:1024 sc1
  global_load_dword v148, v65, s[8:9] offset:2048 sc1
  global_load_dwordx4 v[152:155], v58, s[8:9] sc1
  global_load_dwordx4 v[156:159], v58, s[8:9] offset:1024 sc1
  global_load_dword v160, v66, s[8:9] offset:2048 sc1
  s_sleep 12
  global_load_dwordx4 v[164:167], v56, s[8:9] sc1
  global_load_dwordx4 v[168:171], v56, s[8:9] offset:1024 sc1
  global_load_dword v172, v64, s[8:9] offset:2048 sc1
  global_load_dwordx4 v[176:179], v57, s[8:9] sc1
  global_load_dwordx4 v[180:183], v57, s[8:9] offset:1024 sc1
  global_load_dword v184, v65, s[8:9] offset:2048 sc1
  global_load_dwordx4 v[188:191], v58, s[8:9] sc1
  global_load_dwordx4 v[192:195], v58, s[8:9] offset:1024 sc1
  global_load_dword v196, v66, s[8:9] offset:2048 sc1
L_rx:
  s_waitcnt vmcnt(9)
  v_alignbit_b32 v96, v128, v128, 30
  v_alignbit_b32 v97, v129, v129, 27
  v_alignbit_b32 v98, v130, v130, 24
  v_alignbit_b32 v99, v131, v131, 21
  v_alignbit_b32 v100, v132, v132, 18
  v_alignbit_b32 v101, v133, v133, 15
  v_alignbit_b32 v102, v134, v134, 12
  v_alignbit_b32 v103, v135, v135, 9
  v_add3_u32 v60, v96, v97, s63
  v_add3_u32 v60, v60, v98, v99
  v_add3_u32 v60, v60, v100, v101
  v_add3_u32 v60, v60, v102, v103
  v_xor_b32 v60, v60, v136
  v_mov_b32 v59, v60
  v_alignbit_b32 v96, v140, v140, 30
  v_alignbit_b32 v97, v141, v141, 27
  v_alignbit_b32 v98, v142, v142, 24
  v_alignbit_b32 v99, v143, v143, 21
  v_alignbit_b32 v100, v144, v144, 18
  v_alignbit_b32 v101, v145, v145, 15
  v_alignbit_b32 v102, v146, v146, 12
  v_alignbit_b32 v103, v147, v147, 9
  v_add3_u32 v60, v96, v97, s63
  v_add3_u32 v60, v60, v98, v99
  v_add3_u32 v60, v60, v100, v101
  v_add3_u32 v60, v60, v102, v103
  v_xor_b32 v60, v60, v148
  v_or_b32 v59, v59, v60
  v_alignbit_b32 v96, v152, v152, 30
  v_alignbit_b32 v97, v153, v153, 27
  v_alignbit_b32 v98, v154, v154, 24
  v_alignbit_b32 v99, v155, v155, 21
  v_alignbit_b32 v100, v156, v156, 18
  v_alignbit_b32 v101, v157, v157, 15
  v_alignbit_b32 v102, v158, v158, 12
  v_alignbit_b32 v103, v159, v159, 9
  v_add3_u32 v60, v96, v97, s63
  v_add3_u32 v60, v60, v98, v99
  v_add3_u32 v60, v60, v100, v101
  v_add3_u32 v60, v60, v102, v103
  v_xor_b32 v60, v60, v160
  v_or_b32 v59, v59, v60
  v_cmp_ne_u32 vcc, 0, v59
  s_add_u32 s31, s31, 1
  s_nop 2
  s_cmp_eq_u64 vcc, 0
  s_cbranch_scc1 L_rx_okA
  global_load_dwordx4 v[128:131], v56, s[8:9] sc1
  global_load_dwordx4 v[132:135], v56, s[8:9] offset:1024 sc1
  global_load_dword v136, v64, s[8:9] offset:2048 sc1
  global_load_dwordx4 v[140:143], v57, s[8:9] sc1
  global_load_dwordx4 v[144:147], v57, s[8:9] offset:1024 sc1
  global_load_dword v148, v65, s[8:9] offset:2048 sc1
  global_load_dwordx4 v[152:155], v58, s[8:9] sc1
  global_load_dwordx4 v[156:159], v58, s[8:9] offset:1024 sc1
  global_load_dword v160, v66, s[8:9] offset:2048 sc1
  s_waitcnt vmcnt(9)
  v_alignbit_b32 v96, v164, v164, 30
  v_alignbit_b32 v97, v165, v165, 27
  v_alignbit_b32 v98, v166, v166, 24
  v_alignbit_b32 v99, v167, v167, 21
  v_alignbit_b32 v100, v168, v168, 18
  v_alignbit_b32 v101, v169, v169, 15
  v_alignbit_b32 v102, v170, v170, 12
  v_alignbit_b32 v103, v171, v171, 9
  v_add3_u32 v60, v96, v97, s63
  v_add3_u32 v60, v60, v98, v99
  v_add3_u32 v60, v60, v100, v101
  v_add3_u32 v60, v60, v102, v103
  v_xor_b32 v60, v60, v172
  v_mov_b32 v59, v60
  v_alignbit_b32 v96, v176, v176, 30
  v_alignbit_b32 v97, v177, v177, 27
  v_alignbit_b32 v98, v178, v178, 24
  v_alignbit_b32 v99, v179, v179, 21
  v_alignbit_b32 v100, v180, v180, 18
  v_alignbit_b32 v101, v181, v181, 15
  v_alignbit_b32 v102, v182, v182, 12
  v_alignbit_b32 v103, v183, v183, 9
  v_add3_u32 v60, v96, v97, s63
  v_add3_u32 v60, v60, v98, v99
  v_add3_u32 v60, v60, v100, v101
  v_add3_u32 v60, v60, v102, v103
  v_xor_b32 v60, v60, v184
  v_or_b32 v59, v59, v60
  v_alignbit_b32 v96, v188, v188, 30
  v_alignbit_b32 v97, v189, v189, 27
  v_alignbit_b32 v98, v190, v190, 24
  v_alignbit_b32 v99, v191, v191, 21
  v_alignbit_b32 v100, v192, v192, 18
  v_alignbit_b32 v101, v193, v193, 15
  v_alignbit_b32 v102, v194, v194, 12
  v_alignbit_b32 v103, v195, v195, 9
  v_add3_u32 v60, v96, v97, s63
  v_add3_u32 v60, v60, v98, v99
  v_add3_u32 v60, v60, v100, v101
  v_add3_u32 v60, v60, v102, v103
  v_xor_b32 v60, v60, v196
  v_or_b32 v59, v59, v60
  v_cmp_ne_u32 vcc, 0, v59
  s_add_u32 s31, s31, 1
  s_nop 2
  s_cmp_eq_u64 vcc, 0
  s_cbranch_scc1 L_rx_okB
  global_load_dwordx4 v[164:167], v56, s[8:9] sc1
  global_load_dwordx4 v[168:171], v56, s[8:9] offset:1024 sc1
  global_load_dword v172, v64, s[8:9] offset:2048 sc1
  global_load_dwordx4 v[176:179], v57, s[8:9] sc1
  global_load_dwordx4 v[180:183], v57, s[8:9] offset:1024 sc1
  global_load_dword v184, v65, s[8:9] offset:2048 sc1
  global_load_dwordx4 v[188:191], v58, s[8:9] sc1
  global_load_dwordx4 v[192:195], v58, s[8:9] offset:1024 sc1
  global_load_dword v196, v66, s[8:9] offset:2048 sc1
  s_cmp_lt_u32 s31, 1048576
  s_cbranch_scc1 L_rx
L_rx_okA:
  v_lshlrev_b32 v68, 16, v128
  v_and_b32 v69, s25, v128
  v_pk_add_f32 v[40:41], v[40:41], v[68:69]
  v_lshlrev_b32 v68, 16, v129
  v_and_b32 v69, s25, v129
  v_pk_add_f32 v[42:43], v[42:43], v[68:69]
  v_lshlrev_b32 v68, 16, v130
  v_and_b32 v69, s25, v130
  v_pk_add_f32 v[44:45], v[44:45], v[68:69]
  v_lshlrev_b32 v68, 16, v131
  v_and_b32 v69, s25, v131
  v_pk_add_f32 v[46:47], v[46:47], v[68:69]
  v_lshlrev_b32 v68, 16, v132
  v_and_b32 v69, s25, v132
  v_pk_add_f32 v[48:49], v[48:49], v[68:69]
  v_lshlrev_b32 v68, 16, v133
  v_and_b32 v69, s25, v133
  v_pk_add_f32 v[50:51], v[50:51], v[68:69]
  v_lshlrev_b32 v68, 16, v134
  v_and_b32 v69, s25, v134
  v_pk_add_f32 v[52:53], v[52:53], v[68:69]
  v_lshlrev_b32 v68, 16, v135
  v_and_b32 v69, s25, v135
  v_pk_add_f32 v[54:55], v[54:55], v[68:69]
  v_lshlrev_b32 v68, 16, v140
  v_and_b32 v69, s25, v140
  v_pk_add_f32 v[40:41], v[40:41], v[68:69]
  v_lshlrev_b32 v68, 16, v141
  v_and_b32 v69, s25, v141
  v_pk_add_f32 v[42:43], v[42:43], v[68:69]
  v_lshlrev_b32 v68, 16, v142
  v_and_b32 v69, s25, v142
  v_pk_add_f32 v[44:45], v[44:45], v[68:69]
  v_lshlrev_b32 v68, 16, v143
  v_and_b32 v69, s25, v143
  v_pk_add_f32 v[46:47], v[46:47], v[68:69]
  v_lshlrev_b32 v68, 16, v144
  v_and_b32 v69, s25, v144
  v_pk_add_f32 v[48:49], v[48:49], v[68:69]
  v_lshlrev_b32 v68, 16, v145
  v_and_b32 v69, s25, v145
  v_pk_add_f32 v[50:51], v[50:51], v[68:69]
  v_lshlrev_b32 v68, 16, v146
  v_and_b32 v69, s25, v146
  v_pk_add_f32 v[52:53], v[52:53], v[68:69]
  v_lshlrev_b32 v68, 16, v147
  v_and_b32 v69, s25, v147
  v_pk_add_f32 v[54:55], v[54:55], v[68:69]
  v_lshlrev_b32 v68, 16, v152
  v_and_b32 v69, s25, v152
  v_pk_add_f32 v[40:41], v[40:41], v[68:69]
  v_lshlrev_b32 v68, 16, v153
  v_and_b32 v69, s25, v153
  v_pk_add_f32 v[42:43], v[42:43], v[68:69]
  v_lshlrev_b32 v68, 16, v154
  v_and_b32 v69, s25, v154
  v_pk_add_f32 v[44:45], v[44:45], v[68:69]
  v_lshlrev_b32 v68, 16, v155
  v_and_b32 v69, s25, v155
  v_pk_add_f32 v[46:47], v[46:47], v[68:69]
  v_lshlrev_b32 v68, 16, v156
  v_and_b32 v69, s25, v156
  v_pk_add_f32 v[48:49], v[48:49], v[68:69]
  v_lshlrev_b32 v68, 16, v157
  v_and_b32 v69, s25, v157
  v_pk_add_f32 v[50:51], v[50:51], v[68:69]
  v_lshlrev_b32 v68, 16, v158
  v_and_b32 v69, s25, v158
  v_pk_add_f32 v[52:53], v[52:53], v[68:69]
  v_lshlrev_b32 v68, 16, v159
  v_and_b32 v69, s25, v159
  v_pk_add_f32 v[54:55], v[54:55], v[68:69]
  s_branch L_rx_done
L_rx_okB:
  v_lshlrev_b32 v68, 16, v164
  v_and_b32 v69, s25, v164
  v_pk_add_f32 v[40:41], v[40:41], v[68:69]
  v_lshlrev_b32 v68, 16, v165
  v_and_b32 v69, s25, v165
  v_pk_add_f32 v[42:43], v[42:43], v[68:69]
  v_lshlrev_b32 v68, 16, v166
  v_and_b32 v69, s25, v166
  v_pk_add_f32 v[44:45], v[44:45], v[68:69]
  v_lshlrev_b32 v68, 16, v167
  v_and_b32 v69, s25, v167
  v_pk_add_f32 v[46:47], v[46:47], v[68:69]
  v_lshlrev_b32 v68, 16, v168
  v_and_b32 v69, s25, v168
  v_pk_add_f32 v[48:49], v[48:49], v[68:69]
  v_lshlrev_b32 v68, 16, v169
  v_and_b32 v69, s25, v169
  v_pk_add_f32 v[50:51], v[50:51], v[68:69]
  v_lshlrev_b32 v68, 16, v170
  v_and_b32 v69, s25, v170
  v_pk_add_f32 v[52:53], v[52:53], v[68:69]
  v_lshlrev_b32 v68, 16, v171
  v_and_b32 v69, s25, v171
  v_pk_add_f32 v[54:55], v[54:55], v[68:69]
  v_lshlrev_b32 v68, 16, v176
  v_and_b32 v69, s25, v176
  v_pk_add_f32 v[40:41], v[40:41], v[68:69]
  v_lshlrev_b32 v68, 16, v177
  v_and_b32 v69, s25, v177
  v_pk_add_f32 v[42:43], v[42:43], v[68:69]
  v_lshlrev_b32 v68, 16, v178
  v_and_b32 v69, s25, v178
  v_pk_add_f32 v[44:45], v[44:45], v[68:69]
  v_lshlrev_b32 v68, 16, v179
  v_and_b32 v69, s25, v179
  v_pk_add_f32 v[46:47], v[46:47], v[68:69]
  v_lshlrev_b32 v68, 16, v180
  v_and_b32 v69, s25, v180
  v_pk_add_f32 v[48:49], v[48:49], v[68:69]
  v_lshlrev_b32 v68, 16, v181
  v_and_b32 v69, s25, v181
  v_pk_add_f32 v[50:51], v[50:51], v[68:69]
  v_lshlrev_b32 v68, 16, v182
  v_and_b32 v69, s25, v182
  v_pk_add_f32 v[52:53], v[52:53], v[68:69]
  v_lshlrev_b32 v68, 16, v183
  v_and_b32 v69, s25, v183
  v_pk_add_f32 v[54:55], v[54:55], v[68:69]
  v_lshlrev_b32 v68, 16, v188
  v_and_b32 v69, s25, v188
  v_pk_add_f32 v[40:41], v[40:41], v[68:69]
  v_lshlrev_b32 v68, 16, v189
  v_and_b32 v69, s25, v189
  v_pk_add_f32 v[42:43], v[42:43], v[68:69]
  v_lshlrev_b32 v68, 16, v190
  v_and_b32 v69, s25, v190
  v_pk_add_f32 v[44:45], v[44:45], v[68:69]
  v_lshlrev_b32 v68, 16, v191
  v_and_b32 v69, s25, v191
  v_pk_add_f32 v[46:47], v[46:47], v[68:69]
  v_lshlrev_b32 v68, 16, v192
  v_and_b32 v69, s25, v192
  v_pk_add_f32 v[48:49], v[48:49], v[68:69]
  v_lshlrev_b32 v68, 16, v193
  v_and_b32 v69, s25, v193
  v_pk_add_f32 v[50:51], v[50:51], v[68:69]
  v_lshlrev_b32 v68, 16, v194
  v_and_b32 v69, s25, v194
  v_pk_add_f32 v[52:53], v[52:53], v[68:69]
  v_lshlrev_b32 v68, 16, v195
  v_and_b32 v69, s25, v195
  v_pk_add_f32 v[54:55], v[54:55], v[68:69]
L_rx_done:
  v_cvt_pk_bf16_f32 v112, v40, v41
  v_cvt_pk_bf16_f32 v113, v42, v43
  v_cvt_pk_bf16_f32 v114, v44, v45
  v_cvt_pk_bf16_f32 v115, v46, v47
  v_cvt_pk_bf16_f32 v116, v48, v49
  v_cvt_pk_bf16_f32 v117, v50, v51
  v_cvt_pk_bf16_f32 v118, v52, v53
  v_cvt_pk_bf16_f32 v119, v54, v55
  s_mul_i32 s20, s44, 224
  s_mul_i32 s21, s48, 112
  s_add_u32 s20, s20, s21
  s_lshl_b32 s21, s3, 5
  s_add_u32 s20, s20, s21
  s_lshl_b32 s20, s20, 10
  s_lshl_b32 s21, s47, 8
  s_add_u32 s20, s20, s21
  s_lshl_b32 s21, s46, 6
  s_add_u32 s20, s20, s21
  v_and_b32 v3, 15, v2
  v_lshlrev_b32 v3, 10, v3
  v_lshrrev_b32 v4, 4, v2
  v_lshl_add_u32 v3, v4, 3, v3
  v_add_u32 v3, s20, v3
  global_store_dwordx2 v3, v[112:113], s[10:11]
  global_store_dwordx2 v3, v[114:115], s[10:11] offset:32
  s_cmp_eq_u32 s3, 3
  s_cbranch_scc1 L_out_done
  v_add_u32 v3, 0x4000, v3
  global_store_dwordx2 v3, v[116:117], s[10:11]
  global_store_dwordx2 v3, v[118:119], s[10:11] offset:32
L_out_done:
L_k1_end:
  s_endpgm
L_slow:
  s_mov_b32 s60, 1
  s_waitcnt vmcnt(0) lgkmcnt(0)
  s_barrier
  v_xor_b32 v8, 0x10000, v8
  v_xor_b32 v9, 0x10000, v9
  v_xor_b32 v10, 0x10000, v10
  v_xor_b32 v11, 0x10000, v11
  v_xor_b32 v12, 0x10000, v12
  v_xor_b32 v13, 0x10000, v13
  v_xor_b32 v14, 0x10000, v14
  v_xor_b32 v15, 0x10000, v15
  v_xor_b32 v16, 0x10000, v16
  v_xor_b32 v17, 0x10000, v17
  v_xor_b32 v18, 0x10000, v18
  v_xor_b32 v19, 0x10000, v19
  v_mov_b32 v64, 0xff800000
  v_mov_b32 v68, 0xff800000
  v_mov_b32 v72, 0xff800000
  v_mov_b32 v76, 0xff800000
  v_mov_b32 v80, 0xff800000
  v_mov_b32 v84, 0xff800000
  v_mov_b32 v88, 0xff800000
  s_mov_b32 s47, 0
L_slow_loop:
  s_mov_b32 s28, 0
  s_mov_b32 s30, s29
  s_mov_b32 m0, s30
  s_mov_b32 s94, 0
  global_load_lds_dwordx4 v20, s[12:13] offset:0 nt
  global_load_lds_dwordx4 v21, s[12:13] offset:1024 nt
  global_load_lds_dwordx4 v22, s[12:13] offset:2048 nt
  global_load_lds_dwordx4 v23, s[12:13] offset:3072 nt
  s_add_u32 m0, s30, 0x4000
  s_nop 0
  global_load_lds_dwordx4 v24, s[16:17] offset:0 nt
  global_load_lds_dwordx4 v25, s[16:17] offset:1024 nt
  global_load_lds_dwordx4 v24, s[16:17] offset:2048 nt
  global_load_lds_dwordx4 v25, s[16:17] offset:3072 nt
  s_add_u32 s28, s28, 0x8000
  s_and_b32 s28, s28, 0x1ffff
  s_add_u32 s30, s28, s29
  s_mov_b32 m0, s30
  s_add_u32 s24, s24, 0x4000
  s_and_b32 s24, s24, 0x3ffff
  s_add_u32 s12, s50, s24
  s_addc_u32 s13, s51, 0
  s_add_u32 s16, s52, s24
  s_addc_u32 s17, s53, 0
  s_waitcnt vmcnt(0)
  s_barrier
  ds_read_b128 a[224:227], v8 offset:0
  ds_read_b128 a[240:243], v8 offset:4096
  ds_read_b128 a[228:231], v9 offset:0
  ds_read_b128 a[244:247], v9 offset:4096
  ds_read_b128 a[232:235], v10 offset:0
  ds_read_b128 a[248:251], v10 offset:4096
  ds_read_b128 a[236:239], v11 offset:0
  ds_read_b128 a[252:255], v11 offset:4096
  s_waitcnt lgkmcnt(0)
  v_mfma_f32_16x16x32_bf16 v[40:43], a[224:227], v[128:131], 0
  v_mfma_f32_16x16x32_bf16 v[44:47], a[240:243], v[128:131], 0
  v_mfma_f32_16x16x32_bf16 v[40:43], a[228:231], v[132:135], v[40:43]
  v_mfma_f32_16x16x32_bf16 v[44:47], a[244:247], v[132:135], v[44:47]
  v_mfma_f32_16x16x32_bf16 v[40:43], a[232:235], v[136:139], v[40:43]
  v_mfma_f32_16x16x32_bf16 v[44:47], a[248:251], v[136:139], v[44:47]
  v_mfma_f32_16x16x32_bf16 v[40:43], a[236:239], v[140:143], v[40:43]
  v_mfma_f32_16x16x32_bf16 v[44:47], a[252:255], v[140:143], v[44:47]
  s_nop 15
  v_max3_f32 v35, v40, v41, v42
  v_max3_f32 v35, v35, v43, v44
  v_max3_f32 v35, v35, v45, v46
  v_max3_f32 v64, v64, v35, v47
  s_nop 7
  v_mfma_f32_16x16x32_bf16 v[40:43], a[224:227], v[144:147], 0
  v_mfma_f32_16x16x32_bf16 v[44:47], a[240:243], v[144:147], 0
  v_mfma_f32_16x16x32_bf16 v[40:43], a[228:231], v[148:151], v[40:43]
  v_mfma_f32_16x16x32_bf16 v[44:47], a[244:247], v[148:151], v[44:47]
  v_mfma_f32_16x16x32_bf16 v[40:43], a[232:235], v[152:155], v[40:43]
  v_mfma_f32_16x16x32_bf16 v[44:47], a[248:251], v[152:155], v[44:47]
  v_mfma_f32_16x16x32_bf16 v[40:43], a[236:239], v[156:159], v[40:43]
  v_mfma_f32_16x16x32_bf16 v[44:47], a[252:255], v[156:159], v[44:47]
  s_nop 15
  v_max3_f32 v35, v40, v41, v42
  v_max3_f32 v35, v35, v43, v44
  v_max3_f32 v35, v35, v45, v46
  v_max3_f32 v68, v68, v35, v47
  s_nop 7
  v_mfma_f32_16x16x32_bf16 v[40:43], a[224:227], v[160:163], 0
  v_mfma_f32_16x16x32_bf16 v[44:47], a[240:243], v[160:163], 0
  v_mfma_f32_16x16x32_bf16 v[40:43], a[228:231], v[164:167], v[40:43]
  v_mfma_f32_16x16x32_bf16 v[44:47], a[244:247], v[164:167], v[44:47]
  v_mfma_f32_16x16x32_bf16 v[40:43], a[232:235], v[168:171], v[40:43]
  v_mfma_f32_16x16x32_bf16 v[44:47], a[248:251], v[168:171], v[44:47]
  v_mfma_f32_16x16x32_bf16 v[40:43], a[236:239], v[172:175], v[40:43]
  v_mfma_f32_16x16x32_bf16 v[44:47], a[252:255], v[172:175], v[44:47]
  s_nop 15
  v_max3_f32 v35, v40, v41, v42
  v_max3_f32 v35, v35, v43, v44
  v_max3_f32 v35, v35, v45, v46
  v_max3_f32 v72, v72, v35, v47
  s_nop 7
  v_mfma_f32_16x16x32_bf16 v[40:43], a[224:227], v[176:179], 0
  v_mfma_f32_16x16x32_bf16 v[44:47], a[240:243], v[176:179], 0
  v_mfma_f32_16x16x32_bf16 v[40:43], a[228:231], v[180:183], v[40:43]
  v_mfma_f32_16x16x32_bf16 v[44:47], a[244:247], v[180:183], v[44:47]
  v_mfma_f32_16x16x32_bf16 v[40:43], a[232:235], v[184:187], v[40:43]
  v_mfma_f32_16x16x32_bf16 v[44:47], a[248:251], v[184:187], v[44:47]
  v_mfma_f32_16x16x32_bf16 v[40:43], a[236:239], v[188:191], v[40:43]
  v_mfma_f32_16x16x32_bf16 v[44:47], a[252:255], v[188:191], v[44:47]
  s_nop 15
  v_max3_f32 v35, v40, v41, v42
  v_max3_f32 v35, v35, v43, v44
  v_max3_f32 v35, v35, v45, v46
  v_max3_f32 v76, v76, v35, v47
  s_nop 7
  v_mfma_f32_16x16x32_bf16 v[40:43], a[224:227], v[192:195], 0
  v_mfma_f32_16x16x32_bf16 v[44:47], a[240:243], v[192:195], 0
  v_mfma_f32_16x16x32_bf16 v[40:43], a[228:231], v[196:199], v[40:43]
  v_mfma_f32_16x16x32_bf16 v[44:47], a[244:247], v[196:199], v[44:47]
  v_mfma_f32_16x16x32_bf16 v[40:43], a[232:235], v[200:203], v[40:43]
  v_mfma_f32_16x16x32_bf16 v[44:47], a[248:251], v[200:203], v[44:47]
  v_mfma_f32_16x16x32_bf16 v[40:43], a[236:239], v[204:207], v[40:43]
  v_mfma_f32_16x16x32_bf16 v[44:47], a[252:255], v[204:207], v[44:47]
  s_nop 15
  v_max3_f32 v35, v40, v41, v42
  v_max3_f32 v35, v35, v43, v44
  v_max3_f32 v35, v35, v45, v46
  v_max3_f32 v80, v80, v35, v47
  s_nop 7
  v_mfma_f32_16x16x32_bf16 v[40:43], a[224:227], v[208:211], 0
  v_mfma_f32_16x16x32_bf16 v[44:47], a[240:243], v[208:211], 0
  v_mfma_f32_16x16x32_bf16 v[40:43], a[228:231], v[212:215], v[40:43]
  v_mfma_f32_16x16x32_bf16 v[44:47], a[244:247], v[212:215], v[44:47]
  v_mfma_f32_16x16x32_bf16 v[40:43], a[232:235], v[216:219], v[40:43]
  v_mfma_f32_16x16x32_bf16 v[44:47], a[248:251], v[216:219], v[44:47]
  v_mfma_f32_16x16x32_bf16 v[40:43], a[236:239], v[220:223], v[40:43]
  v_mfma_f32_16x16x32_bf16 v[44:47], a[252:255], v[220:223], v[44:47]
  s_nop 15
  v_max3_f32 v35, v40, v41, v42
  v_max3_f32 v35, v35, v43, v44
  v_max3_f32 v35, v35, v45, v46
  v_max3_f32 v84, v84, v35, v47
  s_nop 7
  v_mfma_f32_16x16x32_bf16 v[40:43], a[224:227], v[224:227], 0
  v_mfma_f32_16x16x32_bf16 v[44:47], a[240:243], v[224:227], 0
  v_mfma_f32_16x16x32_bf16 v[40:43], a[228:231], v[228:231], v[40:43]
  v_mfma_f32_16x16x32_bf16 v[44:47], a[244:247], v[228:231], v[44:47]
  v_mfma_f32_16x16x32_bf16 v[40:43], a[232:235], v[232:235], v[40:43]
  v_mfma_f32_16x16x32_bf16 v[44:47], a[248:251], v[232:235], v[44:47]
  v_mfma_f32_16x16x32_bf16 v[40:43], a[236:239], v[236:239], v[40:43]
  v_mfma_f32_16x16x32_bf16 v[44:47], a[252:255], v[236:239], v[44:47]
  s_nop 15
  v_max3_f32 v35, v40, v41, v42
  v_max3_f32 v35, v35, v43, v44
  v_max3_f32 v35, v35, v45, v46
  v_max3_f32 v88, v88, v35, v47
  s_nop 7
  s_barrier
  s_add_u32 s47, s47, 1
  s_cmp_lt_u32 s47, 16
  s_cbranch_scc1 L_slow_loop
  v_mov_b32 v65, v64
  v_mov_b32 v69, v68
  v_mov_b32 v73, v72
  v_mov_b32 v77, v76
  v_mov_b32 v81, v80
  v_mov_b32 v85, v84
  v_mov_b32 v89, v88
  s_nop 1
  v_permlane16_swap_b32 v64, v65
  v_permlane16_swap_b32 v68, v69
  v_permlane16_swap_b32 v72, v73
  v_permlane16_swap_b32 v76, v77
  v_permlane16_swap_b32 v80, v81
  v_permlane16_swap_b32 v84, v85
  v_permlane16_swap_b32 v88, v89
  s_nop 1
  v_max_f32 v64, v64, v65
  v_max_f32 v68, v68, v69
  v_max_f32 v72, v72, v73
  v_max_f32 v76, v76, v77
  v_max_f32 v80, v80, v81
  v_max_f32 v84, v84, v85
  v_max_f32 v88, v88, v89
  v_mov_b32 v65, v64
  v_mov_b32 v69, v68
  v_mov_b32 v73, v72
  v_mov_b32 v77, v76
  v_mov_b32 v81, v80
  v_mov_b32 v85, v84
  v_mov_b32 v89, v88
  s_nop 1
  v_permlane32_swap_b32 v64, v65
  v_permlane32_swap_b32 v68, v69
  v_permlane32_swap_b32 v72, v73
  v_permlane32_swap_b32 v76, v77
  v_permlane32_swap_b32 v80, v81
  v_permlane32_swap_b32 v84, v85
  v_permlane32_swap_b32 v88, v89
  s_nop 1
  v_max_f32 v64, v64, v65
  v_max_f32 v68, v68, v69
  v_max_f32 v72, v72, v73
  v_max_f32 v76, v76, v77
  v_max_f32 v80, v80, v81
  v_max_f32 v84, v84, v85
  v_max_f32 v88, v88, v89
  v_lshlrev_b32 v35, 2, v2
  s_lshl_b32 s20, s3, 11
  v_add_u32 v36, s20, v35
  s_xor_b32 s21, s3, 1
  s_lshl_b32 s21, s21, 11
  v_add_u32 v37, s21, v35
  ds_write_b32 v36, v64 offset:0
  ds_write_b32 v36, v68 offset:256
  ds_write_b32 v36, v72 offset:512
  ds_write_b32 v36, v76 offset:768
  ds_write_b32 v36, v80 offset:1024
  ds_write_b32 v36, v84 offset:1280
  ds_write_b32 v36, v88 offset:1536
  s_waitcnt lgkmcnt(0)
  s_barrier
  ds_read_b32 v65, v37 offset:0
  ds_read_b32 v69, v37 offset:256
  ds_read_b32 v73, v37 offset:512
  ds_read_b32 v77, v37 offset:768
  ds_read_b32 v81, v37 offset:1024
  ds_read_b32 v85, v37 offset:1280
  ds_read_b32 v89, v37 offset:1536
  s_waitcnt lgkmcnt(0)
  v_max_f32 v64, v64, v65
  v_max_f32 v68, v68, v69
  v_max_f32 v72, v72, v73
  v_max_f32 v76, v76, v77
  v_max_f32 v80, v80, v81
  v_max_f32 v84, v84, v85
  v_max_f32 v88, v88, v89
  v_sub_f32 v64, 0, v64
  v_sub_f32 v68, 0, v68
  v_sub_f32 v72, 0, v72
  v_sub_f32 v76, 0, v76
  v_sub_f32 v80, 0, v80
  v_sub_f32 v84, 0, v84
  v_sub_f32 v88, 0, v88
  v_mov_b32 v65, v64
  v_mov_b32 v69, v68
  v_mov_b32 v73, v72
  v_mov_b32 v77, v76
  v_mov_b32 v81, v80
  v_mov_b32 v85, v84
  v_mov_b32 v89, v88
  v_mov_b32 v66, v64
  v_mov_b32 v70, v68
  v_mov_b32 v74, v72
  v_mov_b32 v78, v76
  v_mov_b32 v82, v80
  v_mov_b32 v86, v84
  v_mov_b32 v90, v88
  v_mov_b32 v67, v64
  v_mov_b32 v71, v68
  v_mov_b32 v75, v72
  v_mov_b32 v79, v76
  v_mov_b32 v83, v80
  v_mov_b32 v87, v84
  v_mov_b32 v91, v88
  s_barrier
  v_accvgpr_write_b32 a0, 0
  v_accvgpr_write_b32 a1, 0
  v_accvgpr_write_b32 a2, 0
  v_accvgpr_write_b32 a3, 0
  v_accvgpr_write_b32 a4, 0
  v_accvgpr_write_b32 a5, 0
  v_accvgpr_write_b32 a6, 0
  v_accvgpr_write_b32 a7, 0
  v_accvgpr_write_b32 a8, 0
  v_accvgpr_write_b32 a9, 0
  v_accvgpr_write_b32 a10, 0
  v_accvgpr_write_b32 a11, 0
  v_accvgpr_write_b32 a12, 0
  v_accvgpr_write_b32 a13, 0
  v_accvgpr_write_b32 a14, 0
  v_accvgpr_write_b32 a15, 0
  v_accvgpr_write_b32 a16, 0
  v_accvgpr_write_b32 a17, 0
  v_accvgpr_write_b32 a18, 0
  v_accvgpr_write_b32 a19, 0
  v_accvgpr_write_b32 a20, 0
  v_accvgpr_write_b32 a21, 0
  v_accvgpr_write_b32 a22, 0
  v_accvgpr_write_b32 a23, 0
  v_accvgpr_write_b32 a24, 0
  v_accvgpr_write_b32 a25, 0
  v_accvgpr_write_b32 a26, 0
  v_accvgpr_write_b32 a27, 0
  v_accvgpr_write_b32 a28, 0
  v_accvgpr_write_b32 a29, 0
  v_accvgpr_write_b32 a30, 0
  v_accvgpr_write_b32 a31, 0
  v_accvgpr_write_b32 a32, 0
  v_accvgpr_write_b32 a33, 0
  v_accvgpr_write_b32 a34, 0
  v_accvgpr_write_b32 a35, 0
  v_accvgpr_write_b32 a36, 0
  v_accvgpr_write_b32 a37, 0
  v_accvgpr_write_b32 a38, 0
  v_accvgpr_write_b32 a39, 0
  v_accvgpr_write_b32 a40, 0
  v_accvgpr_write_b32 a41, 0
  v_accvgpr_write_b32 a42, 0
  v_accvgpr_write_b32 a43, 0
  v_accvgpr_write_b32 a44, 0
  v_accvgpr_write_b32 a45, 0
  v_accvgpr_write_b32 a46, 0
  v_accvgpr_write_b32 a47, 0
  v_accvgpr_write_b32 a48, 0
  v_accvgpr_write_b32 a49, 0
  v_accvgpr_write_b32 a50, 0
  v_accvgpr_write_b32 a51, 0
  v_accvgpr_write_b32 a52, 0
  v_accvgpr_write_b32 a53, 0
  v_accvgpr_write_b32 a54, 0
  v_accvgpr_write_b32 a55, 0
  v_accvgpr_write_b32 a56, 0
  v_accvgpr_write_b32 a57, 0
  v_accvgpr_write_b32 a58, 0
  v_accvgpr_write_b32 a59, 0
  v_accvgpr_write_b32 a60, 0
  v_accvgpr_write_b32 a61, 0
  v_accvgpr_write_b32 a62, 0
  v_accvgpr_write_b32 a63, 0
  v_accvgpr_write_b32 a64, 0
  v_accvgpr_write_b32 a65, 0
  v_accvgpr_write_b32 a66, 0
  v_accvgpr_write_b32 a67, 0
  v_accvgpr_write_b32 a68, 0
  v_accvgpr_write_b32 a69, 0
  v_accvgpr_write_b32 a70, 0
  v_accvgpr_write_b32 a71, 0
  v_accvgpr_write_b32 a72, 0
  v_accvgpr_write_b32 a73, 0
  v_accvgpr_write_b32 a74, 0
  v_accvgpr_write_b32 a75, 0
  v_accvgpr_write_b32 a76, 0
  v_accvgpr_write_b32 a77, 0
  v_accvgpr_write_b32 a78, 0
  v_accvgpr_write_b32 a79, 0
  v_accvgpr_write_b32 a80, 0
  v_accvgpr_write_b32 a81, 0
  v_accvgpr_write_b32 a82, 0
  v_accvgpr_write_b32 a83, 0
  v_accvgpr_write_b32 a84, 0
  v_accvgpr_write_b32 a85, 0
  v_accvgpr_write_b32 a86, 0
  v_accvgpr_write_b32 a87, 0
  v_accvgpr_write_b32 a88, 0
  v_accvgpr_write_b32 a89, 0
  v_accvgpr_write_b32 a90, 0
  v_accvgpr_write_b32 a91, 0
  v_accvgpr_write_b32 a92, 0
  v_accvgpr_write_b32 a93, 0
  v_accvgpr_write_b32 a94, 0
  v_accvgpr_write_b32 a95, 0
  v_accvgpr_write_b32 a96, 0
  v_accvgpr_write_b32 a97, 0
  v_accvgpr_write_b32 a98, 0
  v_accvgpr_write_b32 a99, 0
  v_accvgpr_write_b32 a100, 0
  v_accvgpr_write_b32 a101, 0
  v_accvgpr_write_b32 a102, 0
  v_accvgpr_write_b32 a103, 0
  v_accvgpr_write_b32 a104, 0
  v_accvgpr_write_b32 a105, 0
  v_accvgpr_write_b32 a106, 0
  v_accvgpr_write_b32 a107, 0
  v_accvgpr_write_b32 a108, 0
  v_accvgpr_write_b32 a109, 0
  v_accvgpr_write_b32 a110, 0
  v_accvgpr_write_b32 a111, 0
  v_accvgpr_write_b32 a112, 0
  v_accvgpr_write_b32 a113, 0
  v_accvgpr_write_b32 a114, 0
  v_accvgpr_write_b32 a115, 0
  v_accvgpr_write_b32 a116, 0
  v_accvgpr_write_b32 a117, 0
  v_accvgpr_write_b32 a118, 0
  v_accvgpr_write_b32 a119, 0
  v_accvgpr_write_b32 a120, 0
  v_accvgpr_write_b32 a121, 0
  v_accvgpr_write_b32 a122, 0
  v_accvgpr_write_b32 a123, 0
  v_accvgpr_write_b32 a124, 0
  v_accvgpr_write_b32 a125, 0
  v_accvgpr_write_b32 a126, 0
  v_accvgpr_write_b32 a127, 0
  v_accvgpr_write_b32 a128, 0
  v_accvgpr_write_b32 a129, 0
  v_accvgpr_write_b32 a130, 0
  v_accvgpr_write_b32 a131, 0
  v_accvgpr_write_b32 a132, 0
  v_accvgpr_write_b32 a133, 0
  v_accvgpr_write_b32 a134, 0
  v_accvgpr_write_b32 a135, 0
  v_accvgpr_write_b32 a136, 0
  v_accvgpr_write_b32 a137, 0
  v_accvgpr_write_b32 a138, 0
  v_accvgpr_write_b32 a139, 0
  v_accvgpr_write_b32 a140, 0
  v_accvgpr_write_b32 a141, 0
  v_accvgpr_write_b32 a142, 0
  v_accvgpr_write_b32 a143, 0
  v_accvgpr_write_b32 a144, 0
  v_accvgpr_write_b32 a145, 0
  v_accvgpr_write_b32 a146, 0
  v_accvgpr_write_b32 a147, 0
  v_accvgpr_write_b32 a148, 0
  v_accvgpr_write_b32 a149, 0
  v_accvgpr_write_b32 a150, 0
  v_accvgpr_write_b32 a151, 0
  v_accvgpr_write_b32 a152, 0
  v_accvgpr_write_b32 a153, 0
  v_accvgpr_write_b32 a154, 0
  v_accvgpr_write_b32 a155, 0
  v_accvgpr_write_b32 a156, 0
  v_accvgpr_write_b32 a157, 0
  v_accvgpr_write_b32 a158, 0
  v_accvgpr_write_b32 a159, 0
  v_accvgpr_write_b32 a160, 0
  v_accvgpr_write_b32 a161, 0
  v_accvgpr_write_b32 a162, 0
  v_accvgpr_write_b32 a163, 0
  v_accvgpr_write_b32 a164, 0
  v_accvgpr_write_b32 a165, 0
  v_accvgpr_write_b32 a166, 0
  v_accvgpr_write_b32 a167, 0
  v_accvgpr_write_b32 a168, 0
  v_accvgpr_write_b32 a169, 0
  v_accvgpr_write_b32 a170, 0
  v_accvgpr_write_b32 a171, 0
  v_accvgpr_write_b32 a172, 0
  v_accvgpr_write_b32 a173, 0
  v_accvgpr_write_b32 a174, 0
  v_accvgpr_write_b32 a175, 0
  v_accvgpr_write_b32 a176, 0
  v_accvgpr_write_b32 a177, 0
  v_accvgpr_write_b32 a178, 0
  v_accvgpr_write_b32 a179, 0
  v_accvgpr_write_b32 a180, 0
  v_accvgpr_write_b32 a181, 0
  v_accvgpr_write_b32 a182, 0
  v_accvgpr_write_b32 a183, 0
  v_accvgpr_write_b32 a184, 0
  v_accvgpr_write_b32 a185, 0
  v_accvgpr_write_b32 a186, 0
  v_accvgpr_write_b32 a187, 0
  v_accvgpr_write_b32 a188, 0
  v_accvgpr_write_b32 a189, 0
  v_accvgpr_write_b32 a190, 0
  v_accvgpr_write_b32 a191, 0
  v_accvgpr_write_b32 a192, 0
  v_accvgpr_write_b32 a193, 0
  v_accvgpr_write_b32 a194, 0
  v_accvgpr_write_b32 a195, 0
  v_accvgpr_write_b32 a196, 0
  v_accvgpr_write_b32 a197, 0
  v_accvgpr_write_b32 a198, 0
  v_accvgpr_write_b32 a199, 0
  v_accvgpr_write_b32 a200, 0
  v_accvgpr_write_b32 a201, 0
  v_accvgpr_write_b32 a202, 0
  v_accvgpr_write_b32 a203, 0
  v_accvgpr_write_b32 a204, 0
  v_accvgpr_write_b32 a205, 0
  v_accvgpr_write_b32 a206, 0
  v_accvgpr_write_b32 a207, 0
  v_accvgpr_write_b32 a208, 0
  v_accvgpr_write_b32 a209, 0
  v_accvgpr_write_b32 a210, 0
  v_accvgpr_write_b32 a211, 0
  v_accvgpr_write_b32 a212, 0
  v_accvgpr_write_b32 a213, 0
  v_accvgpr_write_b32 a214, 0
  v_accvgpr_write_b32 a215, 0
  v_accvgpr_write_b32 a216, 0
  v_accvgpr_write_b32 a217, 0
  v_accvgpr_write_b32 a218, 0
  v_accvgpr_write_b32 a219, 0
  v_accvgpr_write_b32 a220, 0
  v_accvgpr_write_b32 a221, 0
  v_accvgpr_write_b32 a222, 0
  v_accvgpr_write_b32 a223, 0
  v_mov_b32 v26, 0
  v_mov_b32 v27, 0
  v_mov_b32 v28, 0
  v_mov_b32 v29, 0
  v_mov_b32 v30, 0
  v_mov_b32 v31, 0
  v_mov_b32 v32, 0
  s_mov_b32 s28, 0
  s_mov_b32 s30, s29
  s_mov_b32 m0, s30
  s_mov_b32 s94, 0
  s_add_u32 s12, s50, s24
  s_addc_u32 s13, s51, 0
  s_add_u32 s16, s52, s24
  s_addc_u32 s17, s53, 0
  global_load_lds_dwordx4 v20, s[12:13] offset:0 nt
  global_load_lds_dwordx4 v21, s[12:13] offset:1024 nt
  global_load_lds_dwordx4 v22, s[12:13] offset:2048 nt
  global_load_lds_dwordx4 v23, s[12:13] offset:3072 nt
  s_add_u32 m0, s30, 0x4000
  s_nop 0
  global_load_lds_dwordx4 v24, s[16:17] offset:0 nt
  global_load_lds_dwordx4 v25, s[16:17] offset:1024 nt
  global_load_lds_dwordx4 v24, s[16:17] offset:2048 nt
  global_load_lds_dwordx4 v25, s[16:17] offset:3072 nt
  s_add_u32 s28, s28, 0x8000
  s_and_b32 s28, s28, 0x1ffff
  s_add_u32 s30, s28, s29
  s_mov_b32 m0, s30
  s_add_u32 s24, s24, 0x4000
  s_and_b32 s24, s24, 0x3ffff
  s_add_u32 s12, s50, s24
  s_addc_u32 s13, s51, 0
  s_add_u32 s16, s52, s24
  s_addc_u32 s17, s53, 0
  global_load_lds_dwordx4 v20, s[12:13] offset:0 nt
  global_load_lds_dwordx4 v21, s[12:13] offset:1024 nt
  global_load_lds_dwordx4 v22, s[12:13] offset:2048 nt
  global_load_lds_dwordx4 v23, s[12:13] offset:3072 nt
  s_add_u32 m0, s30, 0x4000
  s_nop 0
  global_load_lds_dwordx4 v24, s[16:17] offset:0 nt
  global_load_lds_dwordx4 v25, s[16:17] offset:1024 nt
  global_load_lds_dwordx4 v24, s[16:17] offset:2048 nt
  global_load_lds_dwordx4 v25, s[16:17] offset:3072 nt
  s_add_u32 s28, s28, 0x8000
  s_and_b32 s28, s28, 0x1ffff
  s_add_u32 s30, s28, s29
  s_mov_b32 m0, s30
  s_add_u32 s24, s24, 0x4000
  s_and_b32 s24, s24, 0x3ffff
  s_add_u32 s12, s50, s24
  s_addc_u32 s13, s51, 0
  s_add_u32 s16, s52, s24
  s_addc_u32 s17, s53, 0
  global_load_lds_dwordx4 v20, s[12:13] offset:0 nt
  global_load_lds_dwordx4 v21, s[12:13] offset:1024 nt
  global_load_lds_dwordx4 v22, s[12:13] offset:2048 nt
  global_load_lds_dwordx4 v23, s[12:13] offset:3072 nt
  s_add_u32 m0, s30, 0x4000
  s_nop 0
  global_load_lds_dwordx4 v24, s[16:17] offset:0 nt
  global_load_lds_dwordx4 v25, s[16:17] offset:1024 nt
  global_load_lds_dwordx4 v24, s[16:17] offset:2048 nt
  global_load_lds_dwordx4 v25, s[16:17] offset:3072 nt
  s_add_u32 s28, s28, 0x8000
  s_and_b32 s28, s28, 0x1ffff
  s_add_u32 s30, s28, s29
  s_mov_b32 m0, s30
  s_add_u32 s24, s24, 0x4000
  s_and_b32 s24, s24, 0x3ffff
  s_add_u32 s12, s50, s24
  s_addc_u32 s13, s51, 0
  s_add_u32 s16, s52, s24
  s_addc_u32 s17, s53, 0
  global_load_lds_dwordx4 v20, s[12:13] offset:0 nt
  global_load_lds_dwordx4 v21, s[12:13] offset:1024 nt
  global_load_lds_dwordx4 v22, s[12:13] offset:2048 nt
  global_load_lds_dwordx4 v23, s[12:13] offset:3072 nt
  s_add_u32 m0, s30, 0x4000
  s_nop 0
  s_and_b32 s38, s45, 7
  s_lshl_b32 s38, s38, 17
  s_add_u32 s14, s56, s38
  s_addc_u32 s15, s57, 0
  s_waitcnt vmcnt(20)
  s_barrier
  ds_read_b128 a[224:227], v8 offset:0
  ds_read_b128 a[240:243], v8 offset:4096
  ds_read_b128 a[228:231], v9 offset:0
  ds_read_b128 a[244:247], v9 offset:4096
  ds_read_b128 a[232:235], v10 offset:0
  ds_read_b128 a[248:251], v10 offset:4096
  ds_read_b128 a[236:239], v11 offset:0
  ds_read_b128 a[252:255], v11 offset:4096
  ds_read_b64_tr_b16 v[96:97], v12 offset:0
  ds_read_b64_tr_b16 v[98:99], v12 offset:4096
  ds_read_b64_tr_b16 v[100:101], v13 offset:0
  ds_read_b64_tr_b16 v[102:103], v13 offset:4096
  ds_read_b64_tr_b16 v[104:105], v14 offset:0
  ds_read_b64_tr_b16 v[106:107], v14 offset:4096
  ds_read_b64_tr_b16 v[108:109], v15 offset:0
  ds_read_b64_tr_b16 v[110:111], v15 offset:4096
  ds_read_b64_tr_b16 v[112:113], v16 offset:0
  ds_read_b64_tr_b16 v[114:115], v16 offset:4096
  ds_read_b64_tr_b16 v[116:117], v17 offset:0
  ds_read_b64_tr_b16 v[118:119], v17 offset:4096
  ds_read_b64_tr_b16 v[120:121], v18 offset:0
  ds_read_b64_tr_b16 v[122:123], v18 offset:4096
  ds_read_b64_tr_b16 v[124:125], v19 offset:0
  ds_read_b64_tr_b16 v[126:127], v19 offset:4096
  s_waitcnt lgkmcnt(0)
  s_nop 1
  v_mfma_f32_16x16x32_bf16 v[40:43], a[224:227], v[128:131], v[64:67]
  v_mfma_f32_16x16x32_bf16 v[44:47], a[240:243], v[128:131], v[64:67]
  v_mfma_f32_16x16x32_bf16 v[40:43], a[228:231], v[132:135], v[40:43]
  v_mfma_f32_16x16x32_bf16 v[44:47], a[244:247], v[132:135], v[44:47]
  v_mfma_f32_16x16x32_bf16 v[40:43], a[232:235], v[136:139], v[40:43]
  v_mfma_f32_16x16x32_bf16 v[44:47], a[248:251], v[136:139], v[44:47]
  v_mfma_f32_16x16x32_bf16 v[40:43], a[236:239], v[140:143], v[40:43]
  v_mfma_f32_16x16x32_bf16 v[44:47], a[252:255], v[140:143], v[44:47]
  v_mfma_f32_16x16x32_bf16 v[48:51], a[224:227], v[144:147], v[68:71]
  v_mfma_f32_16x16x32_bf16 v[52:55], a[240:243], v[144:147], v[68:71]
  v_mfma_f32_16x16x32_bf16 v[48:51], a[228:231], v[148:151], v[48:51]
  v_mfma_f32_16x16x32_bf16 v[52:55], a[244:247], v[148:151], v[52:55]
  v_mfma_f32_16x16x32_bf16 v[48:51], a[232:235], v[152:155], v[48:51]
  v_mfma_f32_16x16x32_bf16 v[52:55], a[248:251], v[152:155], v[52:55]
  v_mfma_f32_16x16x32_bf16 v[48:51], a[236:239], v[156:159], v[48:51]
  v_exp_f32 v40, v40
  v_exp_f32 v41, v41
  v_mfma_f32_16x16x32_bf16 v[52:55], a[252:255], v[156:159], v[52:55]
  v_exp_f32 v42, v42
  v_exp_f32 v43, v43
  v_exp_f32 v44, v44
  v_exp_f32 v45, v45
  v_exp_f32 v46, v46
  v_exp_f32 v47, v47
  v_add_f32 v26, v26, v40
  v_add_f32 v26, v26, v41
  v_cvt_pk_bf16_f32 v56, v40, v41
  v_add_f32 v26, v26, v42
  v_add_f32 v26, v26, v43
  v_cvt_pk_bf16_f32 v57, v42, v43
  v_add_f32 v26, v26, v44
  v_add_f32 v26, v26, v45
  v_cvt_pk_bf16_f32 v58, v44, v45
  v_add_f32 v26, v26, v46
  v_add_f32 v26, v26, v47
  v_cvt_pk_bf16_f32 v59, v46, v47
  v_exp_f32 v48, v48
  v_exp_f32 v49, v49
  s_nop 0
  v_add_f32 v27, v27, v48
  v_add_f32 v27, v27, v49
  v_cvt_pk_bf16_f32 v60, v48, v49
  s_branch L_attn_start
.section .rodata,"a"
.p2align 6
.amdhsa_kernel standalone__gqa_block_cached__near_ridge_kernel
  .amdhsa_next_free_vgpr 512
  .amdhsa_next_free_sgpr 102
  .amdhsa_accum_offset 256
  .amdhsa_group_segment_fixed_size 0
  .amdhsa_kernarg_size 64
  .amdhsa_user_sgpr_count 2
  .amdhsa_user_sgpr_kernarg_segment_ptr 1
  .amdhsa_system_sgpr_workgroup_id_x 1
.end_amdhsa_kernel
```
